```python
import torch

def _softmax(x, axis=-1):
    return torch.softmax(x, dim=axis)
def _gelu(x):
    return torch.nn.functional.gelu(x, approximate="tanh")
def _silu(x):
    return torch.nn.functional.silu(x)
def _sigmoid(x):
    return torch.sigmoid(x)
def _layernorm(x, axis=-1, eps=1e-5):
    m = x.mean(dim=axis, keepdim=True)
    v = x.var(dim=axis, keepdim=True, unbiased=False)
    return (x - m) / torch.sqrt(v + eps)
def _scatter_add(tgt, idx, src, axis=0):
    return tgt.clone().index_add_(axis, idx, src)
def _segment_sum(src, seg, n):
    out = torch.zeros((n,) + src.shape[1:], dtype=src.dtype)
    return out.index_add_(0, seg, src)
def _pad(x, pw):
    flat = tuple(v for pair in reversed(pw) for v in pair)
    return torch.nn.functional.pad(x, flat)

kernel_name = 'sequential_preLN__sliding_local_dilated__mixer_s_mlp__prompt'

def setup_inputs():

    _w = (lambda a: (lambda t: t.to(torch.bfloat16) if t.is_floating_point() else t)(torch.as_tensor(a)))
    def _A_setup():
        B, S, D = 1, 2048, 640
        return {
            "x": _w((lambda *s: torch.randn(*s, dtype=torch.bfloat16) * 0.05)(B, S, D)),
            "wqkv": _w((lambda *s: torch.randn(*s, dtype=torch.bfloat16) * 0.05)(D, 3 * D)),
            "wo": _w((lambda *s: torch.randn(*s, dtype=torch.bfloat16) * 0.05)(D, D)),
        }
    _A_in = _A_setup()

    def _B_setup():
        B, S, D, F = 1, 2048, 640, 1536
        return {
            "x":  _w((lambda *s: torch.randn(*s, dtype=torch.bfloat16) * 0.05)(B, S, D)),
            "w1": _w((lambda *s: torch.randn(*s, dtype=torch.bfloat16) * 3.2)(D, D) * (D ** -0.5)),
            "w2": _w((lambda *s: torch.randn(*s, dtype=torch.bfloat16) * 3.2)(D, D) * (D ** -0.5)),
            "w3": _w((lambda *s: torch.randn(*s, dtype=torch.bfloat16) * 3.2)(D, F) * (D ** -0.5)),
            "w4": _w((lambda *s: torch.randn(*s, dtype=torch.bfloat16) * 3.2)(F, D) * (F ** -0.5)),
        }
    _B_in = _B_setup()

    return {
        "A_x": _A_in["x"],
        "A_wqkv": _A_in["wqkv"],
        "A_wo": _A_in["wo"],
        "B_x": _B_in["x"],
        "B_w1": _B_in["w1"],
        "B_w2": _B_in["w2"],
        "B_w3": _B_in["w3"],
        "B_w4": _B_in["w4"],
    }

def reference(A_x, A_wqkv, A_wo, B_x, B_w1, B_w2, B_w3, B_w4):
    def _A_ref(x, wqkv, wo):
        B, S, D = x.shape
        H = 32; Dh = D // H
        W, dil = 8, 2
        qkv = (lambda x, *d: x.permute(*d))((x @ wqkv).reshape(B, S, 3, H, Dh), 2, 0, 3, 1, 4)
        q, k, v = qkv[0], qkv[1], qkv[2]
        scale = Dh ** -0.5
        pos = torch.arange(S)
        off = torch.arange(W) * dil
        idx = pos[:, None] - off[None, :]
        mask = idx >= 0
        idx_c = torch.where(mask, idx, 0).reshape(-1)
        kg = k[:, :, idx_c, :].reshape(B, H, S, W, Dh)
        vg = v[:, :, idx_c, :].reshape(B, H, S, W, Dh)
        logits = torch.einsum("bhsd,bhswd->bhsw", q, kg) * scale
        logits = torch.where(mask[None, None, :, :], logits, -1e9)
        attn = _softmax(logits, axis=-1)
        o = torch.einsum("bhsw,bhswd->bhsd", attn, vg)
        return (lambda x, *d: x.permute(*d))(o, 0, 2, 1, 3).reshape(B, S, D) @ wo

    def _B_ref(x, w1, w2, w3, w4):
        B, S, D = x.shape
        h = _gelu(_layernorm(x, axis=-1) @ w1)
        c = D // 4
        g0 = _pad(h[:, :, 0*c:1*c], ((0, 0), (1, 0), (0, 0)))[:, :S, :]
        g1 = _pad(h[:, :, 1*c:2*c], ((0, 0), (0, 1), (0, 0)))[:, 1:, :]
        g2 = _pad(h[:, :, 2*c:3*c], ((0, 0), (2, 0), (0, 0)))[:, :S, :]
        g3 = _pad(h[:, :, 3*c:   ], ((0, 0), (0, 2), (0, 0)))[:, 2:, :]
        hs = torch.concatenate([g0, g1, g2, g3], axis=-1) @ w2
        x1 = x + hs
        h2 = _gelu(_layernorm(x1, axis=-1) @ w3) @ w4
        return x1 + h2

    x = A_x
    h = x + _A_ref(_layernorm(x, axis=-1), A_wqkv, A_wo)
    h2 = h + _B_ref(_layernorm(h, axis=-1), B_w1, B_w2, B_w3, B_w4)
    return h2
```

```asm
; @launch grid=(256,1,1) block=(512,1,1) lds=163840
.amdgcn_target "amdgcn-amd-amdhsa--gfx950"
.text
.globl sequential_preLN__sliding_local_dilated__mixer_s_mlp__prompt_kernel
.p2align 8
.type sequential_preLN__sliding_local_dilated__mixer_s_mlp__prompt_kernel,@function
sequential_preLN__sliding_local_dilated__mixer_s_mlp__prompt_kernel:
    s_cmp_ge_u32 s2, 256
    s_cbranch_scc1 L_end
    s_load_dwordx16 s[4:19], s[0:1], 0
    s_load_dwordx4 s[20:23], s[0:1], 64
    s_load_dwordx2 s[24:25], s[0:1], 80
    s_getpc_b64 s[62:63]
L_pcref:
    s_lshr_b32 s57, s2, 3
    s_lshl_b32 s57, s57, 12
    v_lshlrev_b32 v1, 7, v0
    v_add_u32 v1, s57, v1
    v_min_u32 v1, L_code_end-L_pcref-4, v1
    v_cmp_gt_u32 vcc, 32, v0
    s_and_saveexec_b64 s[26:27], vcc
    s_cbranch_execz L_nopf
    global_load_dword v255, v1, s[62:63]
L_nopf:
    s_mov_b64 exec, -1
    v_and_b32 v1, 63, v0
    v_lshrrev_b32 v0, 6, v0
    s_nop 0
    v_readfirstlane_b32 s40, v0
    s_and_b32 s41, s2, 7
    s_lshr_b32 s57, s2, 3
    s_lshr_b32 s42, s57, 3
    s_and_b32 s43, s57, 7
    s_lshl_b32 s44, s41, 2
    s_add_u32 s44, s44, s42
    v_lshlrev_b32 v2, 4, v1
    v_lshlrev_b32 v3, 3, v1
    v_mov_b32 v4, 153600
    s_mov_b32 s46, 131072
    s_add_u32 s51, s42, 0
    s_and_b32 s51, s51, 3
    s_add_u32 s52, s42, 1
    s_and_b32 s52, s52, 3
    s_add_u32 s53, s42, 2
    s_and_b32 s53, s53, 3
    s_add_u32 s54, s42, 3
    s_and_b32 s54, s54, 3
    s_lshl_b32 s73, s42, 1
    s_mov_b32 s72, 0x3f803f80
    s_cmp_lg_u32 s40, 4
    s_cbranch_scc1 L_noinit
    v_lshl_add_u32 v12, v1, 2, v4
    v_mov_b32 v14, 0
    v_mov_b32 v15, 0
    v_mov_b32 v16, 0
    v_mov_b32 v17, 0
    v_add_u32 v13, 161792, v2
    v_cmp_eq_u32 vcc, 16, v1
    s_nop 1
    v_cndmask_b32_e64 v18, 0, 2, vcc
    ds_write_b32 v12, v18
    ds_write_b32 v12, v14 offset:1408
    ds_write_b32 v12, v14 offset:1664
    ds_write_b128 v13, v[14:17]
    ds_write_b128 v13, v[14:17] offset:1024
    s_waitcnt lgkmcnt(0)
L_noinit:
    s_barrier
    s_lshl_b32 s57, 1, s40
    s_and_b32 s57, s57, 0xb0
    s_cbranch_scc0 L_compute
    s_setprio 3
    s_min_u32 s57, s40, 6
    s_sub_u32 s57, s57, 4
    s_lshl_b32 s70, s57, 11
    s_add_u32 s70, s70, 155648
    s_lshl_b32 s63, s57, 8
    s_add_u32 s63, s63, s2
    s_add_u32 s63, s63, 0
    v_mov_b32 v35, 0
    s_add_u32 s64, s63, 0
    s_cmp_ge_u32 s64, 1680
    s_cbranch_scc1 Lpd_1_4
    s_mul_hi_u32 s66, s64, 214748365
    s_mul_i32 s57, s66, 20
    s_sub_u32 s65, s64, s57
    s_mul_hi_u32 s71, s66, 429496730
    s_min_u32 s71, s71, 6
    s_mul_i32 s57, s71, 10
    s_sub_u32 s66, s66, s57
    s_branch Lpd_1
Lpd_1_4:
    s_sub_u32 s57, s64, 1680
    s_mul_hi_u32 s66, s57, 89478486
    s_mul_i32 s58, s66, 48
    s_sub_u32 s65, s57, s58
    s_mov_b32 s71, 7
Lpd_1:
    s_lshl_b32 s59, s66, 7
    v_lshrrev_b32 v28, 3, v1
    v_and_b32 v29, 7, v1
    s_cmp_lt_u32 s71, 3
    s_cbranch_scc1 Lpa_2_q
    s_cmp_eq_u32 s71, 7
    s_cbranch_scc1 Lpa_2_4
    s_mul_hi_u32 s57, s65, 858993460
    s_mul_i32 s58, s57, 5
    s_sub_u32 s58, s65, s58
    s_mul_i32 s57, s57, 160
    s_lshr_b32 s60, s58, 1
    s_mul_i32 s60, s60, 80
    s_and_b32 s68, s58, 1
    s_lshl_b32 s68, s68, 5
    s_add_u32 s60, s60, s68
    s_cmp_eq_u32 s58, 4
    s_cselect_b32 s60, 64, s60
    s_cselect_b32 s68, 80, 16
    s_add_u32 s67, s57, s60
    s_add_u32 s68, s67, s68
    s_cmp_eq_u32 s71, 6
    s_movk_i32 s69, 1280
    s_cselect_b32 s69, 3072, s69
    s_lshl_b32 s60, s69, 3
    s_branch Lpa_2
Lpa_2_4:
    s_lshr_b32 s57, s65, 4
    s_lshl_b32 s67, s57, 6
    s_bfe_u32 s57, s65, 0x30001
    s_mul_i32 s57, s57, 192
    s_add_u32 s67, s67, s57
    s_and_b32 s57, s65, 1
    s_lshl_b32 s57, s57, 5
    s_add_u32 s67, s67, s57
    s_add_u32 s68, s67, 16
    s_movk_i32 s69, 1280
    s_movk_i32 s60, 10240
    s_branch Lpa_2
Lpa_2_q:
    s_lshl_b32 s67, s65, 5
    s_add_u32 s68, s67, 4
    s_movk_i32 s69, 3840
    s_mov_b32 s60, 61440
    s_add_u32 s57, s71, 1
    s_cmp_eq_u32 s57, 3
    s_cselect_b32 s57, 0, s57
    s_mul_i32 s57, s57, 1280
    s_add_u32 s59, s59, s57
    v_and_b32 v30, 4, v28
    v_add_u32 v28, v28, v30
Lpa_2:
    v_mul_lo_u32 v36, s69, v28
    v_lshl_add_u32 v36, v29, 4, v36
    v_add_u32 v37, s60, v36
    s_mul_i32 s67, s67, s69
    s_add_u32 s67, s67, s59
    s_mul_i32 s68, s68, s69
    s_add_u32 s68, s68, s59
    s_cmp_ge_u32 s64, 2160
    s_cselect_b32 s67, 1073741824, s67
    s_cselect_b32 s68, 1073741824, s68
    s_waitcnt lgkmcnt(0)
    s_mov_b32 s36, s6
    s_mov_b32 s37, s7
    s_mov_b32 s38, 819200
    s_mov_b32 s39, 0x20000
    s_cmp_eq_u32 s71, 3
    s_cselect_b64 s[36:37], s[8:9], s[36:37]
    s_cmp_eq_u32 s71, 4
    s_cselect_b64 s[36:37], s[12:13], s[36:37]
    s_cmp_eq_u32 s71, 5
    s_cselect_b64 s[36:37], s[14:15], s[36:37]
    s_cmp_eq_u32 s71, 6
    s_cselect_b64 s[36:37], s[16:17], s[36:37]
    s_cmp_eq_u32 s71, 7
    s_cselect_b64 s[36:37], s[18:19], s[36:37]
    s_cmp_ge_u32 s71, 6
    s_cselect_b32 s38, 1966080, s38
    s_cmp_lt_u32 s71, 3
    s_cselect_b32 s38, 2457600, s38
    buffer_load_dwordx4 v[64:67], v36, s[36:39], s67 offen nt
    buffer_load_dwordx4 v[68:71], v37, s[36:39], s67 offen nt
    buffer_load_dwordx4 v[72:75], v36, s[36:39], s68 offen nt
    buffer_load_dwordx4 v[76:79], v37, s[36:39], s68 offen nt
    s_mov_b32 s28, s24
    s_mov_b32 s29, s25
    s_mov_b32 s30, 26902528
    s_mov_b32 s31, 0x20000
    s_cmp_eq_u32 s40, 7
    s_cbranch_scc1 L_service
    s_branch L_loader
L_compute:
    s_cmp_eq_u32 s40, 6
    s_cbranch_scc1 L_relay
    s_add_u32 s62, s40, 1
    s_lshl_b32 s45, s44, 2
    s_add_u32 s45, s45, s40
    s_mul_i32 s61, s40, 20480
    s_add_u32 s61, s61, 71680
    s_mul_i32 s75, s45, 20480
    v_lshrrev_b32 v228, 3, v1
    v_and_b32 v229, 7, v1
    v_lshrrev_b32 v231, 1, v228
    v_xor_b32 v229, v229, v231
    v_mul_u32_u24 v228, 1280, v228
    v_add_u32 v228, s75, v228
    v_lshl_add_u32 v230, v229, 4, v228
    v_xor_b32 v229, 4, v229
    v_lshl_add_u32 v231, v229, 4, v228
    v_add_u32 v231, 9216, v231
    s_lshl_b32 s58, s73, 7
    s_waitcnt lgkmcnt(0)
    s_mov_b32 s32, s4
    s_mov_b32 s33, s5
    s_mov_b32 s34, 2621440
    s_mov_b32 s35, 0x20000
    s_add_u32 m0, s61, 0
    s_nop 0
    buffer_load_dwordx4 v230, s[32:35], s58 offen nt lds
    buffer_load_dwordx4 v231, s[32:35], s58 offen offset:1024 nt lds
    s_add_u32 s58, s58, 128
    s_cmp_ge_u32 s58, 1280
    s_cselect_b32 s58, 0, s58
    s_add_u32 m0, s61, 2048
    s_nop 0
    buffer_load_dwordx4 v230, s[32:35], s58 offen nt lds
    buffer_load_dwordx4 v231, s[32:35], s58 offen offset:1024 nt lds
    s_add_u32 s58, s58, 128
    s_cmp_ge_u32 s58, 1280
    s_cselect_b32 s58, 0, s58
    s_add_u32 m0, s61, 4096
    s_nop 0
    buffer_load_dwordx4 v230, s[32:35], s58 offen nt lds
    buffer_load_dwordx4 v231, s[32:35], s58 offen offset:1024 nt lds
    s_add_u32 s58, s58, 128
    s_cmp_ge_u32 s58, 1280
    s_cselect_b32 s58, 0, s58
    s_add_u32 m0, s61, 6144
    s_nop 0
    buffer_load_dwordx4 v230, s[32:35], s58 offen nt lds
    buffer_load_dwordx4 v231, s[32:35], s58 offen offset:1024 nt lds
    s_add_u32 s58, s58, 128
    s_cmp_ge_u32 s58, 1280
    s_cselect_b32 s58, 0, s58
    s_add_u32 m0, s61, 8192
    s_nop 0
    buffer_load_dwordx4 v230, s[32:35], s58 offen nt lds
    buffer_load_dwordx4 v231, s[32:35], s58 offen offset:1024 nt lds
    s_add_u32 s58, s58, 128
    s_cmp_ge_u32 s58, 1280
    s_cselect_b32 s58, 0, s58
    s_add_u32 m0, s61, 10240
    s_nop 0
    buffer_load_dwordx4 v230, s[32:35], s58 offen nt lds
    buffer_load_dwordx4 v231, s[32:35], s58 offen offset:1024 nt lds
    s_add_u32 s58, s58, 128
    s_cmp_ge_u32 s58, 1280
    s_cselect_b32 s58, 0, s58
    s_add_u32 m0, s61, 12288
    s_nop 0
    buffer_load_dwordx4 v230, s[32:35], s58 offen nt lds
    buffer_load_dwordx4 v231, s[32:35], s58 offen offset:1024 nt lds
    s_add_u32 s58, s58, 128
    s_cmp_ge_u32 s58, 1280
    s_cselect_b32 s58, 0, s58
    s_add_u32 m0, s61, 14336
    s_nop 0
    buffer_load_dwordx4 v230, s[32:35], s58 offen nt lds
    buffer_load_dwordx4 v231, s[32:35], s58 offen offset:1024 nt lds
    s_add_u32 s58, s58, 128
    s_cmp_ge_u32 s58, 1280
    s_cselect_b32 s58, 0, s58
    s_add_u32 m0, s61, 16384
    s_nop 0
    buffer_load_dwordx4 v230, s[32:35], s58 offen nt lds
    buffer_load_dwordx4 v231, s[32:35], s58 offen offset:1024 nt lds
    s_add_u32 s58, s58, 128
    s_cmp_ge_u32 s58, 1280
    s_cselect_b32 s58, 0, s58
    s_add_u32 m0, s61, 18432
    s_nop 0
    buffer_load_dwordx4 v230, s[32:35], s58 offen nt lds
    buffer_load_dwordx4 v231, s[32:35], s58 offen offset:1024 nt lds
    v_mov_b32 v25, 1
    s_mov_b64 exec, 1
    ds_add_u32 v4, v25 offset:56
    s_mov_b64 exec, -1
    s_mov_b32 s28, s24
    s_mov_b32 s29, s25
    s_mov_b32 s30, 26902528
    s_mov_b32 s31, 0x20000
    v_lshrrev_b32 v16, 4, v1
    v_and_b32 v17, 15, v1
    v_mov_b32 v14, 0
    v_and_b32 v6, 1, v1
    v_mul_u32_u24 v6, 260, v6
    v_add_u32 v6, 155008, v6
    s_lshl_b32 s58, s40, 8
    s_add_u32 s58, s58, 161792
    v_lshl_add_u32 v15, v1, 2, s58
    s_mul_i32 s55, s45, 115712
    s_add_u32 s55, s55, 9207808
    s_mul_i32 s56, s43, 2560
    s_add_u32 s56, s56, s55
    s_mul_i32 s57, s62, 5120
    s_add_u32 s57, s57, 128000
    v_add_u32 v24, s57, v3
    v_add_u32 v22, s57, v2
    v_add_u32 v23, s57, v3
    v_lshrrev_b32 v20, 1, v17
    v_xor_b32 v18, v20, v16
    v_xor_b32 v19, 4, v18
    v_lshlrev_b32 v21, 7, v17
    v_add_u32 v21, s61, v21
    v_lshl_add_u32 v18, v18, 4, v21
    v_lshl_add_u32 v19, v19, 4, v21
    v_lshrrev_b32 v232, 1, v16
    v_and_b32 v233, 1, v16
    v_lshl_add_u32 v233, v233, 3, v21
    s_mul_i32 s57, s43, 10
    s_add_u32 s57, s57, 0
    s_lshr_b32 s58, s57, 3
    s_and_b32 s57, s57, 7
    s_add_u32 s58, s58, 10
    s_sub_u32 s58, s58, s73
    s_sub_u32 s59, s58, 10
    s_cmp_ge_u32 s58, 10
    s_cselect_b32 s58, s59, s58
    s_lshl_b32 s58, s58, 11
    v_add_u32 v234, s57, v232
    v_xor_b32 v234, v234, v20
    v_lshl_add_u32 v234, v234, 4, v233
    v_add_u32 v234, s58, v234
    s_mul_i32 s57, s43, 10
    s_add_u32 s57, s57, 2
    s_lshr_b32 s58, s57, 3
    s_and_b32 s57, s57, 7
    s_add_u32 s58, s58, 10
    s_sub_u32 s58, s58, s73
    s_sub_u32 s59, s58, 10
    s_cmp_ge_u32 s58, 10
    s_cselect_b32 s58, s59, s58
    s_lshl_b32 s58, s58, 11
    v_add_u32 v235, s57, v232
    v_xor_b32 v235, v235, v20
    v_lshl_add_u32 v235, v235, 4, v233
    v_add_u32 v235, s58, v235
    s_mul_i32 s57, s43, 10
    s_add_u32 s57, s57, 4
    s_lshr_b32 s58, s57, 3
    s_and_b32 s57, s57, 7
    s_add_u32 s58, s58, 10
    s_sub_u32 s58, s58, s73
    s_sub_u32 s59, s58, 10
    s_cmp_ge_u32 s58, 10
    s_cselect_b32 s58, s59, s58
    s_lshl_b32 s58, s58, 11
    v_add_u32 v236, s57, v232
    v_xor_b32 v236, v236, v20
    v_lshl_add_u32 v236, v236, 4, v233
    v_add_u32 v236, s58, v236
    s_mul_i32 s57, s43, 10
    s_add_u32 s57, s57, 6
    s_lshr_b32 s58, s57, 3
    s_and_b32 s57, s57, 7
    s_add_u32 s58, s58, 10
    s_sub_u32 s58, s58, s73
    s_sub_u32 s59, s58, 10
    s_cmp_ge_u32 s58, 10
    s_cselect_b32 s58, s59, s58
    s_lshl_b32 s58, s58, 11
    v_add_u32 v237, s57, v232
    v_xor_b32 v237, v237, v20
    v_lshl_add_u32 v237, v237, 4, v233
    v_add_u32 v237, s58, v237
    s_mul_i32 s57, s43, 10
    s_add_u32 s57, s57, 8
    s_lshr_b32 s58, s57, 3
    s_and_b32 s57, s57, 7
    s_add_u32 s58, s58, 10
    s_sub_u32 s58, s58, s73
    s_sub_u32 s59, s58, 10
    s_cmp_ge_u32 s58, 10
    s_cselect_b32 s58, s59, s58
    s_lshl_b32 s58, s58, 11
    v_add_u32 v238, s57, v232
    v_xor_b32 v238, v238, v20
    v_lshl_add_u32 v238, v238, 4, v233
    v_add_u32 v238, s58, v238
    v_mov_b32 v240, 0
    v_mov_b32 v241, 0
    v_mov_b32 v242, 0
    v_mov_b32 v243, 0
    s_waitcnt vmcnt(18)
    ds_read_b128 v[64:67], v18 offset:0
    ds_read_b128 v[68:71], v19 offset:0
    s_waitcnt vmcnt(16)
    ds_read_b128 v[72:75], v18 offset:2048
    ds_read_b128 v[76:79], v19 offset:2048
    s_waitcnt vmcnt(14)
    ds_read_b128 v[80:83], v18 offset:4096
    ds_read_b128 v[84:87], v19 offset:4096
    s_waitcnt lgkmcnt(4)
    v_dot2c_f32_bf16 v240, s72, v64
    v_dot2c_f32_bf16 v241, v64, v64
    v_dot2c_f32_bf16 v242, s72, v65
    v_dot2c_f32_bf16 v243, v65, v65
    v_dot2c_f32_bf16 v240, s72, v66
    v_dot2c_f32_bf16 v241, v66, v66
    v_dot2c_f32_bf16 v242, s72, v67
    v_dot2c_f32_bf16 v243, v67, v67
    v_dot2c_f32_bf16 v240, s72, v68
    v_dot2c_f32_bf16 v241, v68, v68
    v_dot2c_f32_bf16 v242, s72, v69
    v_dot2c_f32_bf16 v243, v69, v69
    v_dot2c_f32_bf16 v240, s72, v70
    v_dot2c_f32_bf16 v241, v70, v70
    v_dot2c_f32_bf16 v242, s72, v71
    v_dot2c_f32_bf16 v243, v71, v71
    s_waitcnt vmcnt(12)
    ds_read_b128 v[88:91], v18 offset:6144
    ds_read_b128 v[92:95], v19 offset:6144
    s_waitcnt lgkmcnt(4)
    v_dot2c_f32_bf16 v240, s72, v72
    v_dot2c_f32_bf16 v241, v72, v72
    v_dot2c_f32_bf16 v242, s72, v73
    v_dot2c_f32_bf16 v243, v73, v73
    v_dot2c_f32_bf16 v240, s72, v74
    v_dot2c_f32_bf16 v241, v74, v74
    v_dot2c_f32_bf16 v242, s72, v75
    v_dot2c_f32_bf16 v243, v75, v75
    v_dot2c_f32_bf16 v240, s72, v76
    v_dot2c_f32_bf16 v241, v76, v76
    v_dot2c_f32_bf16 v242, s72, v77
    v_dot2c_f32_bf16 v243, v77, v77
    v_dot2c_f32_bf16 v240, s72, v78
    v_dot2c_f32_bf16 v241, v78, v78
    v_dot2c_f32_bf16 v242, s72, v79
    v_dot2c_f32_bf16 v243, v79, v79
    s_waitcnt vmcnt(10)
    ds_read_b128 v[96:99], v18 offset:8192
    ds_read_b128 v[100:103], v19 offset:8192
    s_waitcnt lgkmcnt(4)
    v_dot2c_f32_bf16 v240, s72, v80
    v_dot2c_f32_bf16 v241, v80, v80
    v_dot2c_f32_bf16 v242, s72, v81
    v_dot2c_f32_bf16 v243, v81, v81
    v_dot2c_f32_bf16 v240, s72, v82
    v_dot2c_f32_bf16 v241, v82, v82
    v_dot2c_f32_bf16 v242, s72, v83
    v_dot2c_f32_bf16 v243, v83, v83
    v_dot2c_f32_bf16 v240, s72, v84
    v_dot2c_f32_bf16 v241, v84, v84
    v_dot2c_f32_bf16 v242, s72, v85
    v_dot2c_f32_bf16 v243, v85, v85
    v_dot2c_f32_bf16 v240, s72, v86
    v_dot2c_f32_bf16 v241, v86, v86
    v_dot2c_f32_bf16 v242, s72, v87
    v_dot2c_f32_bf16 v243, v87, v87
    s_waitcnt vmcnt(8)
    ds_read_b128 v[104:107], v18 offset:10240
    ds_read_b128 v[108:111], v19 offset:10240
    s_waitcnt lgkmcnt(4)
    v_dot2c_f32_bf16 v240, s72, v88
    v_dot2c_f32_bf16 v241, v88, v88
    v_dot2c_f32_bf16 v242, s72, v89
    v_dot2c_f32_bf16 v243, v89, v89
    v_dot2c_f32_bf16 v240, s72, v90
    v_dot2c_f32_bf16 v241, v90, v90
    v_dot2c_f32_bf16 v242, s72, v91
    v_dot2c_f32_bf16 v243, v91, v91
    v_dot2c_f32_bf16 v240, s72, v92
    v_dot2c_f32_bf16 v241, v92, v92
    v_dot2c_f32_bf16 v242, s72, v93
    v_dot2c_f32_bf16 v243, v93, v93
    v_dot2c_f32_bf16 v240, s72, v94
    v_dot2c_f32_bf16 v241, v94, v94
    v_dot2c_f32_bf16 v242, s72, v95
    v_dot2c_f32_bf16 v243, v95, v95
    s_waitcnt vmcnt(6)
    ds_read_b128 v[112:115], v18 offset:12288
    ds_read_b128 v[116:119], v19 offset:12288
    s_waitcnt lgkmcnt(4)
    v_dot2c_f32_bf16 v240, s72, v96
    v_dot2c_f32_bf16 v241, v96, v96
    v_dot2c_f32_bf16 v242, s72, v97
    v_dot2c_f32_bf16 v243, v97, v97
    v_dot2c_f32_bf16 v240, s72, v98
    v_dot2c_f32_bf16 v241, v98, v98
    v_dot2c_f32_bf16 v242, s72, v99
    v_dot2c_f32_bf16 v243, v99, v99
    v_dot2c_f32_bf16 v240, s72, v100
    v_dot2c_f32_bf16 v241, v100, v100
    v_dot2c_f32_bf16 v242, s72, v101
    v_dot2c_f32_bf16 v243, v101, v101
    v_dot2c_f32_bf16 v240, s72, v102
    v_dot2c_f32_bf16 v241, v102, v102
    v_dot2c_f32_bf16 v242, s72, v103
    v_dot2c_f32_bf16 v243, v103, v103
    s_waitcnt vmcnt(4)
    ds_read_b128 v[120:123], v18 offset:14336
    ds_read_b128 v[124:127], v19 offset:14336
    s_waitcnt lgkmcnt(4)
    v_dot2c_f32_bf16 v240, s72, v104
    v_dot2c_f32_bf16 v241, v104, v104
    v_dot2c_f32_bf16 v242, s72, v105
    v_dot2c_f32_bf16 v243, v105, v105
    v_dot2c_f32_bf16 v240, s72, v106
    v_dot2c_f32_bf16 v241, v106, v106
    v_dot2c_f32_bf16 v242, s72, v107
    v_dot2c_f32_bf16 v243, v107, v107
    v_dot2c_f32_bf16 v240, s72, v108
    v_dot2c_f32_bf16 v241, v108, v108
    v_dot2c_f32_bf16 v242, s72, v109
    v_dot2c_f32_bf16 v243, v109, v109
    v_dot2c_f32_bf16 v240, s72, v110
    v_dot2c_f32_bf16 v241, v110, v110
    v_dot2c_f32_bf16 v242, s72, v111
    v_dot2c_f32_bf16 v243, v111, v111
    s_waitcnt vmcnt(2)
    ds_read_b128 v[128:131], v18 offset:16384
    ds_read_b128 v[132:135], v19 offset:16384
    s_waitcnt lgkmcnt(4)
    v_dot2c_f32_bf16 v240, s72, v112
    v_dot2c_f32_bf16 v241, v112, v112
    v_dot2c_f32_bf16 v242, s72, v113
    v_dot2c_f32_bf16 v243, v113, v113
    v_dot2c_f32_bf16 v240, s72, v114
    v_dot2c_f32_bf16 v241, v114, v114
    v_dot2c_f32_bf16 v242, s72, v115
    v_dot2c_f32_bf16 v243, v115, v115
    v_dot2c_f32_bf16 v240, s72, v116
    v_dot2c_f32_bf16 v241, v116, v116
    v_dot2c_f32_bf16 v242, s72, v117
    v_dot2c_f32_bf16 v243, v117, v117
    v_dot2c_f32_bf16 v240, s72, v118
    v_dot2c_f32_bf16 v241, v118, v118
    v_dot2c_f32_bf16 v242, s72, v119
    v_dot2c_f32_bf16 v243, v119, v119
    s_waitcnt vmcnt(0)
    ds_read_b128 v[136:139], v18 offset:18432
    ds_read_b128 v[140:143], v19 offset:18432
    s_waitcnt lgkmcnt(4)
    v_dot2c_f32_bf16 v240, s72, v120
    v_dot2c_f32_bf16 v241, v120, v120
    v_dot2c_f32_bf16 v242, s72, v121
    v_dot2c_f32_bf16 v243, v121, v121
    v_dot2c_f32_bf16 v240, s72, v122
    v_dot2c_f32_bf16 v241, v122, v122
    v_dot2c_f32_bf16 v242, s72, v123
    v_dot2c_f32_bf16 v243, v123, v123
    v_dot2c_f32_bf16 v240, s72, v124
    v_dot2c_f32_bf16 v241, v124, v124
    v_dot2c_f32_bf16 v242, s72, v125
    v_dot2c_f32_bf16 v243, v125, v125
    v_dot2c_f32_bf16 v240, s72, v126
    v_dot2c_f32_bf16 v241, v126, v126
    v_dot2c_f32_bf16 v242, s72, v127
    v_dot2c_f32_bf16 v243, v127, v127
    ds_read_b64 v[218:219], v234
    ds_read_b64 v[220:221], v235
    ds_read_b64 v[222:223], v236
    ds_read_b64 v[224:225], v237
    ds_read_b64 v[226:227], v238
    v_mov_b32 v8, 1
    ds_write_b32 v15, v8
    s_waitcnt lgkmcnt(8)
    v_dot2c_f32_bf16 v240, s72, v128
    v_dot2c_f32_bf16 v241, v128, v128
    v_dot2c_f32_bf16 v242, s72, v129
    v_dot2c_f32_bf16 v243, v129, v129
    v_dot2c_f32_bf16 v240, s72, v130
    v_dot2c_f32_bf16 v241, v130, v130
    v_dot2c_f32_bf16 v242, s72, v131
    v_dot2c_f32_bf16 v243, v131, v131
    v_dot2c_f32_bf16 v240, s72, v132
    v_dot2c_f32_bf16 v241, v132, v132
    v_dot2c_f32_bf16 v242, s72, v133
    v_dot2c_f32_bf16 v243, v133, v133
    v_dot2c_f32_bf16 v240, s72, v134
    v_dot2c_f32_bf16 v241, v134, v134
    v_dot2c_f32_bf16 v242, s72, v135
    v_dot2c_f32_bf16 v243, v135, v135
    s_waitcnt lgkmcnt(6)
    v_dot2c_f32_bf16 v240, s72, v136
    v_dot2c_f32_bf16 v241, v136, v136
    v_dot2c_f32_bf16 v242, s72, v137
    v_dot2c_f32_bf16 v243, v137, v137
    v_dot2c_f32_bf16 v240, s72, v138
    v_dot2c_f32_bf16 v241, v138, v138
    v_dot2c_f32_bf16 v242, s72, v139
    v_dot2c_f32_bf16 v243, v139, v139
    v_dot2c_f32_bf16 v240, s72, v140
    v_dot2c_f32_bf16 v241, v140, v140
    v_dot2c_f32_bf16 v242, s72, v141
    v_dot2c_f32_bf16 v243, v141, v141
    v_dot2c_f32_bf16 v240, s72, v142
    v_dot2c_f32_bf16 v241, v142, v142
    v_dot2c_f32_bf16 v242, s72, v143
    v_dot2c_f32_bf16 v243, v143, v143
    s_nop 1
    v_add_f32 v240, v240, v242
    v_add_f32 v241, v241, v243
    s_nop 1
    v_permlane32_swap_b32 v240, v241
    v_add_f32 v240, v240, v241
    v_mov_b32 v241, v240
    s_nop 1
    v_permlane16_swap_b32 v240, v241
    v_add_f32 v240, v240, v241
    v_mov_b32 v241, v240
    s_nop 1
    v_permlane32_swap_b32 v240, v241
    v_mul_f32 v240, 0x3acccccd, v240
    v_mul_f32 v241, 0x3acccccd, v241
    v_fma_f32 v241, -v240, v240, v241
    v_max_f32 v241, 0, v241
    v_add_f32 v241, 0x3727c5ac, v241
    v_rsq_f32 v252, v241
    s_nop 0
    v_mul_f32_e64 v253, -v240, v252
    s_mov_b32 s60, 0xffff0000
    v_lshlrev_b32 v244, 16, v64
    v_and_b32 v245, s60, v64
    v_lshlrev_b32 v246, 16, v65
    v_and_b32 v247, s60, v65
    v_lshlrev_b32 v248, 16, v66
    v_and_b32 v249, s60, v66
    v_lshlrev_b32 v250, 16, v67
    v_and_b32 v251, s60, v67
    v_fma_f32 v244, v244, v252, v253
    v_fma_f32 v245, v245, v252, v253
    v_fma_f32 v246, v246, v252, v253
    v_fma_f32 v247, v247, v252, v253
    v_fma_f32 v248, v248, v252, v253
    v_fma_f32 v249, v249, v252, v253
    v_fma_f32 v250, v250, v252, v253
    v_fma_f32 v251, v251, v252, v253
    v_cvt_pk_bf16_f32 v64, v244, v245
    v_cvt_pk_bf16_f32 v65, v246, v247
    v_cvt_pk_bf16_f32 v66, v248, v249
    v_cvt_pk_bf16_f32 v67, v250, v251
    v_lshlrev_b32 v244, 16, v68
    v_and_b32 v245, s60, v68
    v_lshlrev_b32 v246, 16, v69
    v_and_b32 v247, s60, v69
    v_lshlrev_b32 v248, 16, v70
    v_and_b32 v249, s60, v70
    v_lshlrev_b32 v250, 16, v71
    v_and_b32 v251, s60, v71
    v_fma_f32 v244, v244, v252, v253
    v_fma_f32 v245, v245, v252, v253
    v_fma_f32 v246, v246, v252, v253
    v_fma_f32 v247, v247, v252, v253
    v_fma_f32 v248, v248, v252, v253
    v_fma_f32 v249, v249, v252, v253
    v_fma_f32 v250, v250, v252, v253
    v_fma_f32 v251, v251, v252, v253
    v_cvt_pk_bf16_f32 v68, v244, v245
    v_cvt_pk_bf16_f32 v69, v246, v247
    v_cvt_pk_bf16_f32 v70, v248, v249
    v_cvt_pk_bf16_f32 v71, v250, v251
    v_lshlrev_b32 v244, 16, v72
    v_and_b32 v245, s60, v72
    v_lshlrev_b32 v246, 16, v73
    v_and_b32 v247, s60, v73
    v_lshlrev_b32 v248, 16, v74
    v_and_b32 v249, s60, v74
    v_lshlrev_b32 v250, 16, v75
    v_and_b32 v251, s60, v75
    v_fma_f32 v244, v244, v252, v253
    v_fma_f32 v245, v245, v252, v253
    v_fma_f32 v246, v246, v252, v253
    v_fma_f32 v247, v247, v252, v253
    v_fma_f32 v248, v248, v252, v253
    v_fma_f32 v249, v249, v252, v253
    v_fma_f32 v250, v250, v252, v253
    v_fma_f32 v251, v251, v252, v253
    v_cvt_pk_bf16_f32 v72, v244, v245
    v_cvt_pk_bf16_f32 v73, v246, v247
    v_cvt_pk_bf16_f32 v74, v248, v249
    v_cvt_pk_bf16_f32 v75, v250, v251
    v_lshlrev_b32 v244, 16, v76
    v_and_b32 v245, s60, v76
    v_lshlrev_b32 v246, 16, v77
    v_and_b32 v247, s60, v77
    v_lshlrev_b32 v248, 16, v78
    v_and_b32 v249, s60, v78
    v_lshlrev_b32 v250, 16, v79
    v_and_b32 v251, s60, v79
    v_fma_f32 v244, v244, v252, v253
    v_fma_f32 v245, v245, v252, v253
    v_fma_f32 v246, v246, v252, v253
    v_fma_f32 v247, v247, v252, v253
    v_fma_f32 v248, v248, v252, v253
    v_fma_f32 v249, v249, v252, v253
    v_fma_f32 v250, v250, v252, v253
    v_fma_f32 v251, v251, v252, v253
    v_cvt_pk_bf16_f32 v76, v244, v245
    v_cvt_pk_bf16_f32 v77, v246, v247
    v_cvt_pk_bf16_f32 v78, v248, v249
    v_cvt_pk_bf16_f32 v79, v250, v251
    v_lshlrev_b32 v244, 16, v80
    v_and_b32 v245, s60, v80
    v_lshlrev_b32 v246, 16, v81
    v_and_b32 v247, s60, v81
    v_lshlrev_b32 v248, 16, v82
    v_and_b32 v249, s60, v82
    v_lshlrev_b32 v250, 16, v83
    v_and_b32 v251, s60, v83
    v_fma_f32 v244, v244, v252, v253
    v_fma_f32 v245, v245, v252, v253
    v_fma_f32 v246, v246, v252, v253
    v_fma_f32 v247, v247, v252, v253
    v_fma_f32 v248, v248, v252, v253
    v_fma_f32 v249, v249, v252, v253
    v_fma_f32 v250, v250, v252, v253
    v_fma_f32 v251, v251, v252, v253
    v_cvt_pk_bf16_f32 v80, v244, v245
    v_cvt_pk_bf16_f32 v81, v246, v247
    v_cvt_pk_bf16_f32 v82, v248, v249
    v_cvt_pk_bf16_f32 v83, v250, v251
    v_lshlrev_b32 v244, 16, v84
    v_and_b32 v245, s60, v84
    v_lshlrev_b32 v246, 16, v85
    v_and_b32 v247, s60, v85
    v_lshlrev_b32 v248, 16, v86
    v_and_b32 v249, s60, v86
    v_lshlrev_b32 v250, 16, v87
    v_and_b32 v251, s60, v87
    v_fma_f32 v244, v244, v252, v253
    v_fma_f32 v245, v245, v252, v253
    v_fma_f32 v246, v246, v252, v253
    v_fma_f32 v247, v247, v252, v253
    v_fma_f32 v248, v248, v252, v253
    v_fma_f32 v249, v249, v252, v253
    v_fma_f32 v250, v250, v252, v253
    v_fma_f32 v251, v251, v252, v253
    v_cvt_pk_bf16_f32 v84, v244, v245
    v_cvt_pk_bf16_f32 v85, v246, v247
    v_cvt_pk_bf16_f32 v86, v248, v249
    v_cvt_pk_bf16_f32 v87, v250, v251
    v_lshlrev_b32 v244, 16, v88
    v_and_b32 v245, s60, v88
    v_lshlrev_b32 v246, 16, v89
    v_and_b32 v247, s60, v89
    v_lshlrev_b32 v248, 16, v90
    v_and_b32 v249, s60, v90
    v_lshlrev_b32 v250, 16, v91
    v_and_b32 v251, s60, v91
    v_fma_f32 v244, v244, v252, v253
    v_fma_f32 v245, v245, v252, v253
    v_fma_f32 v246, v246, v252, v253
    v_fma_f32 v247, v247, v252, v253
    v_fma_f32 v248, v248, v252, v253
    v_fma_f32 v249, v249, v252, v253
    v_fma_f32 v250, v250, v252, v253
    v_fma_f32 v251, v251, v252, v253
    v_cvt_pk_bf16_f32 v88, v244, v245
    v_cvt_pk_bf16_f32 v89, v246, v247
    v_cvt_pk_bf16_f32 v90, v248, v249
    v_cvt_pk_bf16_f32 v91, v250, v251
    v_lshlrev_b32 v244, 16, v92
    v_and_b32 v245, s60, v92
    v_lshlrev_b32 v246, 16, v93
    v_and_b32 v247, s60, v93
    v_lshlrev_b32 v248, 16, v94
    v_and_b32 v249, s60, v94
    v_lshlrev_b32 v250, 16, v95
    v_and_b32 v251, s60, v95
    v_fma_f32 v244, v244, v252, v253
    v_fma_f32 v245, v245, v252, v253
    v_fma_f32 v246, v246, v252, v253
    v_fma_f32 v247, v247, v252, v253
    v_fma_f32 v248, v248, v252, v253
    v_fma_f32 v249, v249, v252, v253
    v_fma_f32 v250, v250, v252, v253
    v_fma_f32 v251, v251, v252, v253
    v_cvt_pk_bf16_f32 v92, v244, v245
    v_cvt_pk_bf16_f32 v93, v246, v247
    v_cvt_pk_bf16_f32 v94, v248, v249
    v_cvt_pk_bf16_f32 v95, v250, v251
    v_lshlrev_b32 v244, 16, v96
    v_and_b32 v245, s60, v96
    v_lshlrev_b32 v246, 16, v97
    v_and_b32 v247, s60, v97
    v_lshlrev_b32 v248, 16, v98
    v_and_b32 v249, s60, v98
    v_lshlrev_b32 v250, 16, v99
    v_and_b32 v251, s60, v99
    v_fma_f32 v244, v244, v252, v253
    v_fma_f32 v245, v245, v252, v253
    v_fma_f32 v246, v246, v252, v253
    v_fma_f32 v247, v247, v252, v253
    v_fma_f32 v248, v248, v252, v253
    v_fma_f32 v249, v249, v252, v253
    v_fma_f32 v250, v250, v252, v253
    v_fma_f32 v251, v251, v252, v253
    v_cvt_pk_bf16_f32 v96, v244, v245
    v_cvt_pk_bf16_f32 v97, v246, v247
    v_cvt_pk_bf16_f32 v98, v248, v249
    v_cvt_pk_bf16_f32 v99, v250, v251
    v_lshlrev_b32 v244, 16, v100
    v_and_b32 v245, s60, v100
    v_lshlrev_b32 v246, 16, v101
    v_and_b32 v247, s60, v101
    v_lshlrev_b32 v248, 16, v102
    v_and_b32 v249, s60, v102
    v_lshlrev_b32 v250, 16, v103
    v_and_b32 v251, s60, v103
    v_fma_f32 v244, v244, v252, v253
    v_fma_f32 v245, v245, v252, v253
    v_fma_f32 v246, v246, v252, v253
    v_fma_f32 v247, v247, v252, v253
    v_fma_f32 v248, v248, v252, v253
    v_fma_f32 v249, v249, v252, v253
    v_fma_f32 v250, v250, v252, v253
    v_fma_f32 v251, v251, v252, v253
    v_cvt_pk_bf16_f32 v100, v244, v245
    v_cvt_pk_bf16_f32 v101, v246, v247
    v_cvt_pk_bf16_f32 v102, v248, v249
    v_cvt_pk_bf16_f32 v103, v250, v251
    v_lshlrev_b32 v244, 16, v104
    v_and_b32 v245, s60, v104
    v_lshlrev_b32 v246, 16, v105
    v_and_b32 v247, s60, v105
    v_lshlrev_b32 v248, 16, v106
    v_and_b32 v249, s60, v106
    v_lshlrev_b32 v250, 16, v107
    v_and_b32 v251, s60, v107
    v_fma_f32 v244, v244, v252, v253
    v_fma_f32 v245, v245, v252, v253
    v_fma_f32 v246, v246, v252, v253
    v_fma_f32 v247, v247, v252, v253
    v_fma_f32 v248, v248, v252, v253
    v_fma_f32 v249, v249, v252, v253
    v_fma_f32 v250, v250, v252, v253
    v_fma_f32 v251, v251, v252, v253
    v_cvt_pk_bf16_f32 v104, v244, v245
    v_cvt_pk_bf16_f32 v105, v246, v247
    v_cvt_pk_bf16_f32 v106, v248, v249
    v_cvt_pk_bf16_f32 v107, v250, v251
    v_lshlrev_b32 v244, 16, v108
    v_and_b32 v245, s60, v108
    v_lshlrev_b32 v246, 16, v109
    v_and_b32 v247, s60, v109
    v_lshlrev_b32 v248, 16, v110
    v_and_b32 v249, s60, v110
    v_lshlrev_b32 v250, 16, v111
    v_and_b32 v251, s60, v111
    v_fma_f32 v244, v244, v252, v253
    v_fma_f32 v245, v245, v252, v253
    v_fma_f32 v246, v246, v252, v253
    v_fma_f32 v247, v247, v252, v253
    v_fma_f32 v248, v248, v252, v253
    v_fma_f32 v249, v249, v252, v253
    v_fma_f32 v250, v250, v252, v253
    v_fma_f32 v251, v251, v252, v253
    v_cvt_pk_bf16_f32 v108, v244, v245
    v_cvt_pk_bf16_f32 v109, v246, v247
    v_cvt_pk_bf16_f32 v110, v248, v249
    v_cvt_pk_bf16_f32 v111, v250, v251
    v_lshlrev_b32 v244, 16, v112
    v_and_b32 v245, s60, v112
    v_lshlrev_b32 v246, 16, v113
    v_and_b32 v247, s60, v113
    v_lshlrev_b32 v248, 16, v114
    v_and_b32 v249, s60, v114
    v_lshlrev_b32 v250, 16, v115
    v_and_b32 v251, s60, v115
    v_fma_f32 v244, v244, v252, v253
    v_fma_f32 v245, v245, v252, v253
    v_fma_f32 v246, v246, v252, v253
    v_fma_f32 v247, v247, v252, v253
    v_fma_f32 v248, v248, v252, v253
    v_fma_f32 v249, v249, v252, v253
    v_fma_f32 v250, v250, v252, v253
    v_fma_f32 v251, v251, v252, v253
    v_cvt_pk_bf16_f32 v112, v244, v245
    v_cvt_pk_bf16_f32 v113, v246, v247
    v_cvt_pk_bf16_f32 v114, v248, v249
    v_cvt_pk_bf16_f32 v115, v250, v251
    v_lshlrev_b32 v244, 16, v116
    v_and_b32 v245, s60, v116
    v_lshlrev_b32 v246, 16, v117
    v_and_b32 v247, s60, v117
    v_lshlrev_b32 v248, 16, v118
    v_and_b32 v249, s60, v118
    v_lshlrev_b32 v250, 16, v119
    v_and_b32 v251, s60, v119
    v_fma_f32 v244, v244, v252, v253
    v_fma_f32 v245, v245, v252, v253
    v_fma_f32 v246, v246, v252, v253
    v_fma_f32 v247, v247, v252, v253
    v_fma_f32 v248, v248, v252, v253
    v_fma_f32 v249, v249, v252, v253
    v_fma_f32 v250, v250, v252, v253
    v_fma_f32 v251, v251, v252, v253
    v_cvt_pk_bf16_f32 v116, v244, v245
    v_cvt_pk_bf16_f32 v117, v246, v247
    v_cvt_pk_bf16_f32 v118, v248, v249
    v_cvt_pk_bf16_f32 v119, v250, v251
    v_lshlrev_b32 v244, 16, v120
    v_and_b32 v245, s60, v120
    v_lshlrev_b32 v246, 16, v121
    v_and_b32 v247, s60, v121
    v_lshlrev_b32 v248, 16, v122
    v_and_b32 v249, s60, v122
    v_lshlrev_b32 v250, 16, v123
    v_and_b32 v251, s60, v123
    v_fma_f32 v244, v244, v252, v253
    v_fma_f32 v245, v245, v252, v253
    v_fma_f32 v246, v246, v252, v253
    v_fma_f32 v247, v247, v252, v253
    v_fma_f32 v248, v248, v252, v253
    v_fma_f32 v249, v249, v252, v253
    v_fma_f32 v250, v250, v252, v253
    v_fma_f32 v251, v251, v252, v253
    v_cvt_pk_bf16_f32 v120, v244, v245
    v_cvt_pk_bf16_f32 v121, v246, v247
    v_cvt_pk_bf16_f32 v122, v248, v249
    v_cvt_pk_bf16_f32 v123, v250, v251
    v_lshlrev_b32 v244, 16, v124
    v_and_b32 v245, s60, v124
    v_lshlrev_b32 v246, 16, v125
    v_and_b32 v247, s60, v125
    v_lshlrev_b32 v248, 16, v126
    v_and_b32 v249, s60, v126
    v_lshlrev_b32 v250, 16, v127
    v_and_b32 v251, s60, v127
    v_fma_f32 v244, v244, v252, v253
    v_fma_f32 v245, v245, v252, v253
    v_fma_f32 v246, v246, v252, v253
    v_fma_f32 v247, v247, v252, v253
    v_fma_f32 v248, v248, v252, v253
    v_fma_f32 v249, v249, v252, v253
    v_fma_f32 v250, v250, v252, v253
    v_fma_f32 v251, v251, v252, v253
    v_cvt_pk_bf16_f32 v124, v244, v245
    v_cvt_pk_bf16_f32 v125, v246, v247
    v_cvt_pk_bf16_f32 v126, v248, v249
    v_cvt_pk_bf16_f32 v127, v250, v251
    v_lshlrev_b32 v244, 16, v128
    v_and_b32 v245, s60, v128
    v_lshlrev_b32 v246, 16, v129
    v_and_b32 v247, s60, v129
    v_lshlrev_b32 v248, 16, v130
    v_and_b32 v249, s60, v130
    v_lshlrev_b32 v250, 16, v131
    v_and_b32 v251, s60, v131
    v_fma_f32 v244, v244, v252, v253
    v_fma_f32 v245, v245, v252, v253
    v_fma_f32 v246, v246, v252, v253
    v_fma_f32 v247, v247, v252, v253
    v_fma_f32 v248, v248, v252, v253
    v_fma_f32 v249, v249, v252, v253
    v_fma_f32 v250, v250, v252, v253
    v_fma_f32 v251, v251, v252, v253
    v_cvt_pk_bf16_f32 v128, v244, v245
    v_cvt_pk_bf16_f32 v129, v246, v247
    v_cvt_pk_bf16_f32 v130, v248, v249
    v_cvt_pk_bf16_f32 v131, v250, v251
    v_lshlrev_b32 v244, 16, v132
    v_and_b32 v245, s60, v132
    v_lshlrev_b32 v246, 16, v133
    v_and_b32 v247, s60, v133
    v_lshlrev_b32 v248, 16, v134
    v_and_b32 v249, s60, v134
    v_lshlrev_b32 v250, 16, v135
    v_and_b32 v251, s60, v135
    v_fma_f32 v244, v244, v252, v253
    v_fma_f32 v245, v245, v252, v253
    v_fma_f32 v246, v246, v252, v253
    v_fma_f32 v247, v247, v252, v253
    v_fma_f32 v248, v248, v252, v253
    v_fma_f32 v249, v249, v252, v253
    v_fma_f32 v250, v250, v252, v253
    v_fma_f32 v251, v251, v252, v253
    v_cvt_pk_bf16_f32 v132, v244, v245
    v_cvt_pk_bf16_f32 v133, v246, v247
    v_cvt_pk_bf16_f32 v134, v248, v249
    v_cvt_pk_bf16_f32 v135, v250, v251
    v_lshlrev_b32 v244, 16, v136
    v_and_b32 v245, s60, v136
    v_lshlrev_b32 v246, 16, v137
    v_and_b32 v247, s60, v137
    v_lshlrev_b32 v248, 16, v138
    v_and_b32 v249, s60, v138
    v_lshlrev_b32 v250, 16, v139
    v_and_b32 v251, s60, v139
    v_fma_f32 v244, v244, v252, v253
    v_fma_f32 v245, v245, v252, v253
    v_fma_f32 v246, v246, v252, v253
    v_fma_f32 v247, v247, v252, v253
    v_fma_f32 v248, v248, v252, v253
    v_fma_f32 v249, v249, v252, v253
    v_fma_f32 v250, v250, v252, v253
    v_fma_f32 v251, v251, v252, v253
    v_cvt_pk_bf16_f32 v136, v244, v245
    v_cvt_pk_bf16_f32 v137, v246, v247
    v_cvt_pk_bf16_f32 v138, v248, v249
    v_cvt_pk_bf16_f32 v139, v250, v251
    v_lshlrev_b32 v244, 16, v140
    v_and_b32 v245, s60, v140
    v_lshlrev_b32 v246, 16, v141
    v_and_b32 v247, s60, v141
    v_lshlrev_b32 v248, 16, v142
    v_and_b32 v249, s60, v142
    v_lshlrev_b32 v250, 16, v143
    v_and_b32 v251, s60, v143
    v_fma_f32 v244, v244, v252, v253
    v_fma_f32 v245, v245, v252, v253
    v_fma_f32 v246, v246, v252, v253
    v_fma_f32 v247, v247, v252, v253
    v_fma_f32 v248, v248, v252, v253
    v_fma_f32 v249, v249, v252, v253
    v_fma_f32 v250, v250, v252, v253
    v_fma_f32 v251, v251, v252, v253
    v_cvt_pk_bf16_f32 v140, v244, v245
    v_cvt_pk_bf16_f32 v141, v246, v247
    v_cvt_pk_bf16_f32 v142, v248, v249
    v_cvt_pk_bf16_f32 v143, v250, v251
    v_add_u32 v5, 0x10000, v2
    v_add_u32 v9, 0x20000, v2
    v_lshrrev_b32 v216, 1, v16
    v_lshlrev_b32 v216, 4, v216
    v_and_b32 v217, 1, v16
    v_lshl_add_u32 v216, v217, 2, v216
    v_lshrrev_b32 v217, 2, v17
    v_add_u32 v216, v216, v217
    v_mul_u32_u24 v216, 160, v216
    v_and_b32 v217, 3, v1
    v_lshl_add_u32 v216, v217, 3, v216
    v_add_u32 v217, 0xf000, v216
    v_and_b32 v26, 1, v17
    v_cmp_eq_u32 s[68:69], 1, v26
    v_lshl_add_u32 v26, v16, 2, v26
    v_cmp_le_u32 s[64:65], v26, v17
    v_add_u32 v26, 2, v26
    v_cmp_le_u32 s[66:67], v26, v17
    v_mov_b32 v26, 0xffff
    v_mov_b32 v25, 0xffff0000
    v_cndmask_b32 v26, v26, v25, s[68:69]
    v_cndmask_b32 v248, 0, v26, s[64:65]
    v_cndmask_b32 v249, 0, v26, s[66:67]
    v_xor_b32 v250, v248, v26
    v_xor_b32 v251, v249, v26
    s_cmp_eq_u32 s45, 0
    s_cselect_b32 s58, 0xf149f2ca, 0
    s_waitcnt vmcnt(0)
    v_mov_b32 v252, s58
    v_mov_b32 v253, s58
    v_mov_b32 v254, s58
    v_mov_b32 v255, s58
    v_cmp_le_u32 s[8:9], 1, v16
    v_cmp_le_u32 s[10:11], 2, v16
    v_cmp_le_u32 s[12:13], 3, v16
    s_lshl_b32 s58, s40, 8
    s_add_u32 s58, s58, 162560
    s_cmp_eq_u32 s40, 0
    s_cselect_b32 s58, 153664, s58
    v_mov_b32 v18, s58
    v_add_u32 v27, 1024, v15
    v_subrev_u32 v19, 5120, v22
    v_subrev_u32 v21, 5120, v24
    v_mov_b32 v10, 1
    v_mov_b32 v11, 2
Ltg_3:
    ds_read_b64 v[12:13], v4 offset:48
    s_waitcnt lgkmcnt(0)
    v_cmp_gt_u32 vcc, 1, v13
    s_cbranch_vccz Ltg_3_ok
    s_sleep 1
    s_cmp_eq_u32 s46, 0
    s_cbranch_scc1 Ltg_3_ok
    s_sub_u32 s46, s46, 1
    s_branch Ltg_3
Ltg_3_ok:
    v_readfirstlane_b32 s48, v12
    s_mul_i32 s49, s48, 0x9E3779B1
    s_xor_b32 s49, s49, 0x7F4A7C15
    v_mov_b32 v13, s49
    v_mov_b32 v230, s48
    v_mov_b32 v231, s49
    v_mov_b32 v234, s48
    v_mov_b32 v235, s49
    v_mov_b32 v238, s48
    v_mov_b32 v239, s49
    v_mov_b32 v242, s48
    v_mov_b32 v243, s49
    v_mov_b32 v246, s48
    v_mov_b32 v247, s49
    s_lshl_b32 s57, s44, 3
    s_add_u32 s57, s57, s43
    s_mul_i32 s57, s57, 10240
    s_add_u32 s4, s57, 24018944
    s_sub_u32 s57, s4, 81920
    s_cmp_eq_u32 s40, 0
    s_cselect_b32 s4, s57, s4
Lsp_4:
    ds_read_b32 v7, v6 offset:0
    s_waitcnt lgkmcnt(0)
    v_cmp_gt_u32 vcc, 2, v7
    s_cbranch_vccz Lsp_4_ok
    s_cmp_eq_u32 s46, 0
    s_cbranch_scc1 Lsp_4_ok
    s_sub_u32 s46, s46, 1
    s_branch Lsp_4
Lsp_4_ok:
    ds_read_b128 v[144:147], v2 offset:0
    ds_read_b128 v[148:151], v2 offset:1024
    ds_read_b128 v[152:155], v2 offset:2048
    ds_read_b128 v[156:159], v2 offset:3072
    ds_read_b128 v[160:163], v2 offset:4096
    ds_read_b128 v[164:167], v2 offset:5120
    ds_read_b128 v[168:171], v2 offset:6144
    ds_read_b128 v[172:175], v2 offset:7168
    ds_read_b128 v[48:51], v2 offset:8192
    ds_read_b128 v[52:55], v2 offset:9216
    ds_read_b128 v[56:59], v2 offset:10240
    ds_read_b128 v[60:63], v2 offset:11264
    s_waitcnt lgkmcnt(8)
    v_mfma_f32_16x16x32_bf16 v[176:179], v[144:147], v[64:67], 0
    ds_read_b128 v[144:147], v2 offset:12288
    ds_read_b32 v7, v6
    v_mfma_f32_16x16x32_bf16 v[180:183], v[148:151], v[64:67], 0
    ds_read_b128 v[148:151], v2 offset:13312
    v_mfma_f32_16x16x32_bf16 v[184:187], v[152:155], v[64:67], 0
    ds_read_b128 v[152:155], v2 offset:14336
    v_mfma_f32_16x16x32_bf16 v[188:191], v[156:159], v[64:67], 0
    ds_read_b128 v[156:159], v2 offset:15360
    s_waitcnt lgkmcnt(9)
    v_mfma_f32_16x16x32_bf16 v[192:195], v[160:163], v[64:67], 0
    ds_read_b128 v[160:163], v2 offset:16384
    v_mfma_f32_16x16x32_bf16 v[176:179], v[164:167], v[68:71], v[176:179]
    ds_read_b128 v[164:167], v2 offset:17408
    v_mfma_f32_16x16x32_bf16 v[180:183], v[168:171], v[68:71], v[180:183]
    ds_read_b128 v[168:171], v2 offset:18432
    s_waitcnt lgkmcnt(6)
    v_cmp_gt_u32 s[22:23], 3, v7
    v_mfma_f32_16x16x32_bf16 v[184:187], v[172:175], v[68:71], v[184:187]
    ds_read_b128 v[172:175], v2 offset:19456
    v_mov_b32 v8, 2
    v_mfma_f32_16x16x32_bf16 v[188:191], v[48:51], v[68:71], v[188:191]
    s_cmp_lg_u64 s[22:23], 0
    s_cbranch_scc1 Lw_5
Lw_5_ok:
    ds_read_b128 v[48:51], v2 offset:20480
    ds_write_b32 v15, v8
    v_mfma_f32_16x16x32_bf16 v[192:195], v[52:55], v[68:71], v[192:195]
    ds_read_b128 v[52:55], v2 offset:21504
    v_mfma_f32_16x16x32_bf16 v[176:179], v[56:59], v[72:75], v[176:179]
    ds_read_b128 v[56:59], v2 offset:22528
    v_mfma_f32_16x16x32_bf16 v[180:183], v[60:63], v[72:75], v[180:183]
    ds_read_b128 v[60:63], v2 offset:23552
    s_waitcnt lgkmcnt(9)
    v_mfma_f32_16x16x32_bf16 v[184:187], v[144:147], v[72:75], v[184:187]
    ds_read_b128 v[144:147], v2 offset:24576
    v_mfma_f32_16x16x32_bf16 v[188:191], v[148:151], v[72:75], v[188:191]
    ds_read_b128 v[148:151], v2 offset:25600
    v_mfma_f32_16x16x32_bf16 v[192:195], v[152:155], v[72:75], v[192:195]
    ds_read_b128 v[152:155], v2 offset:26624
    v_mfma_f32_16x16x32_bf16 v[176:179], v[156:159], v[76:79], v[176:179]
    ds_read_b128 v[156:159], v2 offset:27648
    s_waitcnt lgkmcnt(9)
    v_mfma_f32_16x16x32_bf16 v[180:183], v[160:163], v[76:79], v[180:183]
    ds_read_b128 v[160:163], v2 offset:28672
    v_mfma_f32_16x16x32_bf16 v[184:187], v[164:167], v[76:79], v[184:187]
    ds_read_b128 v[164:167], v2 offset:29696
    v_mfma_f32_16x16x32_bf16 v[188:191], v[168:171], v[76:79], v[188:191]
    ds_read_b128 v[168:171], v2 offset:30720
    v_mfma_f32_16x16x32_bf16 v[192:195], v[172:175], v[76:79], v[192:195]
    ds_read_b128 v[172:175], v2 offset:31744
    ds_read_b32 v7, v6
    s_waitcnt lgkmcnt(9)
    v_mfma_f32_16x16x32_bf16 v[176:179], v[48:51], v[80:83], v[176:179]
    ds_read_b128 v[48:51], v2 offset:32768
    v_mfma_f32_16x16x32_bf16 v[180:183], v[52:55], v[80:83], v[180:183]
    ds_read_b128 v[52:55], v2 offset:33792
    v_mfma_f32_16x16x32_bf16 v[184:187], v[56:59], v[80:83], v[184:187]
    ds_read_b128 v[56:59], v2 offset:34816
    v_mfma_f32_16x16x32_bf16 v[188:191], v[60:63], v[80:83], v[188:191]
    ds_read_b128 v[60:63], v2 offset:35840
    s_waitcnt lgkmcnt(9)
    v_mfma_f32_16x16x32_bf16 v[192:195], v[144:147], v[80:83], v[192:195]
    ds_read_b128 v[144:147], v2 offset:36864
    v_mfma_f32_16x16x32_bf16 v[176:179], v[148:151], v[84:87], v[176:179]
    ds_read_b128 v[148:151], v2 offset:37888
    v_mfma_f32_16x16x32_bf16 v[180:183], v[152:155], v[84:87], v[180:183]
    ds_read_b128 v[152:155], v2 offset:38912
    s_waitcnt lgkmcnt(7)
    v_cmp_gt_u32 s[22:23], 4, v7
    v_mfma_f32_16x16x32_bf16 v[184:187], v[156:159], v[84:87], v[184:187]
    ds_read_b128 v[156:159], v2 offset:39936
    v_mfma_f32_16x16x32_bf16 v[188:191], v[160:163], v[84:87], v[188:191]
    s_cmp_lg_u64 s[22:23], 0
    s_cbranch_scc1 Lw_6
Lw_6_ok:
    ds_read_b128 v[160:163], v2 offset:40960
    v_mfma_f32_16x16x32_bf16 v[192:195], v[164:167], v[84:87], v[192:195]
    ds_read_b128 v[164:167], v2 offset:41984
    v_mfma_f32_16x16x32_bf16 v[176:179], v[168:171], v[88:91], v[176:179]
    ds_read_b128 v[168:171], v2 offset:43008
    v_mfma_f32_16x16x32_bf16 v[180:183], v[172:175], v[88:91], v[180:183]
    ds_read_b128 v[172:175], v2 offset:44032
    s_waitcnt lgkmcnt(8)
    v_mfma_f32_16x16x32_bf16 v[184:187], v[48:51], v[88:91], v[184:187]
    ds_read_b128 v[48:51], v2 offset:45056
    v_mfma_f32_16x16x32_bf16 v[188:191], v[52:55], v[88:91], v[188:191]
    ds_read_b128 v[52:55], v2 offset:46080
    v_mfma_f32_16x16x32_bf16 v[192:195], v[56:59], v[88:91], v[192:195]
    ds_read_b128 v[56:59], v2 offset:47104
    v_mfma_f32_16x16x32_bf16 v[176:179], v[60:63], v[92:95], v[176:179]
    ds_read_b128 v[60:63], v2 offset:48128
    s_waitcnt lgkmcnt(8)
    v_mfma_f32_16x16x32_bf16 v[180:183], v[144:147], v[92:95], v[180:183]
    ds_read_b128 v[144:147], v2 offset:49152
    v_mfma_f32_16x16x32_bf16 v[184:187], v[148:151], v[92:95], v[184:187]
    ds_read_b128 v[148:151], v2 offset:50176
    v_mfma_f32_16x16x32_bf16 v[188:191], v[152:155], v[92:95], v[188:191]
    ds_read_b128 v[152:155], v2 offset:51200
    v_mfma_f32_16x16x32_bf16 v[192:195], v[156:159], v[92:95], v[192:195]
    ds_read_b128 v[156:159], v2 offset:52224
    ds_read_b32 v7, v6
    s_waitcnt lgkmcnt(9)
    v_mfma_f32_16x16x32_bf16 v[176:179], v[160:163], v[96:99], v[176:179]
    ds_read_b128 v[160:163], v2 offset:53248
    v_mfma_f32_16x16x32_bf16 v[180:183], v[164:167], v[96:99], v[180:183]
    ds_read_b128 v[164:167], v2 offset:54272
    v_mfma_f32_16x16x32_bf16 v[184:187], v[168:171], v[96:99], v[184:187]
    ds_read_b128 v[168:171], v2 offset:55296
    v_mfma_f32_16x16x32_bf16 v[188:191], v[172:175], v[96:99], v[188:191]
    ds_read_b128 v[172:175], v2 offset:56320
    s_waitcnt lgkmcnt(9)
    v_mfma_f32_16x16x32_bf16 v[192:195], v[48:51], v[96:99], v[192:195]
    ds_read_b128 v[48:51], v2 offset:57344
    v_mfma_f32_16x16x32_bf16 v[176:179], v[52:55], v[100:103], v[176:179]
    ds_read_b128 v[52:55], v2 offset:58368
    v_mfma_f32_16x16x32_bf16 v[180:183], v[56:59], v[100:103], v[180:183]
    ds_read_b128 v[56:59], v2 offset:59392
    s_waitcnt lgkmcnt(7)
    v_cmp_gt_u32 s[22:23], 5, v7
    v_mfma_f32_16x16x32_bf16 v[184:187], v[60:63], v[100:103], v[184:187]
    ds_read_b128 v[60:63], v2 offset:60416
    v_mov_b32 v8, 4
    v_mfma_f32_16x16x32_bf16 v[188:191], v[144:147], v[100:103], v[188:191]
    s_cmp_lg_u64 s[22:23], 0
    s_cbranch_scc1 Lw_7
Lw_7_ok:
    ds_read_b128 v[144:147], v2 offset:61440
    ds_write_b32 v15, v8
    v_mfma_f32_16x16x32_bf16 v[192:195], v[148:151], v[100:103], v[192:195]
    ds_read_b128 v[148:151], v2 offset:62464
    v_mfma_f32_16x16x32_bf16 v[176:179], v[152:155], v[104:107], v[176:179]
    ds_read_b128 v[152:155], v2 offset:63488
    v_mfma_f32_16x16x32_bf16 v[180:183], v[156:159], v[104:107], v[180:183]
    ds_read_b128 v[156:159], v2 offset:64512
    s_waitcnt lgkmcnt(9)
    v_mfma_f32_16x16x32_bf16 v[184:187], v[160:163], v[104:107], v[184:187]
    ds_read_b128 v[160:163], v5 offset:0
    v_mfma_f32_16x16x32_bf16 v[188:191], v[164:167], v[104:107], v[188:191]
    ds_read_b128 v[164:167], v5 offset:1024
    v_mfma_f32_16x16x32_bf16 v[192:195], v[168:171], v[104:107], v[192:195]
    ds_read_b128 v[168:171], v5 offset:2048
    v_mfma_f32_16x16x32_bf16 v[176:179], v[172:175], v[108:111], v[176:179]
    ds_read_b128 v[172:175], v5 offset:3072
    s_waitcnt lgkmcnt(9)
    v_mfma_f32_16x16x32_bf16 v[180:183], v[48:51], v[108:111], v[180:183]
    ds_read_b128 v[48:51], v5 offset:4096
    v_mfma_f32_16x16x32_bf16 v[184:187], v[52:55], v[108:111], v[184:187]
    ds_read_b128 v[52:55], v5 offset:5120
    v_mfma_f32_16x16x32_bf16 v[188:191], v[56:59], v[108:111], v[188:191]
    ds_read_b128 v[56:59], v5 offset:6144
    v_mfma_f32_16x16x32_bf16 v[192:195], v[60:63], v[108:111], v[192:195]
    ds_read_b128 v[60:63], v5 offset:7168
    ds_read_b32 v7, v6
    s_waitcnt lgkmcnt(9)
    v_mfma_f32_16x16x32_bf16 v[176:179], v[144:147], v[112:115], v[176:179]
    ds_read_b128 v[144:147], v5 offset:8192
    v_mfma_f32_16x16x32_bf16 v[180:183], v[148:151], v[112:115], v[180:183]
    ds_read_b128 v[148:151], v5 offset:9216
    v_mfma_f32_16x16x32_bf16 v[184:187], v[152:155], v[112:115], v[184:187]
    ds_read_b128 v[152:155], v5 offset:10240
    v_mfma_f32_16x16x32_bf16 v[188:191], v[156:159], v[112:115], v[188:191]
    ds_read_b128 v[156:159], v5 offset:11264
    s_waitcnt lgkmcnt(9)
    v_mfma_f32_16x16x32_bf16 v[192:195], v[160:163], v[112:115], v[192:195]
    ds_read_b128 v[160:163], v5 offset:12288
    v_mfma_f32_16x16x32_bf16 v[176:179], v[164:167], v[116:119], v[176:179]
    ds_read_b128 v[164:167], v5 offset:13312
    v_mfma_f32_16x16x32_bf16 v[180:183], v[168:171], v[116:119], v[180:183]
    ds_read_b128 v[168:171], v5 offset:14336
    s_waitcnt lgkmcnt(7)
    v_cmp_gt_u32 s[22:23], 6, v7
    v_mfma_f32_16x16x32_bf16 v[184:187], v[172:175], v[116:119], v[184:187]
    ds_read_b128 v[172:175], v5 offset:15360
    v_mfma_f32_16x16x32_bf16 v[188:191], v[48:51], v[116:119], v[188:191]
    s_cmp_lg_u64 s[22:23], 0
    s_cbranch_scc1 Lw_8
Lw_8_ok:
    ds_read_b128 v[48:51], v5 offset:16384
    v_mfma_f32_16x16x32_bf16 v[192:195], v[52:55], v[116:119], v[192:195]
    ds_read_b128 v[52:55], v5 offset:17408
    v_mfma_f32_16x16x32_bf16 v[176:179], v[56:59], v[120:123], v[176:179]
    ds_read_b128 v[56:59], v5 offset:18432
    v_mfma_f32_16x16x32_bf16 v[180:183], v[60:63], v[120:123], v[180:183]
    ds_read_b128 v[60:63], v5 offset:19456
    s_waitcnt lgkmcnt(8)
    v_mfma_f32_16x16x32_bf16 v[184:187], v[144:147], v[120:123], v[184:187]
    ds_read_b128 v[144:147], v5 offset:20480
    v_mfma_f32_16x16x32_bf16 v[188:191], v[148:151], v[120:123], v[188:191]
    ds_read_b128 v[148:151], v5 offset:21504
    v_mfma_f32_16x16x32_bf16 v[192:195], v[152:155], v[120:123], v[192:195]
    ds_read_b128 v[152:155], v5 offset:22528
    v_mfma_f32_16x16x32_bf16 v[176:179], v[156:159], v[124:127], v[176:179]
    ds_read_b128 v[156:159], v5 offset:23552
    s_waitcnt lgkmcnt(8)
    v_mfma_f32_16x16x32_bf16 v[180:183], v[160:163], v[124:127], v[180:183]
    ds_read_b128 v[160:163], v5 offset:24576
    v_mfma_f32_16x16x32_bf16 v[184:187], v[164:167], v[124:127], v[184:187]
    ds_read_b128 v[164:167], v5 offset:25600
    v_mfma_f32_16x16x32_bf16 v[188:191], v[168:171], v[124:127], v[188:191]
    ds_read_b128 v[168:171], v5 offset:26624
    v_mfma_f32_16x16x32_bf16 v[192:195], v[172:175], v[124:127], v[192:195]
    ds_read_b128 v[172:175], v5 offset:27648
    ds_read_b32 v7, v6
    s_waitcnt lgkmcnt(9)
    v_mfma_f32_16x16x32_bf16 v[176:179], v[48:51], v[128:131], v[176:179]
    ds_read_b128 v[48:51], v5 offset:28672
    v_mfma_f32_16x16x32_bf16 v[180:183], v[52:55], v[128:131], v[180:183]
    ds_read_b128 v[52:55], v5 offset:29696
    v_mfma_f32_16x16x32_bf16 v[184:187], v[56:59], v[128:131], v[184:187]
    ds_read_b128 v[56:59], v5 offset:30720
    v_mfma_f32_16x16x32_bf16 v[188:191], v[60:63], v[128:131], v[188:191]
    ds_read_b128 v[60:63], v5 offset:31744
    s_waitcnt lgkmcnt(9)
    v_mfma_f32_16x16x32_bf16 v[192:195], v[144:147], v[128:131], v[192:195]
    ds_read_b128 v[144:147], v5 offset:32768
    v_mfma_f32_16x16x32_bf16 v[176:179], v[148:151], v[132:135], v[176:179]
    ds_read_b128 v[148:151], v5 offset:33792
    v_mfma_f32_16x16x32_bf16 v[180:183], v[152:155], v[132:135], v[180:183]
    ds_read_b128 v[152:155], v5 offset:34816
    s_waitcnt lgkmcnt(7)
    v_cmp_gt_u32 s[22:23], 7, v7
    v_mfma_f32_16x16x32_bf16 v[184:187], v[156:159], v[132:135], v[184:187]
    ds_read_b128 v[156:159], v5 offset:35840
    v_mov_b32 v8, 6
    v_mfma_f32_16x16x32_bf16 v[188:191], v[160:163], v[132:135], v[188:191]
    s_cmp_lg_u64 s[22:23], 0
    s_cbranch_scc1 Lw_9
Lw_9_ok:
    ds_read_b128 v[160:163], v5 offset:36864
    ds_write_b32 v15, v8
    v_mfma_f32_16x16x32_bf16 v[192:195], v[164:167], v[132:135], v[192:195]
    ds_read_b128 v[164:167], v5 offset:37888
    v_mfma_f32_16x16x32_bf16 v[176:179], v[168:171], v[136:139], v[176:179]
    ds_read_b128 v[168:171], v5 offset:38912
    v_mfma_f32_16x16x32_bf16 v[180:183], v[172:175], v[136:139], v[180:183]
    ds_read_b128 v[172:175], v5 offset:39936
    s_waitcnt lgkmcnt(9)
    v_mfma_f32_16x16x32_bf16 v[184:187], v[48:51], v[136:139], v[184:187]
    ds_read_b128 v[48:51], v5 offset:40960
    v_mfma_f32_16x16x32_bf16 v[188:191], v[52:55], v[136:139], v[188:191]
    ds_read_b128 v[52:55], v5 offset:41984
    v_mfma_f32_16x16x32_bf16 v[192:195], v[56:59], v[136:139], v[192:195]
    ds_read_b128 v[56:59], v5 offset:43008
    v_mfma_f32_16x16x32_bf16 v[176:179], v[60:63], v[140:143], v[176:179]
    ds_read_b128 v[60:63], v5 offset:44032
    s_waitcnt lgkmcnt(9)
    v_mfma_f32_16x16x32_bf16 v[180:183], v[144:147], v[140:143], v[180:183]
    ds_read_b128 v[144:147], v5 offset:45056
    v_mfma_f32_16x16x32_bf16 v[184:187], v[148:151], v[140:143], v[184:187]
    ds_read_b128 v[148:151], v5 offset:46080
    v_mfma_f32_16x16x32_bf16 v[188:191], v[152:155], v[140:143], v[188:191]
    ds_read_b128 v[152:155], v5 offset:47104
    v_mfma_f32_16x16x32_bf16 v[192:195], v[156:159], v[140:143], v[192:195]
    ds_read_b128 v[156:159], v5 offset:48128
    ds_read_b32 v7, v6
    s_waitcnt lgkmcnt(9)
    v_mfma_f32_16x16x32_bf16 v[196:199], v[64:67], v[160:163], 0
    ds_read_b128 v[160:163], v5 offset:49152
    v_mfma_f32_16x16x32_bf16 v[200:203], v[64:67], v[164:167], 0
    ds_read_b128 v[164:167], v5 offset:50176
    v_mfma_f32_16x16x32_bf16 v[204:207], v[64:67], v[168:171], 0
    ds_read_b128 v[168:171], v5 offset:51200
    v_mfma_f32_16x16x32_bf16 v[208:211], v[64:67], v[172:175], 0
    ds_read_b128 v[172:175], v5 offset:52224
    s_waitcnt lgkmcnt(9)
    v_mfma_f32_16x16x32_bf16 v[212:215], v[64:67], v[48:51], 0
    ds_read_b128 v[48:51], v5 offset:53248
    v_mfma_f32_16x16x32_bf16 v[196:199], v[68:71], v[52:55], v[196:199]
    ds_read_b128 v[52:55], v5 offset:54272
    v_cvt_pk_bf16_f32 v228, v176, v177
    v_mfma_f32_16x16x32_bf16 v[200:203], v[68:71], v[56:59], v[200:203]
    ds_read_b128 v[56:59], v5 offset:55296
    s_waitcnt lgkmcnt(7)
    v_cmp_gt_u32 s[22:23], 8, v7
    v_cvt_pk_bf16_f32 v229, v178, v179
    v_mfma_f32_16x16x32_bf16 v[204:207], v[68:71], v[60:63], v[204:207]
    ds_read_b128 v[60:63], v5 offset:56320
    v_cvt_pk_bf16_f32 v232, v180, v181
    v_mfma_f32_16x16x32_bf16 v[208:211], v[68:71], v[144:147], v[208:211]
    s_cmp_lg_u64 s[22:23], 0
    s_cbranch_scc1 Lw_10
Lw_10_ok:
    ds_read_b128 v[144:147], v2 offset:0
    v_cvt_pk_bf16_f32 v233, v182, v183
    v_mfma_f32_16x16x32_bf16 v[212:215], v[68:71], v[148:151], v[212:215]
    ds_read_b128 v[148:151], v2 offset:1024
    v_cvt_pk_bf16_f32 v236, v184, v185
    v_mfma_f32_16x16x32_bf16 v[196:199], v[72:75], v[152:155], v[196:199]
    ds_read_b128 v[152:155], v2 offset:2048
    v_cvt_pk_bf16_f32 v237, v186, v187
    v_mfma_f32_16x16x32_bf16 v[200:203], v[72:75], v[156:159], v[200:203]
    ds_read_b128 v[156:159], v2 offset:3072
    v_cvt_pk_bf16_f32 v240, v188, v189
    s_waitcnt lgkmcnt(8)
    v_mfma_f32_16x16x32_bf16 v[204:207], v[72:75], v[160:163], v[204:207]
    ds_read_b128 v[160:163], v2 offset:4096
    v_cvt_pk_bf16_f32 v241, v190, v191
    v_mfma_f32_16x16x32_bf16 v[208:211], v[72:75], v[164:167], v[208:211]
    ds_read_b128 v[164:167], v2 offset:5120
    v_cvt_pk_bf16_f32 v244, v192, v193
    v_mfma_f32_16x16x32_bf16 v[212:215], v[72:75], v[168:171], v[212:215]
    ds_read_b128 v[168:171], v2 offset:6144
    v_cvt_pk_bf16_f32 v245, v194, v195
    v_mfma_f32_16x16x32_bf16 v[196:199], v[76:79], v[172:175], v[196:199]
    ds_read_b128 v[172:175], v2 offset:7168
    s_cmp_eq_u32 s40, 3
    s_cbranch_scc1 Lo_11
Lo_11_b:
    s_waitcnt lgkmcnt(8)
    v_mfma_f32_16x16x32_bf16 v[200:203], v[76:79], v[48:51], v[200:203]
    ds_read_b128 v[48:51], v2 offset:8192
    v_cvt_pk_bf16_f32 v28, v176, v177
    v_mfma_f32_16x16x32_bf16 v[204:207], v[76:79], v[52:55], v[204:207]
    ds_read_b128 v[52:55], v2 offset:9216
    v_cvt_pk_bf16_f32 v29, v178, v179
    v_mfma_f32_16x16x32_bf16 v[208:211], v[76:79], v[56:59], v[208:211]
    ds_read_b128 v[56:59], v2 offset:10240
    v_cvt_pk_bf16_f32 v30, v180, v181
    v_mfma_f32_16x16x32_bf16 v[212:215], v[76:79], v[60:63], v[212:215]
    ds_read_b128 v[60:63], v2 offset:11264
    ds_read_b32 v7, v6
    v_cvt_pk_bf16_f32 v31, v182, v183
    s_waitcnt lgkmcnt(9)
    v_mfma_f32_16x16x32_bf16 v[196:199], v[80:83], v[144:147], v[196:199]
    ds_read_b128 v[144:147], v2 offset:12288
    v_cvt_pk_bf16_f32 v32, v184, v185
    v_mfma_f32_16x16x32_bf16 v[200:203], v[80:83], v[148:151], v[200:203]
    ds_read_b128 v[148:151], v2 offset:13312
    v_cvt_pk_bf16_f32 v33, v186, v187
    v_mfma_f32_16x16x32_bf16 v[204:207], v[80:83], v[152:155], v[204:207]
    ds_read_b128 v[152:155], v2 offset:14336
    v_cvt_pk_bf16_f32 v34, v188, v189
    v_mfma_f32_16x16x32_bf16 v[208:211], v[80:83], v[156:159], v[208:211]
    ds_read_b128 v[156:159], v2 offset:15360
    v_cvt_pk_bf16_f32 v35, v190, v191
    s_waitcnt lgkmcnt(9)
    v_mfma_f32_16x16x32_bf16 v[212:215], v[80:83], v[160:163], v[212:215]
    ds_read_b128 v[160:163], v2 offset:16384
    v_cvt_pk_bf16_f32 v36, v192, v193
    v_mfma_f32_16x16x32_bf16 v[196:199], v[84:87], v[164:167], v[196:199]
    ds_read_b128 v[164:167], v2 offset:17408
    v_cvt_pk_bf16_f32 v37, v194, v195
    v_mfma_f32_16x16x32_bf16 v[200:203], v[84:87], v[168:171], v[200:203]
    ds_read_b128 v[168:171], v2 offset:18432
    s_waitcnt lgkmcnt(7)
    v_cmp_gt_u32 s[22:23], 9, v7
    ds_write_b128 v22, v[28:31]
    v_mfma_f32_16x16x32_bf16 v[204:207], v[84:87], v[172:175], v[204:207]
    ds_read_b128 v[172:175], v2 offset:19456
    v_mov_b32 v8, 8
    ds_write_b128 v22, v[32:35] offset:1024
    v_mfma_f32_16x16x32_bf16 v[208:211], v[84:87], v[48:51], v[208:211]
    s_cmp_lg_u64 s[22:23], 0
    s_cbranch_scc1 Lw_12
Lw_12_ok:
    ds_read_b128 v[48:51], v2 offset:20480
    ds_write_b32 v15, v8
    ds_write_b64 v23, v[36:37] offset:2048
    v_mfma_f32_16x16x32_bf16 v[212:215], v[84:87], v[52:55], v[212:215]
    ds_read_b128 v[52:55], v2 offset:21504
    ds_write_b32 v27, v10
    v_mfma_f32_16x16x32_bf16 v[196:199], v[88:91], v[56:59], v[196:199]
    ds_read_b128 v[56:59], v2 offset:22528
    v_mfma_f32_16x16x32_bf16 v[200:203], v[88:91], v[60:63], v[200:203]
    ds_read_b128 v[60:63], v2 offset:23552
    s_waitcnt lgkmcnt(13)
    v_mfma_f32_16x16x32_bf16 v[204:207], v[88:91], v[144:147], v[204:207]
    ds_read_b128 v[144:147], v2 offset:24576
    v_mfma_f32_16x16x32_bf16 v[208:211], v[88:91], v[148:151], v[208:211]
    ds_read_b128 v[148:151], v2 offset:25600
    v_mfma_f32_16x16x32_bf16 v[212:215], v[88:91], v[152:155], v[212:215]
    ds_read_b128 v[152:155], v2 offset:26624
    v_mfma_f32_16x16x32_bf16 v[196:199], v[92:95], v[156:159], v[196:199]
    ds_read_b128 v[156:159], v2 offset:27648
    s_waitcnt lgkmcnt(12)
    v_mfma_f32_16x16x32_bf16 v[200:203], v[92:95], v[160:163], v[200:203]
    ds_read_b128 v[160:163], v2 offset:28672
    v_mfma_f32_16x16x32_bf16 v[204:207], v[92:95], v[164:167], v[204:207]
    ds_read_b128 v[164:167], v2 offset:29696
    v_mfma_f32_16x16x32_bf16 v[208:211], v[92:95], v[168:171], v[208:211]
    ds_read_b128 v[168:171], v2 offset:30720
    v_mfma_f32_16x16x32_bf16 v[212:215], v[92:95], v[172:175], v[212:215]
    ds_read_b128 v[172:175], v2 offset:31744
    ds_read_b32 v7, v6
    s_waitcnt lgkmcnt(9)
    v_mfma_f32_16x16x32_bf16 v[196:199], v[96:99], v[48:51], v[196:199]
    ds_read_b128 v[48:51], v2 offset:32768
    v_mfma_f32_16x16x32_bf16 v[200:203], v[96:99], v[52:55], v[200:203]
    ds_read_b128 v[52:55], v2 offset:33792
    v_mfma_f32_16x16x32_bf16 v[204:207], v[96:99], v[56:59], v[204:207]
    ds_read_b128 v[56:59], v2 offset:34816
    v_mfma_f32_16x16x32_bf16 v[208:211], v[96:99], v[60:63], v[208:211]
    ds_read_b128 v[60:63], v2 offset:35840
    s_waitcnt lgkmcnt(9)
    v_mfma_f32_16x16x32_bf16 v[212:215], v[96:99], v[144:147], v[212:215]
    ds_read_b128 v[144:147], v2 offset:36864
    v_mfma_f32_16x16x32_bf16 v[196:199], v[100:103], v[148:151], v[196:199]
    ds_read_b128 v[148:151], v2 offset:37888
    v_mfma_f32_16x16x32_bf16 v[200:203], v[100:103], v[152:155], v[200:203]
    ds_read_b128 v[152:155], v2 offset:38912
    s_waitcnt lgkmcnt(7)
    v_cmp_gt_u32 s[22:23], 10, v7
    v_mfma_f32_16x16x32_bf16 v[204:207], v[100:103], v[156:159], v[204:207]
    ds_read_b128 v[156:159], v2 offset:39936
    v_mfma_f32_16x16x32_bf16 v[208:211], v[100:103], v[160:163], v[208:211]
    s_cmp_lg_u64 s[22:23], 0
    s_cbranch_scc1 Lw_13
Lw_13_ok:
    ds_read_b128 v[160:163], v2 offset:40960
    v_mfma_f32_16x16x32_bf16 v[212:215], v[100:103], v[164:167], v[212:215]
    ds_read_b128 v[164:167], v2 offset:41984
    v_mfma_f32_16x16x32_bf16 v[196:199], v[104:107], v[168:171], v[196:199]
    ds_read_b128 v[168:171], v2 offset:43008
    v_mfma_f32_16x16x32_bf16 v[200:203], v[104:107], v[172:175], v[200:203]
    ds_read_b128 v[172:175], v2 offset:44032
    s_waitcnt lgkmcnt(8)
    v_mfma_f32_16x16x32_bf16 v[204:207], v[104:107], v[48:51], v[204:207]
    ds_read_b128 v[48:51], v2 offset:45056
    v_mfma_f32_16x16x32_bf16 v[208:211], v[104:107], v[52:55], v[208:211]
    ds_read_b128 v[52:55], v2 offset:46080
    v_mfma_f32_16x16x32_bf16 v[212:215], v[104:107], v[56:59], v[212:215]
    ds_read_b128 v[56:59], v2 offset:47104
    v_mfma_f32_16x16x32_bf16 v[196:199], v[108:111], v[60:63], v[196:199]
    ds_read_b128 v[60:63], v2 offset:48128
    s_waitcnt lgkmcnt(8)
    v_mfma_f32_16x16x32_bf16 v[200:203], v[108:111], v[144:147], v[200:203]
    ds_read_b128 v[144:147], v2 offset:49152
    v_mfma_f32_16x16x32_bf16 v[204:207], v[108:111], v[148:151], v[204:207]
    ds_read_b128 v[148:151], v2 offset:50176
    v_mfma_f32_16x16x32_bf16 v[208:211], v[108:111], v[152:155], v[208:211]
    ds_read_b128 v[152:155], v2 offset:51200
    v_mfma_f32_16x16x32_bf16 v[212:215], v[108:111], v[156:159], v[212:215]
    ds_read_b128 v[156:159], v2 offset:52224
    ds_read_b32 v7, v6
    s_waitcnt lgkmcnt(9)
    v_mfma_f32_16x16x32_bf16 v[196:199], v[112:115], v[160:163], v[196:199]
    ds_read_b128 v[160:163], v2 offset:53248
    v_mfma_f32_16x16x32_bf16 v[200:203], v[112:115], v[164:167], v[200:203]
    ds_read_b128 v[164:167], v2 offset:54272
    v_mfma_f32_16x16x32_bf16 v[204:207], v[112:115], v[168:171], v[204:207]
    ds_read_b128 v[168:171], v2 offset:55296
    v_mfma_f32_16x16x32_bf16 v[208:211], v[112:115], v[172:175], v[208:211]
    ds_read_b128 v[172:175], v2 offset:56320
    s_waitcnt lgkmcnt(9)
    v_mfma_f32_16x16x32_bf16 v[212:215], v[112:115], v[48:51], v[212:215]
    ds_read_b128 v[48:51], v2 offset:57344
    v_mfma_f32_16x16x32_bf16 v[196:199], v[116:119], v[52:55], v[196:199]
    ds_read_b128 v[52:55], v2 offset:58368
    v_mfma_f32_16x16x32_bf16 v[200:203], v[116:119], v[56:59], v[200:203]
    ds_read_b128 v[56:59], v2 offset:59392
    s_waitcnt lgkmcnt(7)
    v_cmp_gt_u32 s[22:23], 11, v7
    v_mfma_f32_16x16x32_bf16 v[204:207], v[116:119], v[60:63], v[204:207]
    ds_read_b128 v[60:63], v2 offset:60416
    v_mov_b32 v8, 10
    v_mfma_f32_16x16x32_bf16 v[208:211], v[116:119], v[144:147], v[208:211]
    s_cmp_lg_u64 s[22:23], 0
    s_cbranch_scc1 Lw_14
Lw_14_ok:
    ds_read_b128 v[144:147], v2 offset:61440
    ds_write_b32 v15, v8
    v_mfma_f32_16x16x32_bf16 v[212:215], v[116:119], v[148:151], v[212:215]
    ds_read_b128 v[148:151], v2 offset:62464
    v_mfma_f32_16x16x32_bf16 v[196:199], v[120:123], v[152:155], v[196:199]
    ds_read_b128 v[152:155], v2 offset:63488
    v_mfma_f32_16x16x32_bf16 v[200:203], v[120:123], v[156:159], v[200:203]
    ds_read_b128 v[156:159], v2 offset:64512
    s_waitcnt lgkmcnt(9)
    v_mfma_f32_16x16x32_bf16 v[204:207], v[120:123], v[160:163], v[204:207]
    ds_read_b128 v[160:163], v5 offset:0
    v_mfma_f32_16x16x32_bf16 v[208:211], v[120:123], v[164:167], v[208:211]
    ds_read_b128 v[164:167], v5 offset:1024
    v_mfma_f32_16x16x32_bf16 v[212:215], v[120:123], v[168:171], v[212:215]
    ds_read_b128 v[168:171], v5 offset:2048
    v_mfma_f32_16x16x32_bf16 v[196:199], v[124:127], v[172:175], v[196:199]
    ds_read_b128 v[172:175], v5 offset:3072
    s_waitcnt lgkmcnt(9)
    v_mfma_f32_16x16x32_bf16 v[200:203], v[124:127], v[48:51], v[200:203]
    ds_read_b128 v[48:51], v5 offset:4096
    v_mfma_f32_16x16x32_bf16 v[204:207], v[124:127], v[52:55], v[204:207]
    ds_read_b128 v[52:55], v5 offset:5120
    v_mfma_f32_16x16x32_bf16 v[208:211], v[124:127], v[56:59], v[208:211]
    ds_read_b128 v[56:59], v5 offset:6144
    v_mfma_f32_16x16x32_bf16 v[212:215], v[124:127], v[60:63], v[212:215]
    ds_read_b128 v[60:63], v5 offset:7168
    ds_read_b32 v7, v6
    s_waitcnt lgkmcnt(9)
    v_mfma_f32_16x16x32_bf16 v[196:199], v[128:131], v[144:147], v[196:199]
    ds_read_b128 v[144:147], v5 offset:8192
    v_mfma_f32_16x16x32_bf16 v[200:203], v[128:131], v[148:151], v[200:203]
    ds_read_b128 v[148:151], v5 offset:9216
    v_mfma_f32_16x16x32_bf16 v[204:207], v[128:131], v[152:155], v[204:207]
    ds_read_b128 v[152:155], v5 offset:10240
    v_mfma_f32_16x16x32_bf16 v[208:211], v[128:131], v[156:159], v[208:211]
    ds_read_b128 v[156:159], v5 offset:11264
    s_waitcnt lgkmcnt(9)
    v_mfma_f32_16x16x32_bf16 v[212:215], v[128:131], v[160:163], v[212:215]
    ds_read_b128 v[160:163], v5 offset:12288
    v_mfma_f32_16x16x32_bf16 v[196:199], v[132:135], v[164:167], v[196:199]
    ds_read_b128 v[164:167], v5 offset:13312
    v_mfma_f32_16x16x32_bf16 v[200:203], v[132:135], v[168:171], v[200:203]
    ds_read_b128 v[168:171], v5 offset:14336
    s_waitcnt lgkmcnt(7)
    v_cmp_gt_u32 s[22:23], 12, v7
    v_mfma_f32_16x16x32_bf16 v[204:207], v[132:135], v[172:175], v[204:207]
    ds_read_b128 v[172:175], v5 offset:15360
    v_mfma_f32_16x16x32_bf16 v[208:211], v[132:135], v[48:51], v[208:211]
    s_cmp_lg_u64 s[22:23], 0
    s_cbranch_scc1 Lw_15
Lw_15_ok:
    ds_read_b128 v[48:51], v5 offset:16384
    v_mfma_f32_16x16x32_bf16 v[212:215], v[132:135], v[52:55], v[212:215]
    ds_read_b128 v[52:55], v5 offset:17408
    v_mfma_f32_16x16x32_bf16 v[196:199], v[136:139], v[56:59], v[196:199]
    ds_read_b128 v[56:59], v5 offset:18432
    v_mfma_f32_16x16x32_bf16 v[200:203], v[136:139], v[60:63], v[200:203]
    ds_read_b128 v[60:63], v5 offset:19456
    s_waitcnt lgkmcnt(8)
    v_mfma_f32_16x16x32_bf16 v[204:207], v[136:139], v[144:147], v[204:207]
    ds_read_b128 v[144:147], v5 offset:20480
    v_mfma_f32_16x16x32_bf16 v[208:211], v[136:139], v[148:151], v[208:211]
    ds_read_b128 v[148:151], v5 offset:21504
    v_mfma_f32_16x16x32_bf16 v[212:215], v[136:139], v[152:155], v[212:215]
    ds_read_b128 v[152:155], v5 offset:22528
    v_mfma_f32_16x16x32_bf16 v[196:199], v[140:143], v[156:159], v[196:199]
    ds_read_b128 v[156:159], v5 offset:23552
    s_waitcnt lgkmcnt(8)
    v_mfma_f32_16x16x32_bf16 v[200:203], v[140:143], v[160:163], v[200:203]
    ds_read_b128 v[160:163], v5 offset:24576
    v_mfma_f32_16x16x32_bf16 v[204:207], v[140:143], v[164:167], v[204:207]
    ds_read_b128 v[164:167], v5 offset:25600
    v_mfma_f32_16x16x32_bf16 v[208:211], v[140:143], v[168:171], v[208:211]
    ds_read_b128 v[168:171], v5 offset:26624
    v_mfma_f32_16x16x32_bf16 v[212:215], v[140:143], v[172:175], v[212:215]
    ds_read_b128 v[172:175], v5 offset:27648
    ds_read_b32 v7, v6
    s_setprio 3
    s_waitcnt lgkmcnt(9)
    v_mfma_f32_16x16x32_bf16 v[176:179], v[48:51], v[64:67], 0
    ds_read_b128 v[48:51], v5 offset:28672
    v_mfma_f32_16x16x32_bf16 v[180:183], v[52:55], v[64:67], 0
    ds_read_b128 v[52:55], v5 offset:29696
    v_mfma_f32_16x16x32_bf16 v[184:187], v[56:59], v[64:67], 0
    ds_read_b128 v[56:59], v5 offset:30720
    v_mfma_f32_16x16x32_bf16 v[188:191], v[60:63], v[64:67], 0
    ds_read_b128 v[60:63], v5 offset:31744
    s_waitcnt lgkmcnt(9)
    v_mfma_f32_16x16x32_bf16 v[192:195], v[144:147], v[64:67], 0
    ds_read_b128 v[144:147], v5 offset:32768
    v_mfma_f32_16x16x32_bf16 v[176:179], v[148:151], v[68:71], v[176:179]
    ds_read_b128 v[148:151], v5 offset:33792
    v_cvt_pk_bf16_f32 v228, v196, v197
    v_mfma_f32_16x16x32_bf16 v[180:183], v[152:155], v[68:71], v[180:183]
    ds_read_b128 v[152:155], v5 offset:34816
    s_waitcnt lgkmcnt(7)
    v_cmp_gt_u32 s[22:23], 13, v7
    v_cvt_pk_bf16_f32 v229, v198, v199
    v_mfma_f32_16x16x32_bf16 v[184:187], v[156:159], v[68:71], v[184:187]
    ds_read_b128 v[156:159], v5 offset:35840
    v_mov_b32 v8, 12
    v_cvt_pk_bf16_f32 v232, v200, v201
    v_mfma_f32_16x16x32_bf16 v[188:191], v[160:163], v[68:71], v[188:191]
    s_cmp_lg_u64 s[22:23], 0
    s_cbranch_scc1 Lw_16
Lw_16_ok:
    ds_read_b128 v[160:163], v5 offset:36864
    ds_write_b32 v15, v8
    v_cvt_pk_bf16_f32 v233, v202, v203
    v_mfma_f32_16x16x32_bf16 v[192:195], v[164:167], v[68:71], v[192:195]
    ds_read_b128 v[164:167], v5 offset:37888
    v_cvt_pk_bf16_f32 v236, v204, v205
    v_mfma_f32_16x16x32_bf16 v[176:179], v[168:171], v[72:75], v[176:179]
    ds_read_b128 v[168:171], v5 offset:38912
    v_cvt_pk_bf16_f32 v237, v206, v207
    v_mfma_f32_16x16x32_bf16 v[180:183], v[172:175], v[72:75], v[180:183]
    ds_read_b128 v[172:175], v5 offset:39936
    v_cvt_pk_bf16_f32 v240, v208, v209
    s_waitcnt lgkmcnt(9)
    v_mfma_f32_16x16x32_bf16 v[184:187], v[48:51], v[72:75], v[184:187]
    ds_read_b128 v[48:51], v5 offset:40960
    v_cvt_pk_bf16_f32 v241, v210, v211
    v_mfma_f32_16x16x32_bf16 v[188:191], v[52:55], v[72:75], v[188:191]
    ds_read_b128 v[52:55], v5 offset:41984
    v_cvt_pk_bf16_f32 v244, v212, v213
    v_mfma_f32_16x16x32_bf16 v[192:195], v[56:59], v[72:75], v[192:195]
    ds_read_b128 v[56:59], v5 offset:43008
    v_cvt_pk_bf16_f32 v245, v214, v215
    v_mfma_f32_16x16x32_bf16 v[176:179], v[60:63], v[76:79], v[176:179]
    ds_read_b128 v[60:63], v5 offset:44032
    s_cmp_eq_u32 s40, 3
    s_cbranch_scc1 Lo_17
Lo_17_b:
    s_waitcnt lgkmcnt(9)
    v_mfma_f32_16x16x32_bf16 v[180:183], v[144:147], v[76:79], v[180:183]
    ds_read_b128 v[144:147], v5 offset:45056
    s_cmp_eq_u32 s40, 0
    s_cbranch_scc1 Lo_18
Lo_18_b:
    v_mfma_f32_16x16x32_bf16 v[184:187], v[148:151], v[76:79], v[184:187]
    ds_read_b128 v[148:151], v5 offset:46080
    ds_write_b64 v24, v[228:229] offset:2560
    v_mfma_f32_16x16x32_bf16 v[188:191], v[152:155], v[76:79], v[188:191]
    ds_read_b128 v[152:155], v5 offset:47104
    ds_write_b64 v24, v[232:233] offset:3072
    v_mfma_f32_16x16x32_bf16 v[192:195], v[156:159], v[76:79], v[192:195]
    ds_read_b128 v[156:159], v5 offset:48128
    ds_read_b32 v7, v6
    ds_write_b64 v24, v[236:237] offset:3584
    s_waitcnt lgkmcnt(12)
    v_mfma_f32_16x16x32_bf16 v[176:179], v[160:163], v[80:83], v[176:179]
    ds_read_b128 v[160:163], v5 offset:49152
    ds_write_b64 v24, v[240:241] offset:4096
    v_mfma_f32_16x16x32_bf16 v[180:183], v[164:167], v[80:83], v[180:183]
    ds_read_b128 v[164:167], v5 offset:50176
    ds_write_b64 v24, v[244:245] offset:4608
    v_mfma_f32_16x16x32_bf16 v[184:187], v[168:171], v[80:83], v[184:187]
    ds_read_b128 v[168:171], v5 offset:51200
    ds_write_b32 v27, v11
    v_mfma_f32_16x16x32_bf16 v[188:191], v[172:175], v[80:83], v[188:191]
    ds_read_b128 v[172:175], v5 offset:52224
    s_waitcnt lgkmcnt(15)
    v_mfma_f32_16x16x32_bf16 v[192:195], v[48:51], v[80:83], v[192:195]
    ds_read_b128 v[48:51], v5 offset:53248
    v_mfma_f32_16x16x32_bf16 v[176:179], v[52:55], v[84:87], v[176:179]
    ds_read_b128 v[52:55], v5 offset:54272
    v_mfma_f32_16x16x32_bf16 v[180:183], v[56:59], v[84:87], v[180:183]
    ds_read_b128 v[56:59], v5 offset:55296
    s_waitcnt lgkmcnt(11)
    v_cmp_gt_u32 s[22:23], 14, v7
    v_mfma_f32_16x16x32_bf16 v[184:187], v[60:63], v[84:87], v[184:187]
    ds_read_b128 v[60:63], v5 offset:56320
    v_mfma_f32_16x16x32_bf16 v[188:191], v[144:147], v[84:87], v[188:191]
    s_cmp_lg_u64 s[22:23], 0
    s_cbranch_scc1 Lw_19
Lw_19_ok:
    ds_read_b128 v[144:147], v2 offset:0
    v_mfma_f32_16x16x32_bf16 v[192:195], v[148:151], v[84:87], v[192:195]
    ds_read_b128 v[148:151], v2 offset:1024
    v_mfma_f32_16x16x32_bf16 v[176:179], v[152:155], v[88:91], v[176:179]
    ds_read_b128 v[152:155], v2 offset:2048
    v_mfma_f32_16x16x32_bf16 v[180:183], v[156:159], v[88:91], v[180:183]
    ds_read_b128 v[156:159], v2 offset:3072
    s_waitcnt lgkmcnt(8)
    v_mfma_f32_16x16x32_bf16 v[184:187], v[160:163], v[88:91], v[184:187]
    ds_read_b128 v[160:163], v2 offset:4096
    v_mfma_f32_16x16x32_bf16 v[188:191], v[164:167], v[88:91], v[188:191]
    ds_read_b128 v[164:167], v2 offset:5120
    v_mfma_f32_16x16x32_bf16 v[192:195], v[168:171], v[88:91], v[192:195]
    ds_read_b128 v[168:171], v2 offset:6144
    v_mfma_f32_16x16x32_bf16 v[176:179], v[172:175], v[92:95], v[176:179]
    ds_read_b128 v[172:175], v2 offset:7168
    s_waitcnt lgkmcnt(8)
    v_mfma_f32_16x16x32_bf16 v[180:183], v[48:51], v[92:95], v[180:183]
    ds_read_b128 v[48:51], v2 offset:8192
    v_mfma_f32_16x16x32_bf16 v[184:187], v[52:55], v[92:95], v[184:187]
    ds_read_b128 v[52:55], v2 offset:9216
    v_mfma_f32_16x16x32_bf16 v[188:191], v[56:59], v[92:95], v[188:191]
    ds_read_b128 v[56:59], v2 offset:10240
    v_mfma_f32_16x16x32_bf16 v[192:195], v[60:63], v[92:95], v[192:195]
    ds_read_b128 v[60:63], v2 offset:11264
    ds_read_b32 v7, v6
    s_waitcnt lgkmcnt(9)
    v_mfma_f32_16x16x32_bf16 v[176:179], v[144:147], v[96:99], v[176:179]
    ds_read_b128 v[144:147], v2 offset:12288
    ds_read_b32 v26, v4 offset:40
    v_mfma_f32_16x16x32_bf16 v[180:183], v[148:151], v[96:99], v[180:183]
    ds_read_b128 v[148:151], v2 offset:13312
    v_mfma_f32_16x16x32_bf16 v[184:187], v[152:155], v[96:99], v[184:187]
    ds_read_b128 v[152:155], v2 offset:14336
    v_mfma_f32_16x16x32_bf16 v[188:191], v[156:159], v[96:99], v[188:191]
    ds_read_b128 v[156:159], v2 offset:15360
    s_waitcnt lgkmcnt(10)
    v_mfma_f32_16x16x32_bf16 v[192:195], v[160:163], v[96:99], v[192:195]
    ds_read_b128 v[160:163], v2 offset:16384
    v_mfma_f32_16x16x32_bf16 v[176:179], v[164:167], v[100:103], v[176:179]
    ds_read_b128 v[164:167], v2 offset:17408
    v_mfma_f32_16x16x32_bf16 v[180:183], v[168:171], v[100:103], v[180:183]
    ds_read_b128 v[168:171], v2 offset:18432
    s_waitcnt lgkmcnt(8)
    v_cmp_gt_u32 s[22:23], 15, v7
    v_mfma_f32_16x16x32_bf16 v[184:187], v[172:175], v[100:103], v[184:187]
    ds_read_b128 v[172:175], v2 offset:19456
    v_mov_b32 v8, 14
    v_mfma_f32_16x16x32_bf16 v[188:191], v[48:51], v[100:103], v[188:191]
    s_cmp_lg_u64 s[22:23], 0
    s_cbranch_scc1 Lw_20
Lw_20_ok:
    ds_read_b128 v[48:51], v2 offset:20480
    ds_write_b32 v15, v8
    v_mfma_f32_16x16x32_bf16 v[192:195], v[52:55], v[100:103], v[192:195]
    ds_read_b128 v[52:55], v2 offset:21504
    s_waitcnt lgkmcnt(10)
    v_cmp_gt_u32 vcc, 1, v26
    s_cbranch_vccnz La_21
La_21_ok:
    v_mfma_f32_16x16x32_bf16 v[176:179], v[56:59], v[104:107], v[176:179]
    ds_read_b128 v[56:59], v2 offset:22528
    v_readfirstlane_b32 s50, v26
    v_mfma_f32_16x16x32_bf16 v[180:183], v[60:63], v[104:107], v[180:183]
    ds_read_b128 v[60:63], v2 offset:23552
    s_waitcnt lgkmcnt(9)
    v_mfma_f32_16x16x32_bf16 v[184:187], v[144:147], v[104:107], v[184:187]
    ds_read_b128 v[144:147], v2 offset:24576
    v_mfma_f32_16x16x32_bf16 v[188:191], v[148:151], v[104:107], v[188:191]
    ds_read_b128 v[148:151], v2 offset:25600
    v_mfma_f32_16x16x32_bf16 v[192:195], v[152:155], v[104:107], v[192:195]
    ds_read_b128 v[152:155], v2 offset:26624
    v_mfma_f32_16x16x32_bf16 v[176:179], v[156:159], v[108:111], v[176:179]
    ds_read_b128 v[156:159], v2 offset:27648
    s_waitcnt lgkmcnt(9)
    v_mfma_f32_16x16x32_bf16 v[180:183], v[160:163], v[108:111], v[180:183]
    ds_read_b128 v[160:163], v2 offset:28672
    v_mfma_f32_16x16x32_bf16 v[184:187], v[164:167], v[108:111], v[184:187]
    ds_read_b128 v[164:167], v2 offset:29696
    v_mfma_f32_16x16x32_bf16 v[188:191], v[168:171], v[108:111], v[188:191]
    ds_read_b128 v[168:171], v2 offset:30720
    v_mfma_f32_16x16x32_bf16 v[192:195], v[172:175], v[108:111], v[192:195]
    ds_read_b128 v[172:175], v2 offset:31744
    ds_read_b32 v7, v6
    s_waitcnt lgkmcnt(9)
    v_mfma_f32_16x16x32_bf16 v[176:179], v[48:51], v[112:115], v[176:179]
    ds_read_b128 v[48:51], v2 offset:32768
    ds_read_b32 v25, v18 offset:0
    v_mfma_f32_16x16x32_bf16 v[180:183], v[52:55], v[112:115], v[180:183]
    ds_read_b128 v[52:55], v2 offset:33792
    v_mfma_f32_16x16x32_bf16 v[184:187], v[56:59], v[112:115], v[184:187]
    ds_read_b128 v[56:59], v2 offset:34816
    v_mfma_f32_16x16x32_bf16 v[188:191], v[60:63], v[112:115], v[188:191]
    ds_read_b128 v[60:63], v2 offset:35840
    s_waitcnt lgkmcnt(10)
    v_mfma_f32_16x16x32_bf16 v[192:195], v[144:147], v[112:115], v[192:195]
    ds_read_b128 v[144:147], v2 offset:36864
    v_mfma_f32_16x16x32_bf16 v[176:179], v[148:151], v[116:119], v[176:179]
    ds_read_b128 v[148:151], v2 offset:37888
    v_mfma_f32_16x16x32_bf16 v[180:183], v[152:155], v[116:119], v[180:183]
    ds_read_b128 v[152:155], v2 offset:38912
    s_waitcnt lgkmcnt(8)
    v_cmp_gt_u32 s[22:23], 16, v7
    v_mfma_f32_16x16x32_bf16 v[184:187], v[156:159], v[116:119], v[184:187]
    ds_read_b128 v[156:159], v2 offset:39936
    v_mfma_f32_16x16x32_bf16 v[188:191], v[160:163], v[116:119], v[188:191]
    s_cmp_lg_u64 s[22:23], 0
    s_cbranch_scc1 Lw_22
Lw_22_ok:
    ds_read_b128 v[160:163], v2 offset:40960
    v_mfma_f32_16x16x32_bf16 v[192:195], v[164:167], v[116:119], v[192:195]
    ds_read_b128 v[164:167], v2 offset:41984
    s_waitcnt lgkmcnt(9)
    v_cmp_gt_u32 vcc, 2, v25
    s_cbranch_vccnz La_23
La_23_ok:
    v_mfma_f32_16x16x32_bf16 v[176:179], v[168:171], v[120:123], v[176:179]
    ds_read_b128 v[168:171], v2 offset:43008
    ds_read_b128 v[38:41], v19
    v_mfma_f32_16x16x32_bf16 v[180:183], v[172:175], v[120:123], v[180:183]
    ds_read_b128 v[172:175], v2 offset:44032
    ds_read_b128 v[42:45], v19 offset:1024
    s_waitcnt lgkmcnt(10)
    v_mfma_f32_16x16x32_bf16 v[184:187], v[48:51], v[120:123], v[184:187]
    ds_read_b128 v[48:51], v2 offset:45056
    ds_read_b64 v[46:47], v21 offset:2048
    v_mfma_f32_16x16x32_bf16 v[188:191], v[52:55], v[120:123], v[188:191]
    ds_read_b128 v[52:55], v2 offset:46080
    ds_read_b64 v[230:231], v21 offset:2560
    v_mfma_f32_16x16x32_bf16 v[192:195], v[56:59], v[120:123], v[192:195]
    ds_read_b128 v[56:59], v2 offset:47104
    ds_read_b64 v[234:235], v21 offset:3072
    v_mfma_f32_16x16x32_bf16 v[176:179], v[60:63], v[124:127], v[176:179]
    ds_read_b128 v[60:63], v2 offset:48128
    ds_read_b64 v[238:239], v21 offset:3584
    s_waitcnt lgkmcnt(14)
    v_mfma_f32_16x16x32_bf16 v[180:183], v[144:147], v[124:127], v[180:183]
    ds_read_b128 v[144:147], v2 offset:49152
    ds_read_b64 v[242:243], v21 offset:4096
    v_mfma_f32_16x16x32_bf16 v[184:187], v[148:151], v[124:127], v[184:187]
    ds_read_b128 v[148:151], v2 offset:50176
    ds_read_b64 v[246:247], v21 offset:4608
    v_mfma_f32_16x16x32_bf16 v[188:191], v[152:155], v[124:127], v[188:191]
    ds_read_b128 v[152:155], v2 offset:51200
    v_mfma_f32_16x16x32_bf16 v[192:195], v[156:159], v[124:127], v[192:195]
    ds_read_b128 v[156:159], v2 offset:52224
    s_waitcnt lgkmcnt(15)
    v_mfma_f32_16x16x32_bf16 v[176:179], v[160:163], v[128:131], v[176:179]
    ds_read_b128 v[160:163], v2 offset:53248
    v_mfma_f32_16x16x32_bf16 v[180:183], v[164:167], v[128:131], v[180:183]
    ds_read_b128 v[164:167], v2 offset:54272
    v_mfma_f32_16x16x32_bf16 v[184:187], v[168:171], v[128:131], v[184:187]
    ds_read_b128 v[168:171], v2 offset:55296
    v_mfma_f32_16x16x32_bf16 v[188:191], v[172:175], v[128:131], v[188:191]
    ds_read_b128 v[172:175], v2 offset:56320
    s_waitcnt lgkmcnt(11)
    v_mfma_f32_16x16x32_bf16 v[192:195], v[48:51], v[128:131], v[192:195]
    ds_read_b128 v[48:51], v2 offset:57344
    v_mfma_f32_16x16x32_bf16 v[176:179], v[52:55], v[132:135], v[176:179]
    ds_read_b128 v[52:55], v2 offset:58368
    v_mfma_f32_16x16x32_bf16 v[180:183], v[56:59], v[132:135], v[180:183]
    ds_read_b128 v[56:59], v2 offset:59392
    v_mfma_f32_16x16x32_bf16 v[184:187], v[60:63], v[132:135], v[184:187]
    ds_read_b128 v[60:63], v2 offset:60416
    v_mov_b32 v8, 16
    ds_write_b32 v15, v8
    s_waitcnt lgkmcnt(9)
    v_mfma_f32_16x16x32_bf16 v[188:191], v[144:147], v[132:135], v[188:191]
    v_mfma_f32_16x16x32_bf16 v[192:195], v[148:151], v[132:135], v[192:195]
    v_mfma_f32_16x16x32_bf16 v[176:179], v[152:155], v[136:139], v[176:179]
    s_cmp_eq_u32 s40, 0
    s_cbranch_scc1 Lo_24
Lo_24_b:
    v_mfma_f32_16x16x32_bf16 v[180:183], v[156:159], v[136:139], v[180:183]
    s_waitcnt lgkmcnt(5)
    v_mfma_f32_16x16x32_bf16 v[184:187], v[160:163], v[136:139], v[184:187]
    v_mfma_f32_16x16x32_bf16 v[188:191], v[164:167], v[136:139], v[188:191]
    v_mfma_f32_16x16x32_bf16 v[192:195], v[168:171], v[136:139], v[192:195]
    v_mfma_f32_16x16x32_bf16 v[176:179], v[172:175], v[140:143], v[176:179]
    s_waitcnt lgkmcnt(1)
    v_mfma_f32_16x16x32_bf16 v[180:183], v[48:51], v[140:143], v[180:183]
    v_mfma_f32_16x16x32_bf16 v[184:187], v[52:55], v[140:143], v[184:187]
    v_mfma_f32_16x16x32_bf16 v[188:191], v[56:59], v[140:143], v[188:191]
    v_mfma_f32_16x16x32_bf16 v[192:195], v[60:63], v[140:143], v[192:195]
    s_nop 2
    v_cvt_pk_bf16_f32 v64, v176, v177
    v_cvt_pk_bf16_f32 v65, v178, v179
    v_cvt_pk_bf16_f32 v130, v180, v181
    v_cvt_pk_bf16_f32 v131, v182, v183
    v_cvt_pk_bf16_f32 v132, v184, v185
    v_cvt_pk_bf16_f32 v133, v186, v187
    v_cvt_pk_bf16_f32 v134, v188, v189
    v_cvt_pk_bf16_f32 v135, v190, v191
    v_cvt_pk_bf16_f32 v78, v192, v193
    v_cvt_pk_bf16_f32 v79, v194, v195
    v_cndmask_b32 v66, v130, 0, s[8:9]
    v_cndmask_b32 v67, v131, 0, s[8:9]
    v_cndmask_b32 v68, 0, v130, s[8:9]
    v_cndmask_b32 v70, v132, 0, s[10:11]
    v_cndmask_b32 v69, 0, v131, s[8:9]
    v_cndmask_b32 v71, v133, 0, s[10:11]
    v_cndmask_b32 v72, 0, v132, s[10:11]
    v_cndmask_b32 v74, v134, 0, s[12:13]
    v_cndmask_b32 v73, 0, v133, s[10:11]
    v_cndmask_b32 v75, v135, 0, s[12:13]
    v_cndmask_b32 v76, 0, v134, s[12:13]
    v_cndmask_b32 v77, 0, v135, s[12:13]
    v_mfma_f32_16x16x32_bf16 v[80:83], v[28:31], v[64:67], 0
    v_mfma_f32_16x16x32_bf16 v[96:99], v[38:41], v[64:67], v[252:255]
    v_mfma_f32_16x16x32_bf16 v[84:87], v[30:33], v[68:71], 0
    v_mfma_f32_16x16x32_bf16 v[100:103], v[40:43], v[68:71], v[252:255]
    v_mfma_f32_16x16x32_bf16 v[88:91], v[32:35], v[72:75], 0
    v_mfma_f32_16x16x32_bf16 v[104:107], v[42:45], v[72:75], v[252:255]
    v_mfma_f32_16x16x32_bf16 v[92:95], v[34:37], v[76:79], 0
    v_mfma_f32_16x16x32_bf16 v[108:111], v[44:47], v[76:79], v[252:255]
    s_mov_b32 s58, 0x3ea52b5c
    v_cndmask_b32 v80, v80, v81, s[68:69]
    v_cndmask_b32 v96, v96, v97, s[68:69]
    v_cndmask_b32 v82, v82, v83, s[68:69]
    v_cndmask_b32 v98, v98, v99, s[68:69]
    v_cndmask_b32 v128, v96, v80, s[64:65]
    v_cndmask_b32 v132, v98, v82, s[66:67]
    v_max_f32 v136, v128, v132
    v_cndmask_b32 v84, v84, v85, s[68:69]
    v_cndmask_b32 v100, v100, v101, s[68:69]
    v_cndmask_b32 v86, v86, v87, s[68:69]
    v_cndmask_b32 v102, v102, v103, s[68:69]
    v_cndmask_b32 v129, v100, v84, s[64:65]
    v_cndmask_b32 v133, v102, v86, s[66:67]
    v_max_f32 v137, v129, v133
    v_cndmask_b32 v88, v88, v89, s[68:69]
    v_cndmask_b32 v104, v104, v105, s[68:69]
    v_cndmask_b32 v90, v90, v91, s[68:69]
    v_cndmask_b32 v106, v106, v107, s[68:69]
    v_cndmask_b32 v130, v104, v88, s[64:65]
    v_cndmask_b32 v134, v106, v90, s[66:67]
    v_max_f32 v138, v130, v134
    v_cndmask_b32 v92, v92, v93, s[68:69]
    v_cndmask_b32 v108, v108, v109, s[68:69]
    v_cndmask_b32 v94, v94, v95, s[68:69]
    v_cndmask_b32 v110, v110, v111, s[68:69]
    v_cndmask_b32 v131, v108, v92, s[64:65]
    v_cndmask_b32 v135, v110, v94, s[66:67]
    v_max_f32 v139, v131, v135
    v_permlane32_swap_b32 v136, v138
    s_nop 0
    v_permlane32_swap_b32 v137, v139
    v_max_f32 v136, v136, v138
    v_max_f32 v137, v137, v139
    s_nop 1
    v_permlane16_swap_b32 v136, v137
    v_max_f32 v136, v136, v137
    v_mul_f32 v136, s58, v136
    v_mov_b32 v137, v136
    s_nop 1
    v_permlane16_swap_b32 v136, v137
    v_mov_b32 v138, v136
    v_mov_b32 v139, v137
    s_nop 0
    v_permlane32_swap_b32 v136, v138
    v_permlane32_swap_b32 v137, v139
    v_fma_f32 v128, v128, s58, -v136
    v_fma_f32 v132, v132, s58, -v136
    v_fma_f32 v129, v129, s58, -v137
    v_fma_f32 v133, v133, s58, -v137
    v_fma_f32 v130, v130, s58, -v138
    v_fma_f32 v134, v134, s58, -v138
    v_fma_f32 v131, v131, s58, -v139
    v_fma_f32 v135, v135, s58, -v139
    v_exp_f32 v128, v128
    v_exp_f32 v132, v132
    v_exp_f32 v129, v129
    v_exp_f32 v133, v133
    v_exp_f32 v130, v130
    v_exp_f32 v134, v134
    v_exp_f32 v131, v131
    v_exp_f32 v135, v135
    v_add_f32 v136, v128, v132
    v_add_f32 v137, v129, v133
    v_add_f32 v138, v130, v134
    v_add_f32 v139, v131, v135
    s_nop 0
    v_permlane32_swap_b32 v136, v138
    v_permlane32_swap_b32 v137, v139
    v_add_f32 v136, v136, v138
    v_add_f32 v137, v137, v139
    s_nop 1
    v_permlane16_swap_b32 v136, v137
    v_add_f32 v136, v136, v137
    v_rcp_f32 v136, v136
    s_nop 0
    v_mov_b32 v137, v136
    s_nop 1
    v_permlane16_swap_b32 v136, v137
    v_mov_b32 v138, v136
    v_mov_b32 v139, v137
    s_nop 0
    v_permlane32_swap_b32 v136, v138
    v_permlane32_swap_b32 v137, v139
    v_mul_f32 v128, v128, v136
    v_mul_f32 v132, v132, v136
    v_cvt_pk_bf16_f32 v128, v128, v128
    v_cvt_pk_bf16_f32 v132, v132, v132
    v_and_b32 v112, v128, v248
    v_and_b32 v113, v132, v249
    v_and_b32 v114, v128, v250
    v_and_b32 v115, v132, v251
    v_mul_f32 v129, v129, v137
    v_mul_f32 v133, v133, v137
    v_cvt_pk_bf16_f32 v129, v129, v129
    v_cvt_pk_bf16_f32 v133, v133, v133
    v_and_b32 v116, v129, v248
    v_and_b32 v117, v133, v249
    v_and_b32 v118, v129, v250
    v_and_b32 v119, v133, v251
    v_mul_f32 v130, v130, v138
    v_mul_f32 v134, v134, v138
    v_cvt_pk_bf16_f32 v130, v130, v130
    v_cvt_pk_bf16_f32 v134, v134, v134
    v_and_b32 v120, v130, v248
    v_and_b32 v121, v134, v249
    v_and_b32 v122, v130, v250
    v_and_b32 v123, v134, v251
    v_mul_f32 v131, v131, v139
    v_mul_f32 v135, v135, v139
    v_cvt_pk_bf16_f32 v131, v131, v131
    v_cvt_pk_bf16_f32 v135, v135, v135
    v_and_b32 v124, v131, v248
    v_and_b32 v125, v135, v249
    v_and_b32 v126, v131, v250
    v_and_b32 v127, v135, v251
    s_cmp_eq_u32 s40, 0
    s_cbranch_scc1 Lo_25
Lo_25_b:
    v_mfma_f32_16x16x32_bf16 v[176:179], v[228:231], v[112:115], 0
    v_mfma_f32_16x16x32_bf16 v[80:83], v[232:235], v[112:115], 0
    v_mfma_f32_16x16x32_bf16 v[180:183], v[232:235], v[116:119], 0
    v_mfma_f32_16x16x32_bf16 v[84:87], v[236:239], v[116:119], 0
    v_mfma_f32_16x16x32_bf16 v[184:187], v[236:239], v[120:123], 0
    v_mfma_f32_16x16x32_bf16 v[88:91], v[240:243], v[120:123], 0
    v_mfma_f32_16x16x32_bf16 v[188:191], v[240:243], v[124:127], 0
    v_mfma_f32_16x16x32_bf16 v[192:195], v[244:247], v[124:127], 0
    v_mov_b32 v8, 17
    ds_write_b32 v15, v8
    v_cvt_pk_bf16_f32 v228, v176, v177
    v_cvt_pk_bf16_f32 v229, v178, v179
    v_cndmask_b32 v180, v80, v180, s[8:9]
    v_cndmask_b32 v181, v81, v181, s[8:9]
    v_cndmask_b32 v182, v82, v182, s[8:9]
    v_cndmask_b32 v183, v83, v183, s[8:9]
    v_cvt_pk_bf16_f32 v230, v180, v181
    v_cvt_pk_bf16_f32 v231, v182, v183
    v_cndmask_b32 v184, v84, v184, s[10:11]
    v_cndmask_b32 v185, v85, v185, s[10:11]
    v_cndmask_b32 v186, v86, v186, s[10:11]
    v_cndmask_b32 v187, v87, v187, s[10:11]
    v_cvt_pk_bf16_f32 v232, v184, v185
    v_cvt_pk_bf16_f32 v233, v186, v187
    v_cndmask_b32 v188, v88, v188, s[12:13]
    v_cndmask_b32 v189, v89, v189, s[12:13]
    v_cndmask_b32 v190, v90, v190, s[12:13]
    v_cndmask_b32 v191, v91, v191, s[12:13]
    v_cvt_pk_bf16_f32 v234, v188, v189
    v_cvt_pk_bf16_f32 v235, v190, v191
    v_cvt_pk_bf16_f32 v236, v192, v193
    v_cvt_pk_bf16_f32 v237, v194, v195
    s_add_u32 s57, s56, 0
    s_cmp_lg_u32 s50, 1
    s_cbranch_scc1 Lm_26
    buffer_store_dwordx4 v[228:231], v2, s[28:31], s57 offen
    buffer_store_dwordx4 v[232:235], v2, s[28:31], s57 offen offset:1024
    buffer_store_dwordx2 v[236:237], v3, s[28:31], s57 offen offset:2048
Lm_26_b:
    v_add_u32 v18, s55, v2
    s_add_u32 s58, s55, 2048
    v_add_u32 v19, s58, v3
    v_and_b32 v20, 7, v1
    v_lshlrev_b32 v20, 3, v20
    v_add_u32 v20, s55, v20
    s_waitcnt vmcnt(0)
    s_lshl_b32 s57, s43, 3
    s_add_u32 s57, s57, s55
    s_add_u32 s57, s57, 110592
    s_mov_b64 exec, 1
    s_cmp_lg_u32 s50, 1
    s_cbranch_scc1 Lm_27
    buffer_store_dwordx2 v[12:13], v14, s[28:31], s57 offen
Lm_27_b:
    s_mov_b64 exec, -1
L_P2:
    s_setprio 3
Lsp_28:
    ds_read_b32 v7, v6 offset:0
    s_waitcnt lgkmcnt(0)
    v_cmp_gt_u32 vcc, 18, v7
    s_cbranch_vccz Lsp_28_ok
    s_cmp_eq_u32 s46, 0
    s_cbranch_scc1 Lsp_28_ok
    s_sub_u32 s46, s46, 1
    s_branch Lsp_28
Lsp_28_ok:
    ds_read_b128 v[144:147], v5 offset:11264
    ds_read_b128 v[148:151], v5 offset:12288
    ds_read_b128 v[152:155], v5 offset:13312
    ds_read_b128 v[156:159], v5 offset:14336
    ds_read_b128 v[160:163], v5 offset:15360
    ds_read_b128 v[164:167], v5 offset:16384
    ds_read_b128 v[168:171], v5 offset:17408
    ds_read_b128 v[172:175], v5 offset:18432
    ds_read_b128 v[36:39], v5 offset:19456
    ds_read_b128 v[40:43], v5 offset:20480
    ds_read_b128 v[56:59], v5 offset:21504
    ds_read_b128 v[60:63], v5 offset:22528
    v_lshlrev_b32 v176, 16, v218
    v_and_b32 v177, 0xffff0000, v218
    v_lshlrev_b32 v178, 16, v219
    v_and_b32 v179, 0xffff0000, v219
    v_lshlrev_b32 v180, 16, v220
    v_and_b32 v181, 0xffff0000, v220
    v_lshlrev_b32 v182, 16, v221
    v_and_b32 v183, 0xffff0000, v221
    v_lshlrev_b32 v184, 16, v222
    v_and_b32 v185, 0xffff0000, v222
    v_lshlrev_b32 v186, 16, v223
    v_and_b32 v187, 0xffff0000, v223
    v_lshlrev_b32 v188, 16, v224
    v_and_b32 v189, 0xffff0000, v224
    v_lshlrev_b32 v190, 16, v225
    v_and_b32 v191, 0xffff0000, v225
    v_lshlrev_b32 v192, 16, v226
    v_and_b32 v193, 0xffff0000, v226
    v_lshlrev_b32 v194, 16, v227
    v_and_b32 v195, 0xffff0000, v227
    s_mov_b32 s58, 110592
Lp_29:
    buffer_load_dwordx2 v[240:241], v20, s[28:31], s58 offen offset:0 sc1
    s_waitcnt vmcnt(0)
    v_cmp_ne_u64 vcc, s[48:49], v[240:241]
    s_cbranch_vccz Lp_29_ok
    s_cmp_eq_u32 s46, 0
    s_cbranch_scc1 Lp_29_ok
    s_sub_u32 s46, s46, 1
    s_branch Lp_29
Lp_29_ok:
    s_mul_i32 s57, s51, 5120
    s_add_u32 s57, s57, 0
    buffer_load_dwordx4 v[64:67], v18, s[28:31], s57 offen offset:0 sc1
    buffer_load_dwordx4 v[68:71], v18, s[28:31], s57 offen offset:1024 sc1
    buffer_load_dwordx4 v[72:75], v18, s[28:31], s57 offen offset:2560 sc1
    buffer_load_dwordx4 v[76:79], v18, s[28:31], s57 offen offset:3584 sc1
    buffer_load_dwordx2 v[80:81], v19, s[28:31], s57 offen sc1
    buffer_load_dwordx2 v[82:83], v19, s[28:31], s57 offen offset:2560 sc1
    s_mul_i32 s57, s52, 5120
    s_add_u32 s57, s57, 0
    buffer_load_dwordx4 v[84:87], v18, s[28:31], s57 offen offset:0 sc1
    buffer_load_dwordx4 v[88:91], v18, s[28:31], s57 offen offset:1024 sc1
    buffer_load_dwordx4 v[92:95], v18, s[28:31], s57 offen offset:2560 sc1
    buffer_load_dwordx4 v[96:99], v18, s[28:31], s57 offen offset:3584 sc1
    buffer_load_dwordx2 v[100:101], v19, s[28:31], s57 offen sc1
    buffer_load_dwordx2 v[102:103], v19, s[28:31], s57 offen offset:2560 sc1
    s_mul_i32 s57, s53, 5120
    s_add_u32 s57, s57, 0
    buffer_load_dwordx4 v[104:107], v18, s[28:31], s57 offen offset:0 sc1
    buffer_load_dwordx4 v[108:111], v18, s[28:31], s57 offen offset:1024 sc1
    buffer_load_dwordx4 v[112:115], v18, s[28:31], s57 offen offset:2560 sc1
    buffer_load_dwordx4 v[116:119], v18, s[28:31], s57 offen offset:3584 sc1
    buffer_load_dwordx2 v[120:121], v19, s[28:31], s57 offen sc1
    buffer_load_dwordx2 v[122:123], v19, s[28:31], s57 offen offset:2560 sc1
    s_mul_i32 s57, s54, 5120
    s_add_u32 s57, s57, 0
    buffer_load_dwordx4 v[124:127], v18, s[28:31], s57 offen offset:0 sc1
    buffer_load_dwordx4 v[128:131], v18, s[28:31], s57 offen offset:1024 sc1
    buffer_load_dwordx4 v[132:135], v18, s[28:31], s57 offen offset:2560 sc1
    buffer_load_dwordx4 v[136:139], v18, s[28:31], s57 offen offset:3584 sc1
    buffer_load_dwordx2 v[140:141], v19, s[28:31], s57 offen sc1
    buffer_load_dwordx2 v[142:143], v19, s[28:31], s57 offen offset:2560 sc1
    s_waitcnt vmcnt(23)
    s_waitcnt lgkmcnt(8)
    v_mfma_f32_16x16x32_bf16 v[176:179], v[144:147], v[64:67], v[176:179]
    ds_read_b128 v[144:147], v5 offset:23552
    v_mfma_f32_16x16x32_bf16 v[180:183], v[148:151], v[64:67], v[180:183]
    ds_read_b128 v[148:151], v5 offset:24576
    v_mfma_f32_16x16x32_bf16 v[184:187], v[152:155], v[64:67], v[184:187]
    ds_read_b128 v[152:155], v5 offset:25600
    v_mfma_f32_16x16x32_bf16 v[188:191], v[156:159], v[64:67], v[188:191]
    ds_read_b128 v[156:159], v5 offset:26624
    s_waitcnt lgkmcnt(8)
    v_mfma_f32_16x16x32_bf16 v[192:195], v[160:163], v[64:67], v[192:195]
    ds_read_b128 v[160:163], v5 offset:27648
    ds_read_b32 v7, v6
    s_waitcnt vmcnt(22)
    v_mfma_f32_16x16x32_bf16 v[176:179], v[164:167], v[68:71], v[176:179]
    ds_read_b128 v[164:167], v5 offset:28672
    v_mfma_f32_16x16x32_bf16 v[180:183], v[168:171], v[68:71], v[180:183]
    ds_read_b128 v[168:171], v5 offset:29696
    v_mfma_f32_16x16x32_bf16 v[184:187], v[172:175], v[68:71], v[184:187]
    ds_read_b128 v[172:175], v5 offset:30720
    s_waitcnt lgkmcnt(9)
    v_mfma_f32_16x16x32_bf16 v[188:191], v[36:39], v[68:71], v[188:191]
    ds_read_b128 v[36:39], v5 offset:31744
    v_mfma_f32_16x16x32_bf16 v[192:195], v[40:43], v[68:71], v[192:195]
    ds_read_b128 v[40:43], v5 offset:32768
    s_waitcnt vmcnt(21)
    v_mfma_f32_16x16x32_bf16 v[176:179], v[56:59], v[72:75], v[176:179]
    ds_read_b128 v[56:59], v5 offset:33792
    v_mfma_f32_16x16x32_bf16 v[180:183], v[60:63], v[72:75], v[180:183]
    ds_read_b128 v[60:63], v5 offset:34816
    s_waitcnt lgkmcnt(7)
    v_cmp_gt_u32 s[22:23], 19, v7
    v_mfma_f32_16x16x32_bf16 v[184:187], v[144:147], v[72:75], v[184:187]
    ds_read_b128 v[144:147], v5 offset:35840
    v_mov_b32 v8, 18
    v_mfma_f32_16x16x32_bf16 v[188:191], v[148:151], v[72:75], v[188:191]
    s_cmp_lg_u64 s[22:23], 0
    s_cbranch_scc1 Lw_30
Lw_30_ok:
    ds_read_b128 v[148:151], v5 offset:36864
    ds_write_b32 v15, v8
    v_mfma_f32_16x16x32_bf16 v[192:195], v[152:155], v[72:75], v[192:195]
    ds_read_b128 v[152:155], v5 offset:37888
    s_waitcnt vmcnt(20)
    v_mfma_f32_16x16x32_bf16 v[176:179], v[156:159], v[76:79], v[176:179]
    ds_read_b128 v[156:159], v5 offset:38912
    s_waitcnt lgkmcnt(9)
    v_mfma_f32_16x16x32_bf16 v[180:183], v[160:163], v[76:79], v[180:183]
    ds_read_b128 v[160:163], v5 offset:39936
    v_mfma_f32_16x16x32_bf16 v[184:187], v[164:167], v[76:79], v[184:187]
    ds_read_b128 v[164:167], v5 offset:40960
    v_mfma_f32_16x16x32_bf16 v[188:191], v[168:171], v[76:79], v[188:191]
    ds_read_b128 v[168:171], v5 offset:41984
    v_mfma_f32_16x16x32_bf16 v[192:195], v[172:175], v[76:79], v[192:195]
    ds_read_b128 v[172:175], v5 offset:43008
    s_waitcnt vmcnt(18)
    s_waitcnt lgkmcnt(9)
    v_mfma_f32_16x16x32_bf16 v[176:179], v[36:39], v[80:83], v[176:179]
    ds_read_b128 v[36:39], v5 offset:44032
    v_mfma_f32_16x16x32_bf16 v[180:183], v[40:43], v[80:83], v[180:183]
    ds_read_b128 v[40:43], v5 offset:45056
    v_mfma_f32_16x16x32_bf16 v[184:187], v[56:59], v[80:83], v[184:187]
    ds_read_b128 v[56:59], v5 offset:46080
    v_mfma_f32_16x16x32_bf16 v[188:191], v[60:63], v[80:83], v[188:191]
    ds_read_b128 v[60:63], v5 offset:47104
    s_waitcnt lgkmcnt(8)
    v_mfma_f32_16x16x32_bf16 v[192:195], v[144:147], v[80:83], v[192:195]
    ds_read_b128 v[144:147], v5 offset:48128
    s_waitcnt vmcnt(17)
    v_mfma_f32_16x16x32_bf16 v[176:179], v[148:151], v[84:87], v[176:179]
    ds_read_b128 v[148:151], v5 offset:49152
    v_mfma_f32_16x16x32_bf16 v[180:183], v[152:155], v[84:87], v[180:183]
    ds_read_b128 v[152:155], v5 offset:50176
    v_mfma_f32_16x16x32_bf16 v[184:187], v[156:159], v[84:87], v[184:187]
    ds_read_b128 v[156:159], v5 offset:51200
    s_waitcnt lgkmcnt(8)
    v_mfma_f32_16x16x32_bf16 v[188:191], v[160:163], v[84:87], v[188:191]
    ds_read_b128 v[160:163], v5 offset:52224
    v_mfma_f32_16x16x32_bf16 v[192:195], v[164:167], v[84:87], v[192:195]
    ds_read_b128 v[164:167], v5 offset:53248
    ds_read_b32 v7, v6
    s_waitcnt vmcnt(16)
    v_mfma_f32_16x16x32_bf16 v[176:179], v[168:171], v[88:91], v[176:179]
    ds_read_b128 v[168:171], v5 offset:54272
    v_mfma_f32_16x16x32_bf16 v[180:183], v[172:175], v[88:91], v[180:183]
    ds_read_b128 v[172:175], v5 offset:55296
    s_waitcnt lgkmcnt(9)
    v_mfma_f32_16x16x32_bf16 v[184:187], v[36:39], v[88:91], v[184:187]
    ds_read_b128 v[36:39], v5 offset:56320
    v_mfma_f32_16x16x32_bf16 v[188:191], v[40:43], v[88:91], v[188:191]
    ds_read_b128 v[40:43], v5 offset:57344
    v_mfma_f32_16x16x32_bf16 v[192:195], v[56:59], v[88:91], v[192:195]
    ds_read_b128 v[56:59], v5 offset:58368
    s_waitcnt vmcnt(15)
    v_mfma_f32_16x16x32_bf16 v[176:179], v[60:63], v[92:95], v[176:179]
    ds_read_b128 v[60:63], v5 offset:59392
    s_waitcnt lgkmcnt(9)
    v_mfma_f32_16x16x32_bf16 v[180:183], v[144:147], v[92:95], v[180:183]
    ds_read_b128 v[144:147], v5 offset:60416
    s_waitcnt lgkmcnt(7)
    v_cmp_gt_u32 s[22:23], 20, v7
    v_mfma_f32_16x16x32_bf16 v[184:187], v[148:151], v[92:95], v[184:187]
    ds_read_b128 v[148:151], v5 offset:61440
    v_mfma_f32_16x16x32_bf16 v[188:191], v[152:155], v[92:95], v[188:191]
    s_cmp_lg_u64 s[22:23], 0
    s_cbranch_scc1 Lw_31
Lw_31_ok:
    ds_read_b128 v[152:155], v2 offset:0
    v_mfma_f32_16x16x32_bf16 v[192:195], v[156:159], v[92:95], v[192:195]
    ds_read_b128 v[156:159], v2 offset:1024
    s_waitcnt vmcnt(14)
    s_waitcnt lgkmcnt(8)
    v_mfma_f32_16x16x32_bf16 v[176:179], v[160:163], v[96:99], v[176:179]
    ds_read_b128 v[160:163], v2 offset:2048
    v_mfma_f32_16x16x32_bf16 v[180:183], v[164:167], v[96:99], v[180:183]
    ds_read_b128 v[164:167], v2 offset:3072
    v_mfma_f32_16x16x32_bf16 v[184:187], v[168:171], v[96:99], v[184:187]
    ds_read_b128 v[168:171], v2 offset:4096
    v_mfma_f32_16x16x32_bf16 v[188:191], v[172:175], v[96:99], v[188:191]
    ds_read_b128 v[172:175], v2 offset:5120
    s_waitcnt lgkmcnt(8)
    v_mfma_f32_16x16x32_bf16 v[192:195], v[36:39], v[96:99], v[192:195]
    ds_read_b128 v[36:39], v2 offset:6144
    s_waitcnt vmcnt(12)
    v_mfma_f32_16x16x32_bf16 v[176:179], v[40:43], v[100:103], v[176:179]
    ds_read_b128 v[40:43], v2 offset:7168
    v_mfma_f32_16x16x32_bf16 v[180:183], v[56:59], v[100:103], v[180:183]
    ds_read_b128 v[56:59], v2 offset:8192
    v_mfma_f32_16x16x32_bf16 v[184:187], v[60:63], v[100:103], v[184:187]
    ds_read_b128 v[60:63], v2 offset:9216
    s_waitcnt lgkmcnt(8)
    v_mfma_f32_16x16x32_bf16 v[188:191], v[144:147], v[100:103], v[188:191]
    ds_read_b128 v[144:147], v2 offset:10240
    v_mfma_f32_16x16x32_bf16 v[192:195], v[148:151], v[100:103], v[192:195]
    ds_read_b128 v[148:151], v2 offset:11264
    s_waitcnt vmcnt(11)
    v_mfma_f32_16x16x32_bf16 v[176:179], v[152:155], v[104:107], v[176:179]
    ds_read_b128 v[152:155], v2 offset:12288
    v_mfma_f32_16x16x32_bf16 v[180:183], v[156:159], v[104:107], v[180:183]
    ds_read_b128 v[156:159], v2 offset:13312
    s_waitcnt lgkmcnt(8)
    v_mfma_f32_16x16x32_bf16 v[184:187], v[160:163], v[104:107], v[184:187]
    ds_read_b128 v[160:163], v2 offset:14336
    v_mfma_f32_16x16x32_bf16 v[188:191], v[164:167], v[104:107], v[188:191]
    ds_read_b128 v[164:167], v2 offset:15360
    v_mfma_f32_16x16x32_bf16 v[192:195], v[168:171], v[104:107], v[192:195]
    ds_read_b128 v[168:171], v2 offset:16384
    ds_read_b32 v7, v6
    s_waitcnt vmcnt(10)
    v_mfma_f32_16x16x32_bf16 v[176:179], v[172:175], v[108:111], v[176:179]
    ds_read_b128 v[172:175], v2 offset:17408
    s_waitcnt lgkmcnt(9)
    v_mfma_f32_16x16x32_bf16 v[180:183], v[36:39], v[108:111], v[180:183]
    ds_read_b128 v[36:39], v2 offset:18432
    v_mfma_f32_16x16x32_bf16 v[184:187], v[40:43], v[108:111], v[184:187]
    ds_read_b128 v[40:43], v2 offset:19456
    v_mfma_f32_16x16x32_bf16 v[188:191], v[56:59], v[108:111], v[188:191]
    ds_read_b128 v[56:59], v2 offset:20480
    v_mfma_f32_16x16x32_bf16 v[192:195], v[60:63], v[108:111], v[192:195]
    ds_read_b128 v[60:63], v2 offset:21504
    s_waitcnt vmcnt(9)
    s_waitcnt lgkmcnt(9)
    v_mfma_f32_16x16x32_bf16 v[176:179], v[144:147], v[112:115], v[176:179]
    ds_read_b128 v[144:147], v2 offset:22528
    v_mfma_f32_16x16x32_bf16 v[180:183], v[148:151], v[112:115], v[180:183]
    ds_read_b128 v[148:151], v2 offset:23552
    s_waitcnt lgkmcnt(7)
    v_cmp_gt_u32 s[22:23], 21, v7
    v_mfma_f32_16x16x32_bf16 v[184:187], v[152:155], v[112:115], v[184:187]
    ds_read_b128 v[152:155], v2 offset:24576
    v_mov_b32 v8, 20
    v_mfma_f32_16x16x32_bf16 v[188:191], v[156:159], v[112:115], v[188:191]
    s_cmp_lg_u64 s[22:23], 0
    s_cbranch_scc1 Lw_32
Lw_32_ok:
    ds_read_b128 v[156:159], v2 offset:25600
    ds_write_b32 v15, v8
    s_waitcnt lgkmcnt(9)
    v_mfma_f32_16x16x32_bf16 v[192:195], v[160:163], v[112:115], v[192:195]
    ds_read_b128 v[160:163], v2 offset:26624
    s_waitcnt vmcnt(8)
    v_mfma_f32_16x16x32_bf16 v[176:179], v[164:167], v[116:119], v[176:179]
    ds_read_b128 v[164:167], v2 offset:27648
    v_mfma_f32_16x16x32_bf16 v[180:183], v[168:171], v[116:119], v[180:183]
    ds_read_b128 v[168:171], v2 offset:28672
    v_mfma_f32_16x16x32_bf16 v[184:187], v[172:175], v[116:119], v[184:187]
    ds_read_b128 v[172:175], v2 offset:29696
    s_waitcnt lgkmcnt(9)
    v_mfma_f32_16x16x32_bf16 v[188:191], v[36:39], v[116:119], v[188:191]
    ds_read_b128 v[36:39], v2 offset:30720
    v_mfma_f32_16x16x32_bf16 v[192:195], v[40:43], v[116:119], v[192:195]
    ds_read_b128 v[40:43], v2 offset:31744
    s_waitcnt vmcnt(6)
    v_mfma_f32_16x16x32_bf16 v[176:179], v[56:59], v[120:123], v[176:179]
    ds_read_b128 v[56:59], v2 offset:32768
    v_mfma_f32_16x16x32_bf16 v[180:183], v[60:63], v[120:123], v[180:183]
    ds_read_b128 v[60:63], v2 offset:33792
    s_waitcnt lgkmcnt(9)
    v_mfma_f32_16x16x32_bf16 v[184:187], v[144:147], v[120:123], v[184:187]
    ds_read_b128 v[144:147], v2 offset:34816
    v_mfma_f32_16x16x32_bf16 v[188:191], v[148:151], v[120:123], v[188:191]
    ds_read_b128 v[148:151], v2 offset:35840
    v_mfma_f32_16x16x32_bf16 v[192:195], v[152:155], v[120:123], v[192:195]
    ds_read_b128 v[152:155], v2 offset:36864
    s_waitcnt vmcnt(5)
    v_mfma_f32_16x16x32_bf16 v[176:179], v[156:159], v[124:127], v[176:179]
    ds_read_b128 v[156:159], v2 offset:37888
    s_waitcnt lgkmcnt(8)
    v_mfma_f32_16x16x32_bf16 v[180:183], v[160:163], v[124:127], v[180:183]
    ds_read_b128 v[160:163], v2 offset:38912
    v_mfma_f32_16x16x32_bf16 v[184:187], v[164:167], v[124:127], v[184:187]
    ds_read_b128 v[164:167], v2 offset:39936
    v_mfma_f32_16x16x32_bf16 v[188:191], v[168:171], v[124:127], v[188:191]
    ds_read_b128 v[168:171], v2 offset:40960
    v_mfma_f32_16x16x32_bf16 v[192:195], v[172:175], v[124:127], v[192:195]
    ds_read_b128 v[172:175], v2 offset:41984
    s_waitcnt vmcnt(4)
    s_waitcnt lgkmcnt(8)
    v_mfma_f32_16x16x32_bf16 v[176:179], v[36:39], v[128:131], v[176:179]
    ds_read_b128 v[36:39], v2 offset:43008
    v_mfma_f32_16x16x32_bf16 v[180:183], v[40:43], v[128:131], v[180:183]
    ds_read_b128 v[40:43], v2 offset:44032
    v_mfma_f32_16x16x32_bf16 v[184:187], v[56:59], v[128:131], v[184:187]
    ds_read_b128 v[56:59], v2 offset:45056
    v_mfma_f32_16x16x32_bf16 v[188:191], v[60:63], v[128:131], v[188:191]
    ds_read_b128 v[60:63], v2 offset:46080
    s_waitcnt lgkmcnt(8)
    v_mfma_f32_16x16x32_bf16 v[192:195], v[144:147], v[128:131], v[192:195]
    ds_read_b128 v[144:147], v2 offset:47104
    s_waitcnt vmcnt(3)
    v_mfma_f32_16x16x32_bf16 v[176:179], v[148:151], v[132:135], v[176:179]
    ds_read_b128 v[148:151], v2 offset:48128
    v_mfma_f32_16x16x32_bf16 v[180:183], v[152:155], v[132:135], v[180:183]
    ds_read_b128 v[152:155], v2 offset:49152
    v_mfma_f32_16x16x32_bf16 v[184:187], v[156:159], v[132:135], v[184:187]
    ds_read_b128 v[156:159], v2 offset:50176
    s_waitcnt lgkmcnt(8)
    v_mfma_f32_16x16x32_bf16 v[188:191], v[160:163], v[132:135], v[188:191]
    v_mfma_f32_16x16x32_bf16 v[192:195], v[164:167], v[132:135], v[192:195]
    s_waitcnt vmcnt(2)
    v_mfma_f32_16x16x32_bf16 v[176:179], v[168:171], v[136:139], v[176:179]
    v_mfma_f32_16x16x32_bf16 v[180:183], v[172:175], v[136:139], v[180:183]
    s_waitcnt lgkmcnt(4)
    v_mfma_f32_16x16x32_bf16 v[184:187], v[36:39], v[136:139], v[184:187]
    v_mfma_f32_16x16x32_bf16 v[188:191], v[40:43], v[136:139], v[188:191]
    v_mfma_f32_16x16x32_bf16 v[192:195], v[56:59], v[136:139], v[192:195]
    s_waitcnt vmcnt(0)
    v_mfma_f32_16x16x32_bf16 v[176:179], v[60:63], v[140:143], v[176:179]
    s_waitcnt lgkmcnt(0)
    v_mfma_f32_16x16x32_bf16 v[180:183], v[144:147], v[140:143], v[180:183]
    v_mfma_f32_16x16x32_bf16 v[184:187], v[148:151], v[140:143], v[184:187]
    v_mfma_f32_16x16x32_bf16 v[188:191], v[152:155], v[140:143], v[188:191]
    v_mfma_f32_16x16x32_bf16 v[192:195], v[156:159], v[140:143], v[192:195]
    s_nop 2
    v_cvt_pk_bf16_f32 v208, v176, v177
    v_cvt_pk_bf16_f32 v209, v178, v179
    v_cvt_pk_bf16_f32 v210, v180, v181
    v_cvt_pk_bf16_f32 v211, v182, v183
    v_cvt_pk_bf16_f32 v212, v184, v185
    v_cvt_pk_bf16_f32 v213, v186, v187
    v_cvt_pk_bf16_f32 v214, v188, v189
    v_cvt_pk_bf16_f32 v215, v190, v191
    v_cvt_pk_bf16_f32 v216, v192, v193
    v_cvt_pk_bf16_f32 v217, v194, v195
    s_add_u32 s57, s56, 20480
    s_cmp_lg_u32 s50, 1
    s_cbranch_scc1 Lm_33
    buffer_store_dwordx4 v[208:211], v2, s[28:31], s57 offen
    buffer_store_dwordx4 v[212:215], v2, s[28:31], s57 offen offset:1024
    buffer_store_dwordx2 v[216:217], v3, s[28:31], s57 offen offset:2048
Lm_33_b:
    v_mov_b32 v240, 0
    v_mov_b32 v241, 0
    v_dot2c_f32_bf16 v240, s72, v208
    v_dot2c_f32_bf16 v241, v208, v208
    v_dot2c_f32_bf16 v240, s72, v209
    v_dot2c_f32_bf16 v241, v209, v209
    v_dot2c_f32_bf16 v240, s72, v210
    v_dot2c_f32_bf16 v241, v210, v210
    v_dot2c_f32_bf16 v240, s72, v211
    v_dot2c_f32_bf16 v241, v211, v211
    v_dot2c_f32_bf16 v240, s72, v212
    v_dot2c_f32_bf16 v241, v212, v212
    v_dot2c_f32_bf16 v240, s72, v213
    v_dot2c_f32_bf16 v241, v213, v213
    v_dot2c_f32_bf16 v240, s72, v214
    v_dot2c_f32_bf16 v241, v214, v214
    v_dot2c_f32_bf16 v240, s72, v215
    v_dot2c_f32_bf16 v241, v215, v215
    v_dot2c_f32_bf16 v240, s72, v216
    v_dot2c_f32_bf16 v241, v216, v216
    v_dot2c_f32_bf16 v240, s72, v217
    v_dot2c_f32_bf16 v241, v217, v217
    s_nop 2
    v_permlane32_swap_b32 v240, v241
    v_add_f32 v240, v240, v241
    v_mov_b32 v241, v240
    s_nop 1
    v_permlane16_swap_b32 v240, v241
    v_add_f32 v240, v240, v241
    v_mov_b32 v241, v240
    s_nop 1
    v_permlane32_swap_b32 v240, v241
    v_mov_b32 v242, s48
    v_mov_b32 v243, s49
    s_lshl_b32 s57, s43, 8
    s_add_u32 s57, s57, s55
    s_add_u32 s57, s57, 111616
    s_waitcnt vmcnt(0)
    s_mov_b64 exec, 0xffff
    s_cmp_lg_u32 s50, 1
    s_cbranch_scc1 Lm_34
    buffer_store_dwordx4 v[240:243], v2, s[28:31], s57 offen
Lm_34_b:
    s_mov_b64 exec, -1
L_P3:
Lsp_35:
    ds_read_b32 v7, v6 offset:0
    s_waitcnt lgkmcnt(0)
    v_cmp_gt_u32 vcc, 22, v7
    s_cbranch_vccz Lsp_35_ok
    s_cmp_eq_u32 s46, 0
    s_cbranch_scc1 Lsp_35_ok
    s_sub_u32 s46, s46, 1
    s_branch Lsp_35
Lsp_35_ok:
    ds_read_b128 v[144:147], v2 offset:51200
    ds_read_b128 v[148:151], v2 offset:52224
    ds_read_b128 v[152:155], v2 offset:53248
    ds_read_b128 v[156:159], v2 offset:54272
    ds_read_b128 v[160:163], v2 offset:55296
    ds_read_b128 v[164:167], v2 offset:56320
    ds_read_b128 v[168:171], v2 offset:57344
    ds_read_b128 v[172:175], v2 offset:58368
    ds_read_b128 v[36:39], v2 offset:59392
    ds_read_b128 v[40:43], v2 offset:60416
    ds_read_b128 v[56:59], v2 offset:61440
    ds_read_b128 v[60:63], v2 offset:62464
Lsp_36:
    ds_read_b32 v7, v4 offset:44
    s_waitcnt lgkmcnt(0)
    v_cmp_gt_u32 vcc, 2, v7
    s_cbranch_vccz Lsp_36_ok
    s_cmp_eq_u32 s46, 0
    s_cbranch_scc1 Lsp_36_ok
    s_sub_u32 s46, s46, 1
    s_branch Lsp_36
Lsp_36_ok:
    v_lshlrev_b32 v21, 4, v16
    v_add_u32 v21, 153856, v21
    ds_read_b128 v[176:179], v21 offset:0
    ds_read_b128 v[180:183], v21 offset:64
    ds_read_b128 v[184:187], v21 offset:128
    ds_read_b128 v[188:191], v21 offset:192
    ds_read_b128 v[192:195], v21 offset:256
    s_mov_b32 s57, 111616
Lp_37:
    buffer_load_dwordx4 v[240:243], v18, s[28:31], s57 offen sc1
    buffer_load_dwordx4 v[244:247], v18, s[28:31], s57 offen offset:1024 sc1
    s_waitcnt vmcnt(0)
    v_cmp_ne_u64 vcc, s[48:49], v[242:243]
    v_cmp_ne_u64 s[26:27], s[48:49], v[246:247]
    s_or_b64 vcc, vcc, s[26:27]
    s_cbranch_scc0 Lp_37_ok
    s_cmp_eq_u32 s46, 0
    s_cbranch_scc1 Lp_37_ok
    s_sub_u32 s46, s46, 1
    s_branch Lp_37
Lp_37_ok:
    s_mul_i32 s57, s51, 5120
    s_add_u32 s57, s57, 20480
    buffer_load_dwordx4 v[64:67], v18, s[28:31], s57 offen offset:0 sc1
    buffer_load_dwordx4 v[68:71], v18, s[28:31], s57 offen offset:1024 sc1
    buffer_load_dwordx4 v[72:75], v18, s[28:31], s57 offen offset:2560 sc1
    buffer_load_dwordx4 v[76:79], v18, s[28:31], s57 offen offset:3584 sc1
    buffer_load_dwordx2 v[80:81], v19, s[28:31], s57 offen sc1
    buffer_load_dwordx2 v[82:83], v19, s[28:31], s57 offen offset:2560 sc1
    s_mul_i32 s57, s52, 5120
    s_add_u32 s57, s57, 20480
    buffer_load_dwordx4 v[84:87], v18, s[28:31], s57 offen offset:0 sc1
    buffer_load_dwordx4 v[88:91], v18, s[28:31], s57 offen offset:1024 sc1
    buffer_load_dwordx4 v[92:95], v18, s[28:31], s57 offen offset:2560 sc1
    buffer_load_dwordx4 v[96:99], v18, s[28:31], s57 offen offset:3584 sc1
    buffer_load_dwordx2 v[100:101], v19, s[28:31], s57 offen sc1
    buffer_load_dwordx2 v[102:103], v19, s[28:31], s57 offen offset:2560 sc1
    s_mul_i32 s57, s53, 5120
    s_add_u32 s57, s57, 20480
    buffer_load_dwordx4 v[104:107], v18, s[28:31], s57 offen offset:0 sc1
    buffer_load_dwordx4 v[108:111], v18, s[28:31], s57 offen offset:1024 sc1
    buffer_load_dwordx4 v[112:115], v18, s[28:31], s57 offen offset:2560 sc1
    buffer_load_dwordx4 v[116:119], v18, s[28:31], s57 offen offset:3584 sc1
    buffer_load_dwordx2 v[120:121], v19, s[28:31], s57 offen sc1
    buffer_load_dwordx2 v[122:123], v19, s[28:31], s57 offen offset:2560 sc1
    s_mul_i32 s57, s54, 5120
    s_add_u32 s57, s57, 20480
    buffer_load_dwordx4 v[124:127], v18, s[28:31], s57 offen offset:0 sc1
    buffer_load_dwordx4 v[128:131], v18, s[28:31], s57 offen offset:1024 sc1
    buffer_load_dwordx4 v[132:135], v18, s[28:31], s57 offen offset:2560 sc1
    buffer_load_dwordx4 v[136:139], v18, s[28:31], s57 offen offset:3584 sc1
    buffer_load_dwordx2 v[140:141], v19, s[28:31], s57 offen sc1
    buffer_load_dwordx2 v[142:143], v19, s[28:31], s57 offen offset:2560 sc1
    v_add_f32 v32, v240, v244
    v_add_f32 v34, v241, v245
    s_nop 1
    v_permlane32_swap_b32 v32, v34
    v_add_f32 v32, v32, v34
    v_mov_b32 v34, v32
    s_nop 1
    v_permlane16_swap_b32 v32, v34
    v_add_f32 v32, v32, v34
    v_mov_b32 v34, v32
    s_nop 1
    v_permlane32_swap_b32 v32, v34
    v_mul_f32 v32, 0xbacccccd, v32
    s_waitcnt lgkmcnt(0)
    v_mul_f32 v176, v32, v176
    v_mul_f32 v177, v32, v177
    v_mul_f32 v178, v32, v178
    v_mul_f32 v179, v32, v179
    v_mul_f32 v180, v32, v180
    v_mul_f32 v181, v32, v181
    v_mul_f32 v182, v32, v182
    v_mul_f32 v183, v32, v183
    v_mul_f32 v184, v32, v184
    v_mul_f32 v185, v32, v185
    v_mul_f32 v186, v32, v186
    v_mul_f32 v187, v32, v187
    v_mul_f32 v188, v32, v188
    v_mul_f32 v189, v32, v189
    v_mul_f32 v190, v32, v190
    v_mul_f32 v191, v32, v191
    v_mul_f32 v192, v32, v192
    v_mul_f32 v193, v32, v193
    v_mul_f32 v194, v32, v194
    v_mul_f32 v195, v32, v195
    s_waitcnt vmcnt(23)
    v_mfma_f32_16x16x32_bf16 v[176:179], v[144:147], v[64:67], v[176:179]
    ds_read_b128 v[144:147], v2 offset:63488
    v_mul_f32 v34, 0x3acccccd, v34
    v_mfma_f32_16x16x32_bf16 v[180:183], v[148:151], v[64:67], v[180:183]
    ds_read_b128 v[148:151], v2 offset:64512
    v_fma_f32 v34, -v32, v32, v34
    v_mfma_f32_16x16x32_bf16 v[184:187], v[152:155], v[64:67], v[184:187]
    ds_read_b128 v[152:155], v5 offset:0
    v_max_f32 v34, 0, v34
    v_mfma_f32_16x16x32_bf16 v[188:191], v[156:159], v[64:67], v[188:191]
    ds_read_b128 v[156:159], v5 offset:1024
    v_add_f32 v35, 0x3727c5ac, v34
    v_mfma_f32_16x16x32_bf16 v[192:195], v[160:163], v[64:67], v[192:195]
    ds_read_b128 v[160:163], v5 offset:2048
    ds_read_b32 v7, v6
    v_rsq_f32 v33, v35
    s_waitcnt vmcnt(22)
    v_mfma_f32_16x16x32_bf16 v[176:179], v[164:167], v[68:71], v[176:179]
    ds_read_b128 v[164:167], v5 offset:3072
    v_mul_f32 v35, v33, v33
    v_mfma_f32_16x16x32_bf16 v[180:183], v[168:171], v[68:71], v[180:183]
    ds_read_b128 v[168:171], v5 offset:4096
    v_mul_f32 v35, v35, v34
    v_mfma_f32_16x16x32_bf16 v[184:187], v[172:175], v[68:71], v[184:187]
    ds_read_b128 v[172:175], v5 offset:5120
    v_add_f32 v35, 0x3727c5ac, v35
    v_mfma_f32_16x16x32_bf16 v[188:191], v[36:39], v[68:71], v[188:191]
    ds_read_b128 v[36:39], v5 offset:6144
    v_rsq_f32 v35, v35
    v_mfma_f32_16x16x32_bf16 v[192:195], v[40:43], v[68:71], v[192:195]
    ds_read_b128 v[40:43], v5 offset:7168
    v_mul_f32 v35, v35, v33
    s_waitcnt vmcnt(21)
    v_mfma_f32_16x16x32_bf16 v[176:179], v[56:59], v[72:75], v[176:179]
    ds_read_b128 v[56:59], v5 offset:8192
    v_mul_f32 v28, 0xc0135761, v35
    v_mfma_f32_16x16x32_bf16 v[180:183], v[60:63], v[72:75], v[180:183]
    ds_read_b128 v[60:63], v5 offset:9216
    s_waitcnt lgkmcnt(7)
    v_cmp_gt_u32 s[22:23], 23, v7
    v_mul_f32 v29, v35, v35
    v_mfma_f32_16x16x32_bf16 v[184:187], v[144:147], v[72:75], v[184:187]
    ds_read_b128 v[144:147], v5 offset:10240
    v_mov_b32 v8, 22
    v_mul_f32 v29, v29, v28
    v_mfma_f32_16x16x32_bf16 v[188:191], v[148:151], v[72:75], v[188:191]
    s_cmp_lg_u64 s[22:23], 0
    s_cbranch_scc1 Lw_38
Lw_38_ok:
    ds_read_b128 v[148:151], v5 offset:62464
    ds_write_b32 v15, v8
    v_mul_f32 v29, 0x3d372713, v29
    v_mfma_f32_16x16x32_bf16 v[192:195], v[152:155], v[72:75], v[192:195]
    ds_read_b128 v[152:155], v5 offset:63488
    v_rcp_f32 v30, v35
    s_waitcnt vmcnt(20)
    v_mfma_f32_16x16x32_bf16 v[176:179], v[156:159], v[76:79], v[176:179]
    ds_read_b128 v[156:159], v5 offset:64512
    s_waitcnt lgkmcnt(9)
    v_mfma_f32_16x16x32_bf16 v[180:183], v[160:163], v[76:79], v[180:183]
    ds_read_b128 v[160:163], v9 offset:0
    v_mfma_f32_16x16x32_bf16 v[184:187], v[164:167], v[76:79], v[184:187]
    ds_read_b128 v[164:167], v9 offset:1024
    v_mfma_f32_16x16x32_bf16 v[188:191], v[168:171], v[76:79], v[188:191]
    ds_read_b128 v[168:171], v9 offset:2048
    v_mfma_f32_16x16x32_bf16 v[192:195], v[172:175], v[76:79], v[192:195]
    ds_read_b128 v[172:175], v9 offset:3072
    s_waitcnt vmcnt(18)
    s_waitcnt lgkmcnt(9)
    v_mfma_f32_16x16x32_bf16 v[176:179], v[36:39], v[80:83], v[176:179]
    ds_read_b128 v[36:39], v9 offset:4096
    v_mfma_f32_16x16x32_bf16 v[180:183], v[40:43], v[80:83], v[180:183]
    ds_read_b128 v[40:43], v9 offset:5120
    v_mfma_f32_16x16x32_bf16 v[184:187], v[56:59], v[80:83], v[184:187]
    ds_read_b128 v[56:59], v9 offset:6144
    v_mfma_f32_16x16x32_bf16 v[188:191], v[60:63], v[80:83], v[188:191]
    ds_read_b128 v[60:63], v9 offset:7168
    s_waitcnt lgkmcnt(8)
    v_mfma_f32_16x16x32_bf16 v[192:195], v[144:147], v[80:83], v[192:195]
    ds_read_b128 v[144:147], v9 offset:8192
    s_waitcnt vmcnt(17)
    v_mfma_f32_16x16x32_bf16 v[176:179], v[148:151], v[84:87], v[176:179]
    ds_read_b128 v[148:151], v9 offset:9216
    v_mfma_f32_16x16x32_bf16 v[180:183], v[152:155], v[84:87], v[180:183]
    ds_read_b128 v[152:155], v9 offset:10240
    v_mfma_f32_16x16x32_bf16 v[184:187], v[156:159], v[84:87], v[184:187]
    ds_read_b128 v[156:159], v9 offset:11264
    s_waitcnt lgkmcnt(8)
    v_mfma_f32_16x16x32_bf16 v[188:191], v[160:163], v[84:87], v[188:191]
    ds_read_b128 v[160:163], v9 offset:12288
    v_mfma_f32_16x16x32_bf16 v[192:195], v[164:167], v[84:87], v[192:195]
    ds_read_b128 v[164:167], v9 offset:13312
    ds_read_b32 v7, v6
    s_waitcnt vmcnt(16)
    v_mfma_f32_16x16x32_bf16 v[176:179], v[168:171], v[88:91], v[176:179]
    ds_read_b128 v[168:171], v9 offset:14336
    v_mfma_f32_16x16x32_bf16 v[180:183], v[172:175], v[88:91], v[180:183]
    ds_read_b128 v[172:175], v9 offset:15360
    s_waitcnt lgkmcnt(9)
    v_mfma_f32_16x16x32_bf16 v[184:187], v[36:39], v[88:91], v[184:187]
    ds_read_b128 v[36:39], v9 offset:16384
    v_mfma_f32_16x16x32_bf16 v[188:191], v[40:43], v[88:91], v[188:191]
    ds_read_b128 v[40:43], v9 offset:17408
    v_mfma_f32_16x16x32_bf16 v[192:195], v[56:59], v[88:91], v[192:195]
    ds_read_b128 v[56:59], v9 offset:18432
    s_waitcnt vmcnt(15)
    v_mfma_f32_16x16x32_bf16 v[176:179], v[60:63], v[92:95], v[176:179]
    ds_read_b128 v[60:63], v9 offset:19456
    s_waitcnt lgkmcnt(9)
    v_mfma_f32_16x16x32_bf16 v[180:183], v[144:147], v[92:95], v[180:183]
    ds_read_b128 v[144:147], v9 offset:20480
    s_waitcnt lgkmcnt(7)
    v_cmp_gt_u32 s[22:23], 24, v7
    v_mfma_f32_16x16x32_bf16 v[184:187], v[148:151], v[92:95], v[184:187]
    ds_read_b128 v[148:151], v9 offset:21504
    v_mfma_f32_16x16x32_bf16 v[188:191], v[152:155], v[92:95], v[188:191]
    s_cmp_lg_u64 s[22:23], 0
    s_cbranch_scc1 Lw_39
Lw_39_ok:
    ds_read_b128 v[152:155], v5 offset:11264
    v_mfma_f32_16x16x32_bf16 v[192:195], v[156:159], v[92:95], v[192:195]
    ds_read_b128 v[156:159], v5 offset:12288
    s_waitcnt vmcnt(14)
    s_waitcnt lgkmcnt(8)
    v_mfma_f32_16x16x32_bf16 v[176:179], v[160:163], v[96:99], v[176:179]
    ds_read_b128 v[160:163], v5 offset:13312
    v_mfma_f32_16x16x32_bf16 v[180:183], v[164:167], v[96:99], v[180:183]
    ds_read_b128 v[164:167], v5 offset:14336
    v_mfma_f32_16x16x32_bf16 v[184:187], v[168:171], v[96:99], v[184:187]
    ds_read_b128 v[168:171], v5 offset:15360
    v_mfma_f32_16x16x32_bf16 v[188:191], v[172:175], v[96:99], v[188:191]
    ds_read_b128 v[172:175], v5 offset:16384
    s_waitcnt lgkmcnt(8)
    v_mfma_f32_16x16x32_bf16 v[192:195], v[36:39], v[96:99], v[192:195]
    ds_read_b128 v[36:39], v5 offset:17408
    s_waitcnt vmcnt(12)
    v_mfma_f32_16x16x32_bf16 v[176:179], v[40:43], v[100:103], v[176:179]
    ds_read_b128 v[40:43], v5 offset:18432
    v_mfma_f32_16x16x32_bf16 v[180:183], v[56:59], v[100:103], v[180:183]
    ds_read_b128 v[56:59], v5 offset:19456
    v_mfma_f32_16x16x32_bf16 v[184:187], v[60:63], v[100:103], v[184:187]
    ds_read_b128 v[60:63], v5 offset:20480
    s_waitcnt lgkmcnt(8)
    v_mfma_f32_16x16x32_bf16 v[188:191], v[144:147], v[100:103], v[188:191]
    ds_read_b128 v[144:147], v5 offset:21504
    v_mfma_f32_16x16x32_bf16 v[192:195], v[148:151], v[100:103], v[192:195]
    ds_read_b128 v[148:151], v5 offset:22528
    s_waitcnt vmcnt(11)
    v_mfma_f32_16x16x32_bf16 v[176:179], v[152:155], v[104:107], v[176:179]
    ds_read_b128 v[152:155], v5 offset:23552
    v_mfma_f32_16x16x32_bf16 v[180:183], v[156:159], v[104:107], v[180:183]
    ds_read_b128 v[156:159], v5 offset:24576
    s_waitcnt lgkmcnt(8)
    v_mfma_f32_16x16x32_bf16 v[184:187], v[160:163], v[104:107], v[184:187]
    ds_read_b128 v[160:163], v5 offset:25600
    v_mfma_f32_16x16x32_bf16 v[188:191], v[164:167], v[104:107], v[188:191]
    ds_read_b128 v[164:167], v5 offset:26624
    v_mfma_f32_16x16x32_bf16 v[192:195], v[168:171], v[104:107], v[192:195]
    ds_read_b128 v[168:171], v5 offset:27648
    ds_read_b32 v7, v6
    s_waitcnt vmcnt(10)
    v_mfma_f32_16x16x32_bf16 v[176:179], v[172:175], v[108:111], v[176:179]
    ds_read_b128 v[172:175], v5 offset:28672
    s_waitcnt lgkmcnt(9)
    v_mfma_f32_16x16x32_bf16 v[180:183], v[36:39], v[108:111], v[180:183]
    ds_read_b128 v[36:39], v5 offset:29696
    v_mfma_f32_16x16x32_bf16 v[184:187], v[40:43], v[108:111], v[184:187]
    ds_read_b128 v[40:43], v5 offset:30720
    v_mfma_f32_16x16x32_bf16 v[188:191], v[56:59], v[108:111], v[188:191]
    ds_read_b128 v[56:59], v5 offset:31744
    v_mfma_f32_16x16x32_bf16 v[192:195], v[60:63], v[108:111], v[192:195]
    ds_read_b128 v[60:63], v5 offset:32768
    s_waitcnt vmcnt(9)
    s_waitcnt lgkmcnt(9)
    v_mfma_f32_16x16x32_bf16 v[176:179], v[144:147], v[112:115], v[176:179]
    ds_read_b128 v[144:147], v5 offset:33792
    v_mfma_f32_16x16x32_bf16 v[180:183], v[148:151], v[112:115], v[180:183]
    ds_read_b128 v[148:151], v5 offset:34816
    s_waitcnt lgkmcnt(7)
    v_cmp_gt_u32 s[22:23], 25, v7
    v_mfma_f32_16x16x32_bf16 v[184:187], v[152:155], v[112:115], v[184:187]
    ds_read_b128 v[152:155], v5 offset:35840
    v_mov_b32 v8, 24
    v_mfma_f32_16x16x32_bf16 v[188:191], v[156:159], v[112:115], v[188:191]
    s_cmp_lg_u64 s[22:23], 0
    s_cbranch_scc1 Lw_40
Lw_40_ok:
    ds_read_b128 v[156:159], v5 offset:36864
    ds_write_b32 v15, v8
    s_waitcnt lgkmcnt(9)
    v_mfma_f32_16x16x32_bf16 v[192:195], v[160:163], v[112:115], v[192:195]
    ds_read_b128 v[160:163], v5 offset:37888
    s_waitcnt vmcnt(8)
    v_mfma_f32_16x16x32_bf16 v[176:179], v[164:167], v[116:119], v[176:179]
    ds_read_b128 v[164:167], v5 offset:38912
    v_mfma_f32_16x16x32_bf16 v[180:183], v[168:171], v[116:119], v[180:183]
    ds_read_b128 v[168:171], v5 offset:39936
    v_mfma_f32_16x16x32_bf16 v[184:187], v[172:175], v[116:119], v[184:187]
    ds_read_b128 v[172:175], v5 offset:40960
    s_waitcnt lgkmcnt(9)
    v_mfma_f32_16x16x32_bf16 v[188:191], v[36:39], v[116:119], v[188:191]
    ds_read_b128 v[36:39], v5 offset:41984
    v_mfma_f32_16x16x32_bf16 v[192:195], v[40:43], v[116:119], v[192:195]
    ds_read_b128 v[40:43], v5 offset:43008
    s_waitcnt vmcnt(6)
    v_mfma_f32_16x16x32_bf16 v[176:179], v[56:59], v[120:123], v[176:179]
    ds_read_b128 v[56:59], v5 offset:44032
    v_mfma_f32_16x16x32_bf16 v[180:183], v[60:63], v[120:123], v[180:183]
    ds_read_b128 v[60:63], v5 offset:45056
    s_waitcnt lgkmcnt(9)
    v_mfma_f32_16x16x32_bf16 v[184:187], v[144:147], v[120:123], v[184:187]
    ds_read_b128 v[144:147], v5 offset:46080
    v_mfma_f32_16x16x32_bf16 v[188:191], v[148:151], v[120:123], v[188:191]
    ds_read_b128 v[148:151], v5 offset:47104
    v_mfma_f32_16x16x32_bf16 v[192:195], v[152:155], v[120:123], v[192:195]
    ds_read_b128 v[152:155], v5 offset:48128
    s_waitcnt vmcnt(5)
    v_mfma_f32_16x16x32_bf16 v[176:179], v[156:159], v[124:127], v[176:179]
    ds_read_b128 v[156:159], v5 offset:49152
    s_waitcnt lgkmcnt(8)
    v_mfma_f32_16x16x32_bf16 v[180:183], v[160:163], v[124:127], v[180:183]
    ds_read_b128 v[160:163], v5 offset:50176
    v_mfma_f32_16x16x32_bf16 v[184:187], v[164:167], v[124:127], v[184:187]
    ds_read_b128 v[164:167], v5 offset:51200
    v_mfma_f32_16x16x32_bf16 v[188:191], v[168:171], v[124:127], v[188:191]
    ds_read_b128 v[168:171], v5 offset:52224
    v_mfma_f32_16x16x32_bf16 v[192:195], v[172:175], v[124:127], v[192:195]
    ds_read_b128 v[172:175], v5 offset:53248
    s_waitcnt vmcnt(4)
    s_waitcnt lgkmcnt(8)
    v_mfma_f32_16x16x32_bf16 v[176:179], v[36:39], v[128:131], v[176:179]
    ds_read_b128 v[36:39], v5 offset:54272
    v_mfma_f32_16x16x32_bf16 v[180:183], v[40:43], v[128:131], v[180:183]
    ds_read_b128 v[40:43], v5 offset:55296
    v_mfma_f32_16x16x32_bf16 v[184:187], v[56:59], v[128:131], v[184:187]
    ds_read_b128 v[56:59], v5 offset:56320
    v_mfma_f32_16x16x32_bf16 v[188:191], v[60:63], v[128:131], v[188:191]
    ds_read_b128 v[60:63], v5 offset:57344
    s_waitcnt lgkmcnt(8)
    v_mfma_f32_16x16x32_bf16 v[192:195], v[144:147], v[128:131], v[192:195]
    ds_read_b128 v[144:147], v5 offset:58368
    s_waitcnt vmcnt(3)
    v_mfma_f32_16x16x32_bf16 v[176:179], v[148:151], v[132:135], v[176:179]
    ds_read_b128 v[148:151], v5 offset:59392
    v_mfma_f32_16x16x32_bf16 v[180:183], v[152:155], v[132:135], v[180:183]
    ds_read_b128 v[152:155], v5 offset:60416
    v_mfma_f32_16x16x32_bf16 v[184:187], v[156:159], v[132:135], v[184:187]
    ds_read_b128 v[156:159], v5 offset:61440
    s_waitcnt lgkmcnt(8)
    v_mfma_f32_16x16x32_bf16 v[188:191], v[160:163], v[132:135], v[188:191]
    v_mfma_f32_16x16x32_bf16 v[192:195], v[164:167], v[132:135], v[192:195]
    s_waitcnt vmcnt(2)
    v_mfma_f32_16x16x32_bf16 v[176:179], v[168:171], v[136:139], v[176:179]
    v_mfma_f32_16x16x32_bf16 v[180:183], v[172:175], v[136:139], v[180:183]
    s_waitcnt lgkmcnt(4)
    v_mfma_f32_16x16x32_bf16 v[184:187], v[36:39], v[136:139], v[184:187]
    v_mfma_f32_16x16x32_bf16 v[188:191], v[40:43], v[136:139], v[188:191]
    v_mfma_f32_16x16x32_bf16 v[192:195], v[56:59], v[136:139], v[192:195]
    s_waitcnt vmcnt(0)
    v_mfma_f32_16x16x32_bf16 v[176:179], v[60:63], v[140:143], v[176:179]
    s_waitcnt lgkmcnt(0)
    v_mfma_f32_16x16x32_bf16 v[180:183], v[144:147], v[140:143], v[180:183]
    v_mfma_f32_16x16x32_bf16 v[184:187], v[148:151], v[140:143], v[184:187]
    v_mfma_f32_16x16x32_bf16 v[188:191], v[152:155], v[140:143], v[188:191]
    v_mfma_f32_16x16x32_bf16 v[192:195], v[156:159], v[140:143], v[192:195]
    s_nop 2
    v_pk_mul_f32 v[240:241], v[176:177], v[176:177]
    v_pk_mul_f32 v[242:243], v[178:179], v[178:179]
    v_pk_fma_f32 v[240:241], v[240:241], v[28:29], v[28:29] op_sel:[0,1,0] op_sel_hi:[1,1,0]
    v_pk_fma_f32 v[242:243], v[242:243], v[28:29], v[28:29] op_sel:[0,1,0] op_sel_hi:[1,1,0]
    v_pk_mul_f32 v[240:241], v[240:241], v[176:177]
    v_pk_mul_f32 v[242:243], v[242:243], v[178:179]
    v_exp_f32 v240, v240
    v_exp_f32 v241, v241
    v_exp_f32 v242, v242
    v_exp_f32 v243, v243
    v_pk_fma_f32 v[240:241], v[240:241], v[30:31], v[30:31] op_sel_hi:[1,0,0]
    v_pk_fma_f32 v[242:243], v[242:243], v[30:31], v[30:31] op_sel_hi:[1,0,0]
    v_rcp_f32 v240, v240
    v_rcp_f32 v241, v241
    v_rcp_f32 v242, v242
    v_rcp_f32 v243, v243
    v_pk_mul_f32 v[240:241], v[240:241], v[176:177]
    v_pk_mul_f32 v[242:243], v[242:243], v[178:179]
    v_cvt_pk_bf16_f32 v228, v240, v241
    v_cvt_pk_bf16_f32 v229, v242, v243
    v_pk_mul_f32 v[240:241], v[180:181], v[180:181]
    v_pk_mul_f32 v[242:243], v[182:183], v[182:183]
    v_pk_fma_f32 v[240:241], v[240:241], v[28:29], v[28:29] op_sel:[0,1,0] op_sel_hi:[1,1,0]
    v_pk_fma_f32 v[242:243], v[242:243], v[28:29], v[28:29] op_sel:[0,1,0] op_sel_hi:[1,1,0]
    v_pk_mul_f32 v[240:241], v[240:241], v[180:181]
    v_pk_mul_f32 v[242:243], v[242:243], v[182:183]
    v_exp_f32 v240, v240
    v_exp_f32 v241, v241
    v_exp_f32 v242, v242
    v_exp_f32 v243, v243
    v_pk_fma_f32 v[240:241], v[240:241], v[30:31], v[30:31] op_sel_hi:[1,0,0]
    v_pk_fma_f32 v[242:243], v[242:243], v[30:31], v[30:31] op_sel_hi:[1,0,0]
    v_rcp_f32 v240, v240
    v_rcp_f32 v241, v241
    v_rcp_f32 v242, v242
    v_rcp_f32 v243, v243
    v_pk_mul_f32 v[240:241], v[240:241], v[180:181]
    v_pk_mul_f32 v[242:243], v[242:243], v[182:183]
    v_cvt_pk_bf16_f32 v230, v240, v241
    v_cvt_pk_bf16_f32 v231, v242, v243
    v_pk_mul_f32 v[240:241], v[184:185], v[184:185]
    v_pk_mul_f32 v[242:243], v[186:187], v[186:187]
    v_pk_fma_f32 v[240:241], v[240:241], v[28:29], v[28:29] op_sel:[0,1,0] op_sel_hi:[1,1,0]
    v_pk_fma_f32 v[242:243], v[242:243], v[28:29], v[28:29] op_sel:[0,1,0] op_sel_hi:[1,1,0]
    v_pk_mul_f32 v[240:241], v[240:241], v[184:185]
    v_pk_mul_f32 v[242:243], v[242:243], v[186:187]
    v_exp_f32 v240, v240
    v_exp_f32 v241, v241
    v_exp_f32 v242, v242
    v_exp_f32 v243, v243
    v_pk_fma_f32 v[240:241], v[240:241], v[30:31], v[30:31] op_sel_hi:[1,0,0]
    v_pk_fma_f32 v[242:243], v[242:243], v[30:31], v[30:31] op_sel_hi:[1,0,0]
    v_rcp_f32 v240, v240
    v_rcp_f32 v241, v241
    v_rcp_f32 v242, v242
    v_rcp_f32 v243, v243
    v_pk_mul_f32 v[240:241], v[240:241], v[184:185]
    v_pk_mul_f32 v[242:243], v[242:243], v[186:187]
    v_cvt_pk_bf16_f32 v232, v240, v241
    v_cvt_pk_bf16_f32 v233, v242, v243
    v_pk_mul_f32 v[240:241], v[188:189], v[188:189]
    v_pk_mul_f32 v[242:243], v[190:191], v[190:191]
    v_pk_fma_f32 v[240:241], v[240:241], v[28:29], v[28:29] op_sel:[0,1,0] op_sel_hi:[1,1,0]
    v_pk_fma_f32 v[242:243], v[242:243], v[28:29], v[28:29] op_sel:[0,1,0] op_sel_hi:[1,1,0]
    v_pk_mul_f32 v[240:241], v[240:241], v[188:189]
    v_pk_mul_f32 v[242:243], v[242:243], v[190:191]
    v_exp_f32 v240, v240
    v_exp_f32 v241, v241
    v_exp_f32 v242, v242
    v_exp_f32 v243, v243
    v_pk_fma_f32 v[240:241], v[240:241], v[30:31], v[30:31] op_sel_hi:[1,0,0]
    v_pk_fma_f32 v[242:243], v[242:243], v[30:31], v[30:31] op_sel_hi:[1,0,0]
    v_rcp_f32 v240, v240
    v_rcp_f32 v241, v241
    v_rcp_f32 v242, v242
    v_rcp_f32 v243, v243
    v_pk_mul_f32 v[240:241], v[240:241], v[188:189]
    v_pk_mul_f32 v[242:243], v[242:243], v[190:191]
    v_cvt_pk_bf16_f32 v234, v240, v241
    v_cvt_pk_bf16_f32 v235, v242, v243
    v_pk_mul_f32 v[240:241], v[192:193], v[192:193]
    v_pk_mul_f32 v[242:243], v[194:195], v[194:195]
    v_pk_fma_f32 v[240:241], v[240:241], v[28:29], v[28:29] op_sel:[0,1,0] op_sel_hi:[1,1,0]
    v_pk_fma_f32 v[242:243], v[242:243], v[28:29], v[28:29] op_sel:[0,1,0] op_sel_hi:[1,1,0]
    v_pk_mul_f32 v[240:241], v[240:241], v[192:193]
    v_pk_mul_f32 v[242:243], v[242:243], v[194:195]
    v_exp_f32 v240, v240
    v_exp_f32 v241, v241
    v_exp_f32 v242, v242
    v_exp_f32 v243, v243
    v_pk_fma_f32 v[240:241], v[240:241], v[30:31], v[30:31] op_sel_hi:[1,0,0]
    v_pk_fma_f32 v[242:243], v[242:243], v[30:31], v[30:31] op_sel_hi:[1,0,0]
    v_rcp_f32 v240, v240
    v_rcp_f32 v241, v241
    v_rcp_f32 v242, v242
    v_rcp_f32 v243, v243
    v_pk_mul_f32 v[240:241], v[240:241], v[192:193]
    v_pk_mul_f32 v[242:243], v[242:243], v[194:195]
    v_cvt_pk_bf16_f32 v236, v240, v241
    v_cvt_pk_bf16_f32 v237, v242, v243
    s_add_u32 s57, s56, 0
    s_cmp_lg_u32 s50, 1
    s_cbranch_scc1 Lm_41
    buffer_store_dwordx4 v[228:231], v2, s[28:31], s57 offen
    buffer_store_dwordx4 v[232:235], v2, s[28:31], s57 offen offset:1024
    buffer_store_dwordx2 v[236:237], v3, s[28:31], s57 offen offset:2048
Lm_41_b:
    s_bitcmp1_b32 s43, 1
    s_cselect_b32 s58, 0, 3
    s_cmp_eq_u32 s40, s58
    s_cbranch_scc1 Lsh_42
    s_waitcnt vmcnt(0)
    s_lshl_b32 s57, s43, 3
    s_add_u32 s57, s57, s55
    s_add_u32 s57, s57, 110720
    s_mov_b64 exec, 1
    s_cmp_lg_u32 s50, 1
    s_cbranch_scc1 Lm_43
    buffer_store_dwordx2 v[12:13], v14, s[28:31], s57 offen
Lm_43_b:
    s_mov_b64 exec, -1
Lsh_42_b:
L_P4:
Lsp_44:
    ds_read_b32 v7, v6 offset:0
    s_waitcnt lgkmcnt(0)
    v_cmp_gt_u32 vcc, 26, v7
    s_cbranch_vccz Lsp_44_ok
    s_cmp_eq_u32 s46, 0
    s_cbranch_scc1 Lsp_44_ok
    s_sub_u32 s46, s46, 1
    s_branch Lsp_44
Lsp_44_ok:
    ds_read_b128 v[144:147], v2 offset:0
    ds_read_b128 v[148:151], v2 offset:1024
    ds_read_b128 v[152:155], v2 offset:2048
    ds_read_b128 v[156:159], v2 offset:3072
    ds_read_b128 v[160:163], v2 offset:4096
    ds_read_b128 v[164:167], v2 offset:5120
    ds_read_b128 v[168:171], v2 offset:6144
    ds_read_b128 v[172:175], v2 offset:7168
    ds_read_b128 v[36:39], v2 offset:8192
    ds_read_b128 v[40:43], v2 offset:9216
    ds_read_b128 v[56:59], v2 offset:10240
    ds_read_b128 v[60:63], v2 offset:11264
    v_lshlrev_b32 v176, 16, v208
    v_and_b32 v177, 0xffff0000, v208
    v_lshlrev_b32 v178, 16, v209
    v_and_b32 v179, 0xffff0000, v209
    v_lshlrev_b32 v180, 16, v210
    v_and_b32 v181, 0xffff0000, v210
    v_lshlrev_b32 v182, 16, v211
    v_and_b32 v183, 0xffff0000, v211
    v_lshlrev_b32 v184, 16, v212
    v_and_b32 v185, 0xffff0000, v212
    v_lshlrev_b32 v186, 16, v213
    v_and_b32 v187, 0xffff0000, v213
    v_lshlrev_b32 v188, 16, v214
    v_and_b32 v189, 0xffff0000, v214
    v_lshlrev_b32 v190, 16, v215
    v_and_b32 v191, 0xffff0000, v215
    v_lshlrev_b32 v192, 16, v216
    v_and_b32 v193, 0xffff0000, v216
    v_lshlrev_b32 v194, 16, v217
    v_and_b32 v195, 0xffff0000, v217
    v_mul_f32 v34, v32, v33
    v_fma_f32 v176, v176, v33, v34
    v_fma_f32 v177, v177, v33, v34
    v_fma_f32 v178, v178, v33, v34
    v_fma_f32 v179, v179, v33, v34
    v_fma_f32 v180, v180, v33, v34
    v_fma_f32 v181, v181, v33, v34
    v_fma_f32 v182, v182, v33, v34
    v_fma_f32 v183, v183, v33, v34
    v_fma_f32 v184, v184, v33, v34
    v_fma_f32 v185, v185, v33, v34
    v_fma_f32 v186, v186, v33, v34
    v_fma_f32 v187, v187, v33, v34
    v_fma_f32 v188, v188, v33, v34
    v_fma_f32 v189, v189, v33, v34
    v_fma_f32 v190, v190, v33, v34
    v_fma_f32 v191, v191, v33, v34
    v_fma_f32 v192, v192, v33, v34
    v_fma_f32 v193, v193, v33, v34
    v_fma_f32 v194, v194, v33, v34
    v_fma_f32 v195, v195, v33, v34
    s_sub_u32 s60, s55, 115712
    s_add_u32 s57, s60, 90112
    s_cmp_eq_u32 s40, 0
    s_cselect_b32 s60, s57, s60
    s_cmp_eq_u32 s45, 0
    s_cselect_b32 s60, 1073741824, s60
    s_add_u32 s61, s55, 115712
    s_add_u32 s57, s61, 90112
    s_cmp_eq_u32 s40, 3
    s_cselect_b32 s61, s57, s61
    s_cmp_eq_u32 s45, 127
    s_cselect_b32 s61, 1073741824, s61
    s_lshr_b32 s57, s51, 1
    s_add_u32 s57, s57, 1
    s_sub_u32 s58, 0, s57
    s_bitcmp1_b32 s51, 0
    s_cselect_b32 s57, s57, s58
    s_cselect_b32 s58, s61, s60
    v_add_u32 v53, s57, v17
    v_cmp_lt_u32 vcc, 15, v53
    v_mov_b32 v52, s55
    v_mov_b32 v48, s58
    v_cndmask_b32 v52, v52, v48, vcc
    v_and_b32 v53, 15, v53
    v_lshl_add_u32 v53, v16, 4, v53
    v_lshl_add_u32 v44, v53, 4, v52
    v_lshl_add_u32 v48, v53, 3, v52
    v_add_u32 v48, 2048, v48
    s_lshr_b32 s57, s52, 1
    s_add_u32 s57, s57, 1
    s_sub_u32 s58, 0, s57
    s_bitcmp1_b32 s52, 0
    s_cselect_b32 s57, s57, s58
    s_cselect_b32 s58, s61, s60
    v_add_u32 v53, s57, v17
    v_cmp_lt_u32 vcc, 15, v53
    v_mov_b32 v52, s55
    v_mov_b32 v49, s58
    v_cndmask_b32 v52, v52, v49, vcc
    v_and_b32 v53, 15, v53
    v_lshl_add_u32 v53, v16, 4, v53
    v_lshl_add_u32 v45, v53, 4, v52
    v_lshl_add_u32 v49, v53, 3, v52
    v_add_u32 v49, 2048, v49
    s_lshr_b32 s57, s53, 1
    s_add_u32 s57, s57, 1
    s_sub_u32 s58, 0, s57
    s_bitcmp1_b32 s53, 0
    s_cselect_b32 s57, s57, s58
    s_cselect_b32 s58, s61, s60
    v_add_u32 v53, s57, v17
    v_cmp_lt_u32 vcc, 15, v53
    v_mov_b32 v52, s55
    v_mov_b32 v50, s58
    v_cndmask_b32 v52, v52, v50, vcc
    v_and_b32 v53, 15, v53
    v_lshl_add_u32 v53, v16, 4, v53
    v_lshl_add_u32 v46, v53, 4, v52
    v_lshl_add_u32 v50, v53, 3, v52
    v_add_u32 v50, 2048, v50
    s_lshr_b32 s57, s54, 1
    s_add_u32 s57, s57, 1
    s_sub_u32 s58, 0, s57
    s_bitcmp1_b32 s54, 0
    s_cselect_b32 s57, s57, s58
    s_cselect_b32 s58, s61, s60
    v_add_u32 v53, s57, v17
    v_cmp_lt_u32 vcc, 15, v53
    v_mov_b32 v52, s55
    v_mov_b32 v51, s58
    v_cndmask_b32 v52, v52, v51, vcc
    v_and_b32 v53, 15, v53
    v_lshl_add_u32 v53, v16, 4, v53
    v_lshl_add_u32 v47, v53, 4, v52
    v_lshl_add_u32 v51, v53, 3, v52
    v_add_u32 v51, 2048, v51
    s_sub_u32 s57, s55, 115712
    s_add_u32 s58, s57, 128
    s_cmp_eq_u32 s40, 0
    s_cselect_b32 s57, s58, s57
    s_cmp_eq_u32 s45, 0
    s_cselect_b32 s57, s55, s57
    s_add_u32 s59, s55, 115712
    s_add_u32 s58, s59, 128
    s_cmp_eq_u32 s40, 3
    s_cselect_b32 s59, s58, s59
    s_cmp_eq_u32 s45, 127
    s_cselect_b32 s59, s55, s59
    v_mov_b32 v52, s57
    v_mov_b32 v53, s59
    v_and_b32 v54, 2, v1
    v_cmp_ne_u32 vcc, 0, v54
    s_nop 1
    v_cndmask_b32 v52, v52, v53, vcc
    v_mov_b32 v53, s55
    v_and_b32 v54, 8, v1
    v_cmp_ne_u32 vcc, 0, v54
    s_nop 1
    v_cndmask_b32 v52, v53, v52, vcc
    v_and_b32 v54, 7, v1
    v_lshl_add_u32 v54, v54, 3, v52
    s_mov_b32 s58, 110720
Lp_45:
    buffer_load_dwordx2 v[240:241], v54, s[28:31], s58 offen offset:0 sc1
    s_waitcnt vmcnt(0)
    v_cmp_ne_u64 vcc, s[48:49], v[240:241]
    s_cbranch_vccz Lp_45_ok
    s_cmp_eq_u32 s46, 0
    s_cbranch_scc1 Lp_45_ok
    s_sub_u32 s46, s46, 1
    s_branch Lp_45
Lp_45_ok:
    s_mul_i32 s57, s51, 5120
    s_add_u32 s57, s57, 0
    buffer_load_dwordx4 v[64:67], v44, s[28:31], s57 offen offset:0 sc1
    buffer_load_dwordx4 v[68:71], v44, s[28:31], s57 offen offset:1024 sc1
    buffer_load_dwordx4 v[72:75], v44, s[28:31], s57 offen offset:2560 sc1
    buffer_load_dwordx4 v[76:79], v44, s[28:31], s57 offen offset:3584 sc1
    buffer_load_dwordx2 v[80:81], v48, s[28:31], s57 offen sc1
    buffer_load_dwordx2 v[82:83], v48, s[28:31], s57 offen offset:2560 sc1
    s_mul_i32 s57, s52, 5120
    s_add_u32 s57, s57, 0
    buffer_load_dwordx4 v[84:87], v45, s[28:31], s57 offen offset:0 sc1
    buffer_load_dwordx4 v[88:91], v45, s[28:31], s57 offen offset:1024 sc1
    buffer_load_dwordx4 v[92:95], v45, s[28:31], s57 offen offset:2560 sc1
    buffer_load_dwordx4 v[96:99], v45, s[28:31], s57 offen offset:3584 sc1
    buffer_load_dwordx2 v[100:101], v49, s[28:31], s57 offen sc1
    buffer_load_dwordx2 v[102:103], v49, s[28:31], s57 offen offset:2560 sc1
    s_mul_i32 s57, s53, 5120
    s_add_u32 s57, s57, 0
    buffer_load_dwordx4 v[104:107], v46, s[28:31], s57 offen offset:0 sc1
    buffer_load_dwordx4 v[108:111], v46, s[28:31], s57 offen offset:1024 sc1
    buffer_load_dwordx4 v[112:115], v46, s[28:31], s57 offen offset:2560 sc1
    buffer_load_dwordx4 v[116:119], v46, s[28:31], s57 offen offset:3584 sc1
    buffer_load_dwordx2 v[120:121], v50, s[28:31], s57 offen sc1
    buffer_load_dwordx2 v[122:123], v50, s[28:31], s57 offen offset:2560 sc1
    s_mul_i32 s57, s54, 5120
    s_add_u32 s57, s57, 0
    buffer_load_dwordx4 v[124:127], v47, s[28:31], s57 offen offset:0 sc1
    buffer_load_dwordx4 v[128:131], v47, s[28:31], s57 offen offset:1024 sc1
    buffer_load_dwordx4 v[132:135], v47, s[28:31], s57 offen offset:2560 sc1
    buffer_load_dwordx4 v[136:139], v47, s[28:31], s57 offen offset:3584 sc1
    buffer_load_dwordx2 v[140:141], v51, s[28:31], s57 offen sc1
    buffer_load_dwordx2 v[142:143], v51, s[28:31], s57 offen offset:2560 sc1
    s_waitcnt vmcnt(23)
    s_waitcnt lgkmcnt(8)
    v_mfma_f32_16x16x32_bf16 v[176:179], v[144:147], v[64:67], v[176:179]
    ds_read_b128 v[144:147], v2 offset:12288
    v_mfma_f32_16x16x32_bf16 v[180:183], v[148:151], v[64:67], v[180:183]
    ds_read_b128 v[148:151], v2 offset:13312
    v_mfma_f32_16x16x32_bf16 v[184:187], v[152:155], v[64:67], v[184:187]
    ds_read_b128 v[152:155], v2 offset:14336
    v_mfma_f32_16x16x32_bf16 v[188:191], v[156:159], v[64:67], v[188:191]
    ds_read_b128 v[156:159], v2 offset:15360
    s_waitcnt lgkmcnt(8)
    v_mfma_f32_16x16x32_bf16 v[192:195], v[160:163], v[64:67], v[192:195]
    ds_read_b128 v[160:163], v2 offset:16384
    ds_read_b32 v7, v6
    s_waitcnt vmcnt(22)
    v_mfma_f32_16x16x32_bf16 v[176:179], v[164:167], v[68:71], v[176:179]
    ds_read_b128 v[164:167], v2 offset:17408
    v_mfma_f32_16x16x32_bf16 v[180:183], v[168:171], v[68:71], v[180:183]
    ds_read_b128 v[168:171], v2 offset:18432
    v_mfma_f32_16x16x32_bf16 v[184:187], v[172:175], v[68:71], v[184:187]
    ds_read_b128 v[172:175], v2 offset:19456
    s_waitcnt lgkmcnt(9)
    v_mfma_f32_16x16x32_bf16 v[188:191], v[36:39], v[68:71], v[188:191]
    ds_read_b128 v[36:39], v2 offset:20480
    v_mfma_f32_16x16x32_bf16 v[192:195], v[40:43], v[68:71], v[192:195]
    ds_read_b128 v[40:43], v2 offset:21504
    s_waitcnt vmcnt(21)
    v_mfma_f32_16x16x32_bf16 v[176:179], v[56:59], v[72:75], v[176:179]
    ds_read_b128 v[56:59], v2 offset:22528
    v_mfma_f32_16x16x32_bf16 v[180:183], v[60:63], v[72:75], v[180:183]
    ds_read_b128 v[60:63], v2 offset:23552
    s_waitcnt lgkmcnt(7)
    v_cmp_gt_u32 s[22:23], 27, v7
    v_mfma_f32_16x16x32_bf16 v[184:187], v[144:147], v[72:75], v[184:187]
    ds_read_b128 v[144:147], v2 offset:24576
    v_mov_b32 v8, 26
    v_mfma_f32_16x16x32_bf16 v[188:191], v[148:151], v[72:75], v[188:191]
    s_cmp_lg_u64 s[22:23], 0
    s_cbranch_scc1 Lw_46
Lw_46_ok:
    ds_read_b128 v[148:151], v2 offset:25600
    ds_write_b32 v15, v8
    v_mfma_f32_16x16x32_bf16 v[192:195], v[152:155], v[72:75], v[192:195]
    ds_read_b128 v[152:155], v2 offset:26624
    s_waitcnt vmcnt(20)
    v_mfma_f32_16x16x32_bf16 v[176:179], v[156:159], v[76:79], v[176:179]
    ds_read_b128 v[156:159], v2 offset:27648
    s_waitcnt lgkmcnt(9)
    v_mfma_f32_16x16x32_bf16 v[180:183], v[160:163], v[76:79], v[180:183]
    ds_read_b128 v[160:163], v2 offset:28672
    v_mfma_f32_16x16x32_bf16 v[184:187], v[164:167], v[76:79], v[184:187]
    ds_read_b128 v[164:167], v2 offset:29696
    v_mfma_f32_16x16x32_bf16 v[188:191], v[168:171], v[76:79], v[188:191]
    ds_read_b128 v[168:171], v2 offset:30720
    v_mfma_f32_16x16x32_bf16 v[192:195], v[172:175], v[76:79], v[192:195]
    ds_read_b128 v[172:175], v2 offset:31744
    s_waitcnt vmcnt(18)
    s_waitcnt lgkmcnt(9)
    v_mfma_f32_16x16x32_bf16 v[176:179], v[36:39], v[80:83], v[176:179]
    ds_read_b128 v[36:39], v2 offset:32768
    v_mfma_f32_16x16x32_bf16 v[180:183], v[40:43], v[80:83], v[180:183]
    ds_read_b128 v[40:43], v2 offset:33792
    v_mfma_f32_16x16x32_bf16 v[184:187], v[56:59], v[80:83], v[184:187]
    ds_read_b128 v[56:59], v2 offset:34816
    v_mfma_f32_16x16x32_bf16 v[188:191], v[60:63], v[80:83], v[188:191]
    ds_read_b128 v[60:63], v2 offset:35840
    s_waitcnt lgkmcnt(8)
    v_mfma_f32_16x16x32_bf16 v[192:195], v[144:147], v[80:83], v[192:195]
    ds_read_b128 v[144:147], v2 offset:36864
    s_waitcnt vmcnt(17)
    v_mfma_f32_16x16x32_bf16 v[176:179], v[148:151], v[84:87], v[176:179]
    ds_read_b128 v[148:151], v2 offset:37888
    v_mfma_f32_16x16x32_bf16 v[180:183], v[152:155], v[84:87], v[180:183]
    ds_read_b128 v[152:155], v2 offset:38912
    v_mfma_f32_16x16x32_bf16 v[184:187], v[156:159], v[84:87], v[184:187]
    ds_read_b128 v[156:159], v2 offset:39936
    s_waitcnt lgkmcnt(8)
    v_mfma_f32_16x16x32_bf16 v[188:191], v[160:163], v[84:87], v[188:191]
    ds_read_b128 v[160:163], v2 offset:40960
    v_mfma_f32_16x16x32_bf16 v[192:195], v[164:167], v[84:87], v[192:195]
    ds_read_b128 v[164:167], v2 offset:41984
    ds_read_b32 v7, v6
    s_waitcnt vmcnt(16)
    v_mfma_f32_16x16x32_bf16 v[176:179], v[168:171], v[88:91], v[176:179]
    ds_read_b128 v[168:171], v2 offset:43008
    v_mfma_f32_16x16x32_bf16 v[180:183], v[172:175], v[88:91], v[180:183]
    ds_read_b128 v[172:175], v2 offset:44032
    s_waitcnt lgkmcnt(9)
    v_mfma_f32_16x16x32_bf16 v[184:187], v[36:39], v[88:91], v[184:187]
    ds_read_b128 v[36:39], v2 offset:45056
    v_mfma_f32_16x16x32_bf16 v[188:191], v[40:43], v[88:91], v[188:191]
    ds_read_b128 v[40:43], v2 offset:46080
    v_mfma_f32_16x16x32_bf16 v[192:195], v[56:59], v[88:91], v[192:195]
    ds_read_b128 v[56:59], v2 offset:47104
    s_waitcnt vmcnt(15)
    v_mfma_f32_16x16x32_bf16 v[176:179], v[60:63], v[92:95], v[176:179]
    ds_read_b128 v[60:63], v2 offset:48128
    s_waitcnt lgkmcnt(9)
    v_mfma_f32_16x16x32_bf16 v[180:183], v[144:147], v[92:95], v[180:183]
    ds_read_b128 v[144:147], v2 offset:49152
    s_waitcnt lgkmcnt(7)
    v_cmp_gt_u32 s[22:23], 28, v7
    v_mfma_f32_16x16x32_bf16 v[184:187], v[148:151], v[92:95], v[184:187]
    ds_read_b128 v[148:151], v2 offset:50176
    v_mfma_f32_16x16x32_bf16 v[188:191], v[152:155], v[92:95], v[188:191]
    s_cmp_lg_u64 s[22:23], 0
    s_cbranch_scc1 Lw_47
Lw_47_ok:
    ds_read_b128 v[152:155], v2 offset:51200
    v_mfma_f32_16x16x32_bf16 v[192:195], v[156:159], v[92:95], v[192:195]
    ds_read_b128 v[156:159], v2 offset:52224
    s_waitcnt vmcnt(14)
    s_waitcnt lgkmcnt(8)
    v_mfma_f32_16x16x32_bf16 v[176:179], v[160:163], v[96:99], v[176:179]
    ds_read_b128 v[160:163], v2 offset:53248
    v_mfma_f32_16x16x32_bf16 v[180:183], v[164:167], v[96:99], v[180:183]
    ds_read_b128 v[164:167], v2 offset:54272
    v_mfma_f32_16x16x32_bf16 v[184:187], v[168:171], v[96:99], v[184:187]
    ds_read_b128 v[168:171], v2 offset:55296
    v_mfma_f32_16x16x32_bf16 v[188:191], v[172:175], v[96:99], v[188:191]
    ds_read_b128 v[172:175], v2 offset:56320
    s_waitcnt lgkmcnt(8)
    v_mfma_f32_16x16x32_bf16 v[192:195], v[36:39], v[96:99], v[192:195]
    ds_read_b128 v[36:39], v2 offset:57344
    s_waitcnt vmcnt(12)
    v_mfma_f32_16x16x32_bf16 v[176:179], v[40:43], v[100:103], v[176:179]
    ds_read_b128 v[40:43], v2 offset:58368
    v_mfma_f32_16x16x32_bf16 v[180:183], v[56:59], v[100:103], v[180:183]
    ds_read_b128 v[56:59], v2 offset:59392
    v_mfma_f32_16x16x32_bf16 v[184:187], v[60:63], v[100:103], v[184:187]
    ds_read_b128 v[60:63], v2 offset:60416
    s_waitcnt lgkmcnt(8)
    v_mfma_f32_16x16x32_bf16 v[188:191], v[144:147], v[100:103], v[188:191]
    ds_read_b128 v[144:147], v2 offset:61440
    v_mfma_f32_16x16x32_bf16 v[192:195], v[148:151], v[100:103], v[192:195]
    ds_read_b128 v[148:151], v2 offset:62464
    s_waitcnt vmcnt(11)
    v_mfma_f32_16x16x32_bf16 v[176:179], v[152:155], v[104:107], v[176:179]
    ds_read_b128 v[152:155], v2 offset:63488
    v_mfma_f32_16x16x32_bf16 v[180:183], v[156:159], v[104:107], v[180:183]
    ds_read_b128 v[156:159], v2 offset:64512
    s_waitcnt lgkmcnt(8)
    v_mfma_f32_16x16x32_bf16 v[184:187], v[160:163], v[104:107], v[184:187]
    ds_read_b128 v[160:163], v5 offset:0
    v_mfma_f32_16x16x32_bf16 v[188:191], v[164:167], v[104:107], v[188:191]
    ds_read_b128 v[164:167], v5 offset:1024
    v_mfma_f32_16x16x32_bf16 v[192:195], v[168:171], v[104:107], v[192:195]
    ds_read_b128 v[168:171], v5 offset:2048
    ds_read_b32 v7, v6
    s_waitcnt vmcnt(10)
    v_mfma_f32_16x16x32_bf16 v[176:179], v[172:175], v[108:111], v[176:179]
    ds_read_b128 v[172:175], v5 offset:3072
    s_waitcnt lgkmcnt(9)
    v_mfma_f32_16x16x32_bf16 v[180:183], v[36:39], v[108:111], v[180:183]
    ds_read_b128 v[36:39], v5 offset:4096
    v_mfma_f32_16x16x32_bf16 v[184:187], v[40:43], v[108:111], v[184:187]
    ds_read_b128 v[40:43], v5 offset:5120
    v_mfma_f32_16x16x32_bf16 v[188:191], v[56:59], v[108:111], v[188:191]
    ds_read_b128 v[56:59], v5 offset:6144
    v_mfma_f32_16x16x32_bf16 v[192:195], v[60:63], v[108:111], v[192:195]
    ds_read_b128 v[60:63], v5 offset:7168
    s_waitcnt vmcnt(9)
    s_waitcnt lgkmcnt(9)
    v_mfma_f32_16x16x32_bf16 v[176:179], v[144:147], v[112:115], v[176:179]
    ds_read_b128 v[144:147], v5 offset:8192
    v_mfma_f32_16x16x32_bf16 v[180:183], v[148:151], v[112:115], v[180:183]
    ds_read_b128 v[148:151], v5 offset:9216
    s_waitcnt lgkmcnt(7)
    v_cmp_gt_u32 s[22:23], 29, v7
    v_mfma_f32_16x16x32_bf16 v[184:187], v[152:155], v[112:115], v[184:187]
    ds_read_b128 v[152:155], v5 offset:10240
    v_mov_b32 v8, 28
    v_mfma_f32_16x16x32_bf16 v[188:191], v[156:159], v[112:115], v[188:191]
    s_cmp_lg_u64 s[22:23], 0
    s_cbranch_scc1 Lw_48
Lw_48_ok:
    ds_read_b128 v[156:159], v5 offset:62464
    ds_write_b32 v15, v8
    s_waitcnt lgkmcnt(9)
    v_mfma_f32_16x16x32_bf16 v[192:195], v[160:163], v[112:115], v[192:195]
    ds_read_b128 v[160:163], v5 offset:63488
    s_waitcnt vmcnt(8)
    v_mfma_f32_16x16x32_bf16 v[176:179], v[164:167], v[116:119], v[176:179]
    ds_read_b128 v[164:167], v5 offset:64512
    v_mfma_f32_16x16x32_bf16 v[180:183], v[168:171], v[116:119], v[180:183]
    ds_read_b128 v[168:171], v9 offset:0
    v_mfma_f32_16x16x32_bf16 v[184:187], v[172:175], v[116:119], v[184:187]
    ds_read_b128 v[172:175], v9 offset:1024
    s_waitcnt lgkmcnt(9)
    v_mfma_f32_16x16x32_bf16 v[188:191], v[36:39], v[116:119], v[188:191]
    ds_read_b128 v[36:39], v9 offset:2048
    v_mfma_f32_16x16x32_bf16 v[192:195], v[40:43], v[116:119], v[192:195]
    ds_read_b128 v[40:43], v9 offset:3072
    s_waitcnt vmcnt(6)
    v_mfma_f32_16x16x32_bf16 v[176:179], v[56:59], v[120:123], v[176:179]
    ds_read_b128 v[56:59], v9 offset:4096
    v_mfma_f32_16x16x32_bf16 v[180:183], v[60:63], v[120:123], v[180:183]
    ds_read_b128 v[60:63], v9 offset:5120
    s_waitcnt lgkmcnt(9)
    v_mfma_f32_16x16x32_bf16 v[184:187], v[144:147], v[120:123], v[184:187]
    ds_read_b128 v[144:147], v9 offset:6144
    v_mfma_f32_16x16x32_bf16 v[188:191], v[148:151], v[120:123], v[188:191]
    ds_read_b128 v[148:151], v9 offset:7168
    v_mfma_f32_16x16x32_bf16 v[192:195], v[152:155], v[120:123], v[192:195]
    ds_read_b128 v[152:155], v9 offset:8192
    s_waitcnt vmcnt(5)
    v_mfma_f32_16x16x32_bf16 v[176:179], v[156:159], v[124:127], v[176:179]
    ds_read_b128 v[156:159], v9 offset:9216
    s_waitcnt lgkmcnt(8)
    v_mfma_f32_16x16x32_bf16 v[180:183], v[160:163], v[124:127], v[180:183]
    ds_read_b128 v[160:163], v9 offset:10240
    v_mfma_f32_16x16x32_bf16 v[184:187], v[164:167], v[124:127], v[184:187]
    ds_read_b128 v[164:167], v9 offset:11264
    v_mfma_f32_16x16x32_bf16 v[188:191], v[168:171], v[124:127], v[188:191]
    ds_read_b128 v[168:171], v9 offset:12288
    v_mfma_f32_16x16x32_bf16 v[192:195], v[172:175], v[124:127], v[192:195]
    ds_read_b128 v[172:175], v9 offset:13312
    s_waitcnt vmcnt(4)
    s_waitcnt lgkmcnt(8)
    v_mfma_f32_16x16x32_bf16 v[176:179], v[36:39], v[128:131], v[176:179]
    ds_read_b128 v[36:39], v9 offset:14336
    v_mfma_f32_16x16x32_bf16 v[180:183], v[40:43], v[128:131], v[180:183]
    ds_read_b128 v[40:43], v9 offset:15360
    v_mfma_f32_16x16x32_bf16 v[184:187], v[56:59], v[128:131], v[184:187]
    ds_read_b128 v[56:59], v9 offset:16384
    v_mfma_f32_16x16x32_bf16 v[188:191], v[60:63], v[128:131], v[188:191]
    ds_read_b128 v[60:63], v9 offset:17408
    s_waitcnt lgkmcnt(8)
    v_mfma_f32_16x16x32_bf16 v[192:195], v[144:147], v[128:131], v[192:195]
    ds_read_b128 v[144:147], v9 offset:18432
    s_waitcnt vmcnt(3)
    v_mfma_f32_16x16x32_bf16 v[176:179], v[148:151], v[132:135], v[176:179]
    ds_read_b128 v[148:151], v9 offset:19456
    v_mfma_f32_16x16x32_bf16 v[180:183], v[152:155], v[132:135], v[180:183]
    ds_read_b128 v[152:155], v9 offset:20480
    v_mfma_f32_16x16x32_bf16 v[184:187], v[156:159], v[132:135], v[184:187]
    ds_read_b128 v[156:159], v9 offset:21504
    s_waitcnt lgkmcnt(8)
    v_mfma_f32_16x16x32_bf16 v[188:191], v[160:163], v[132:135], v[188:191]
    v_mfma_f32_16x16x32_bf16 v[192:195], v[164:167], v[132:135], v[192:195]
    s_waitcnt vmcnt(2)
    v_mfma_f32_16x16x32_bf16 v[176:179], v[168:171], v[136:139], v[176:179]
    v_mfma_f32_16x16x32_bf16 v[180:183], v[172:175], v[136:139], v[180:183]
    s_waitcnt lgkmcnt(4)
    v_mfma_f32_16x16x32_bf16 v[184:187], v[36:39], v[136:139], v[184:187]
    v_mfma_f32_16x16x32_bf16 v[188:191], v[40:43], v[136:139], v[188:191]
    v_mfma_f32_16x16x32_bf16 v[192:195], v[56:59], v[136:139], v[192:195]
    s_waitcnt vmcnt(0)
    v_mfma_f32_16x16x32_bf16 v[176:179], v[60:63], v[140:143], v[176:179]
    s_waitcnt lgkmcnt(0)
    v_mfma_f32_16x16x32_bf16 v[180:183], v[144:147], v[140:143], v[180:183]
    v_mfma_f32_16x16x32_bf16 v[184:187], v[148:151], v[140:143], v[184:187]
    v_mfma_f32_16x16x32_bf16 v[188:191], v[152:155], v[140:143], v[188:191]
    v_mfma_f32_16x16x32_bf16 v[192:195], v[156:159], v[140:143], v[192:195]
    s_nop 2
    v_cvt_pk_bf16_f32 v218, v176, v177
    v_cvt_pk_bf16_f32 v219, v178, v179
    v_cvt_pk_bf16_f32 v220, v180, v181
    v_cvt_pk_bf16_f32 v221, v182, v183
    v_cvt_pk_bf16_f32 v222, v184, v185
    v_cvt_pk_bf16_f32 v223, v186, v187
    v_cvt_pk_bf16_f32 v224, v188, v189
    v_cvt_pk_bf16_f32 v225, v190, v191
    v_cvt_pk_bf16_f32 v226, v192, v193
    v_cvt_pk_bf16_f32 v227, v194, v195
    s_add_u32 s57, s56, 20480
    s_cmp_lg_u32 s50, 1
    s_cbranch_scc1 Lm_49
    buffer_store_dwordx4 v[218:221], v2, s[28:31], s57 offen
    buffer_store_dwordx4 v[222:225], v2, s[28:31], s57 offen offset:1024
    buffer_store_dwordx2 v[226:227], v3, s[28:31], s57 offen offset:2048
Lm_49_b:
    v_mov_b32 v240, 0
    v_mov_b32 v241, 0
    v_dot2c_f32_bf16 v240, s72, v218
    v_dot2c_f32_bf16 v241, v218, v218
    v_dot2c_f32_bf16 v240, s72, v219
    v_dot2c_f32_bf16 v241, v219, v219
    v_dot2c_f32_bf16 v240, s72, v220
    v_dot2c_f32_bf16 v241, v220, v220
    v_dot2c_f32_bf16 v240, s72, v221
    v_dot2c_f32_bf16 v241, v221, v221
    v_dot2c_f32_bf16 v240, s72, v222
    v_dot2c_f32_bf16 v241, v222, v222
    v_dot2c_f32_bf16 v240, s72, v223
    v_dot2c_f32_bf16 v241, v223, v223
    v_dot2c_f32_bf16 v240, s72, v224
    v_dot2c_f32_bf16 v241, v224, v224
    v_dot2c_f32_bf16 v240, s72, v225
    v_dot2c_f32_bf16 v241, v225, v225
    v_dot2c_f32_bf16 v240, s72, v226
    v_dot2c_f32_bf16 v241, v226, v226
    v_dot2c_f32_bf16 v240, s72, v227
    v_dot2c_f32_bf16 v241, v227, v227
    s_nop 2
    v_permlane32_swap_b32 v240, v241
    v_add_f32 v240, v240, v241
    v_mov_b32 v241, v240
    s_nop 1
    v_permlane16_swap_b32 v240, v241
    v_add_f32 v240, v240, v241
    v_mov_b32 v241, v240
    s_nop 1
    v_permlane32_swap_b32 v240, v241
    v_mov_b32 v242, s48
    v_mov_b32 v243, s49
    s_lshl_b32 s57, s43, 8
    s_add_u32 s57, s57, s55
    s_add_u32 s57, s57, 113664
    s_waitcnt vmcnt(0)
    s_mov_b64 exec, 0xffff
    s_cmp_lg_u32 s50, 1
    s_cbranch_scc1 Lm_50
    buffer_store_dwordx4 v[240:243], v2, s[28:31], s57 offen
Lm_50_b:
    s_mov_b64 exec, -1
L_P5:
Lsp_51:
    ds_read_b32 v7, v6 offset:0
    s_waitcnt lgkmcnt(0)
    v_cmp_gt_u32 vcc, 30, v7
    s_cbranch_vccz Lsp_51_ok
    s_cmp_eq_u32 s46, 0
    s_cbranch_scc1 Lsp_51_ok
    s_sub_u32 s46, s46, 1
    s_branch Lsp_51
Lsp_51_ok:
    ds_read_b128 v[144:147], v5 offset:16384
    ds_read_b128 v[148:151], v5 offset:17408
    ds_read_b128 v[152:155], v5 offset:18432
    ds_read_b128 v[156:159], v5 offset:19456
    ds_read_b128 v[160:163], v5 offset:20480
    ds_read_b128 v[164:167], v5 offset:21504
    ds_read_b128 v[168:171], v5 offset:22528
    ds_read_b128 v[172:175], v5 offset:23552
    ds_read_b128 v[36:39], v5 offset:24576
    ds_read_b128 v[40:43], v5 offset:25600
    ds_read_b128 v[56:59], v5 offset:26624
    ds_read_b128 v[60:63], v5 offset:27648
    ds_read_b128 v[176:179], v21 offset:320
    ds_read_b128 v[180:183], v21 offset:384
    ds_read_b128 v[184:187], v21 offset:448
    ds_read_b128 v[188:191], v21 offset:512
    ds_read_b128 v[192:195], v21 offset:576
    ds_read_b128 v[196:199], v21 offset:640
    ds_read_b128 v[200:203], v21 offset:704
    ds_read_b128 v[204:207], v21 offset:768
    s_mov_b32 s57, 113664
Lp_52:
    buffer_load_dwordx4 v[240:243], v18, s[28:31], s57 offen sc1
    buffer_load_dwordx4 v[244:247], v18, s[28:31], s57 offen offset:1024 sc1
    s_waitcnt vmcnt(0)
    v_cmp_ne_u64 vcc, s[48:49], v[242:243]
    v_cmp_ne_u64 s[26:27], s[48:49], v[246:247]
    s_or_b64 vcc, vcc, s[26:27]
    s_cbranch_scc0 Lp_52_ok
    s_cmp_eq_u32 s46, 0
    s_cbranch_scc1 Lp_52_ok
    s_sub_u32 s46, s46, 1
    s_branch Lp_52
Lp_52_ok:
    s_mul_i32 s57, s51, 5120
    s_add_u32 s57, s57, 20480
    buffer_load_dwordx4 v[64:67], v18, s[28:31], s57 offen offset:0 sc1
    buffer_load_dwordx4 v[68:71], v18, s[28:31], s57 offen offset:1024 sc1
    buffer_load_dwordx4 v[72:75], v18, s[28:31], s57 offen offset:2560 sc1
    buffer_load_dwordx4 v[76:79], v18, s[28:31], s57 offen offset:3584 sc1
    buffer_load_dwordx2 v[80:81], v19, s[28:31], s57 offen sc1
    buffer_load_dwordx2 v[82:83], v19, s[28:31], s57 offen offset:2560 sc1
    s_mul_i32 s57, s52, 5120
    s_add_u32 s57, s57, 20480
    buffer_load_dwordx4 v[84:87], v18, s[28:31], s57 offen offset:0 sc1
    buffer_load_dwordx4 v[88:91], v18, s[28:31], s57 offen offset:1024 sc1
    buffer_load_dwordx4 v[92:95], v18, s[28:31], s57 offen offset:2560 sc1
    buffer_load_dwordx4 v[96:99], v18, s[28:31], s57 offen offset:3584 sc1
    buffer_load_dwordx2 v[100:101], v19, s[28:31], s57 offen sc1
    buffer_load_dwordx2 v[102:103], v19, s[28:31], s57 offen offset:2560 sc1
    s_mul_i32 s57, s53, 5120
    s_add_u32 s57, s57, 20480
    buffer_load_dwordx4 v[104:107], v18, s[28:31], s57 offen offset:0 sc1
    buffer_load_dwordx4 v[108:111], v18, s[28:31], s57 offen offset:1024 sc1
    buffer_load_dwordx4 v[112:115], v18, s[28:31], s57 offen offset:2560 sc1
    buffer_load_dwordx4 v[116:119], v18, s[28:31], s57 offen offset:3584 sc1
    buffer_load_dwordx2 v[120:121], v19, s[28:31], s57 offen sc1
    buffer_load_dwordx2 v[122:123], v19, s[28:31], s57 offen offset:2560 sc1
    s_mul_i32 s57, s54, 5120
    s_add_u32 s57, s57, 20480
    buffer_load_dwordx4 v[124:127], v18, s[28:31], s57 offen offset:0 sc1
    buffer_load_dwordx4 v[128:131], v18, s[28:31], s57 offen offset:1024 sc1
    buffer_load_dwordx4 v[132:135], v18, s[28:31], s57 offen offset:2560 sc1
    buffer_load_dwordx4 v[136:139], v18, s[28:31], s57 offen offset:3584 sc1
    buffer_load_dwordx2 v[140:141], v19, s[28:31], s57 offen sc1
    buffer_load_dwordx2 v[142:143], v19, s[28:31], s57 offen offset:2560 sc1
    v_add_f32 v32, v240, v244
    v_add_f32 v34, v241, v245
    s_nop 1
    v_permlane32_swap_b32 v32, v34
    v_add_f32 v32, v32, v34
    v_mov_b32 v34, v32
    s_nop 1
    v_permlane16_swap_b32 v32, v34
    v_add_f32 v32, v32, v34
    v_mov_b32 v34, v32
    s_nop 1
    v_permlane32_swap_b32 v32, v34
    v_mul_f32 v32, 0xbacccccd, v32
    s_waitcnt lgkmcnt(0)
    v_mul_f32 v176, v32, v176
    v_mul_f32 v177, v32, v177
    v_mul_f32 v178, v32, v178
    v_mul_f32 v179, v32, v179
    v_mul_f32 v180, v32, v180
    v_mul_f32 v181, v32, v181
    v_mul_f32 v182, v32, v182
    v_mul_f32 v183, v32, v183
    v_mul_f32 v184, v32, v184
    v_mul_f32 v185, v32, v185
    v_mul_f32 v186, v32, v186
    v_mul_f32 v187, v32, v187
    v_mul_f32 v188, v32, v188
    v_mul_f32 v189, v32, v189
    v_mul_f32 v190, v32, v190
    v_mul_f32 v191, v32, v191
    s_waitcnt vmcnt(23)
    v_mfma_f32_16x16x32_bf16 v[176:179], v[144:147], v[64:67], v[176:179]
    ds_read_b128 v[144:147], v5 offset:28672
    ds_read_b32 v7, v6
    v_mul_f32 v192, v32, v192
    v_mfma_f32_16x16x32_bf16 v[180:183], v[148:151], v[64:67], v[180:183]
    ds_read_b128 v[148:151], v5 offset:29696
    v_mul_f32 v193, v32, v193
    v_mfma_f32_16x16x32_bf16 v[184:187], v[152:155], v[64:67], v[184:187]
    ds_read_b128 v[152:155], v5 offset:30720
    v_mul_f32 v194, v32, v194
    v_mfma_f32_16x16x32_bf16 v[188:191], v[156:159], v[64:67], v[188:191]
    ds_read_b128 v[156:159], v5 offset:31744
    v_mul_f32 v195, v32, v195
    s_waitcnt vmcnt(22)
    v_mfma_f32_16x16x32_bf16 v[176:179], v[160:163], v[68:71], v[176:179]
    ds_read_b128 v[160:163], v5 offset:32768
    v_mul_f32 v196, v32, v196
    v_mfma_f32_16x16x32_bf16 v[180:183], v[164:167], v[68:71], v[180:183]
    ds_read_b128 v[164:167], v5 offset:33792
    v_mul_f32 v197, v32, v197
    v_mfma_f32_16x16x32_bf16 v[184:187], v[168:171], v[68:71], v[184:187]
    ds_read_b128 v[168:171], v5 offset:34816
    s_waitcnt lgkmcnt(6)
    v_cmp_gt_u32 s[22:23], 31, v7
    v_mul_f32 v198, v32, v198
    v_mfma_f32_16x16x32_bf16 v[188:191], v[172:175], v[68:71], v[188:191]
    ds_read_b128 v[172:175], v5 offset:35840
    v_mov_b32 v8, 30
    v_mul_f32 v199, v32, v199
    s_waitcnt vmcnt(21)
    v_mfma_f32_16x16x32_bf16 v[176:179], v[36:39], v[72:75], v[176:179]
    s_cmp_lg_u64 s[22:23], 0
    s_cbranch_scc1 Lw_53
Lw_53_ok:
    ds_read_b128 v[36:39], v5 offset:36864
    ds_write_b32 v15, v8
    v_mul_f32 v200, v32, v200
    v_mfma_f32_16x16x32_bf16 v[180:183], v[40:43], v[72:75], v[180:183]
    ds_read_b128 v[40:43], v5 offset:37888
    v_mul_f32 v201, v32, v201
    v_mfma_f32_16x16x32_bf16 v[184:187], v[56:59], v[72:75], v[184:187]
    ds_read_b128 v[56:59], v5 offset:38912
    v_mul_f32 v202, v32, v202
    v_mfma_f32_16x16x32_bf16 v[188:191], v[60:63], v[72:75], v[188:191]
    ds_read_b128 v[60:63], v5 offset:39936
    v_mul_f32 v203, v32, v203
    s_waitcnt vmcnt(20)
    s_waitcnt lgkmcnt(9)
    v_mfma_f32_16x16x32_bf16 v[176:179], v[144:147], v[76:79], v[176:179]
    ds_read_b128 v[144:147], v5 offset:40960
    v_mul_f32 v204, v32, v204
    v_mfma_f32_16x16x32_bf16 v[180:183], v[148:151], v[76:79], v[180:183]
    ds_read_b128 v[148:151], v5 offset:41984
    v_mul_f32 v205, v32, v205
    v_mfma_f32_16x16x32_bf16 v[184:187], v[152:155], v[76:79], v[184:187]
    ds_read_b128 v[152:155], v5 offset:43008
    v_mul_f32 v206, v32, v206
    v_mfma_f32_16x16x32_bf16 v[188:191], v[156:159], v[76:79], v[188:191]
    ds_read_b128 v[156:159], v5 offset:44032
    v_mul_f32 v207, v32, v207
    s_waitcnt vmcnt(18)
    s_waitcnt lgkmcnt(9)
    v_mfma_f32_16x16x32_bf16 v[176:179], v[160:163], v[80:83], v[176:179]
    ds_read_b128 v[160:163], v5 offset:45056
    v_mul_f32 v34, 0x3acccccd, v34
    v_mfma_f32_16x16x32_bf16 v[180:183], v[164:167], v[80:83], v[180:183]
    ds_read_b128 v[164:167], v5 offset:46080
    v_fma_f32 v34, -v32, v32, v34
    v_mfma_f32_16x16x32_bf16 v[184:187], v[168:171], v[80:83], v[184:187]
    ds_read_b128 v[168:171], v5 offset:47104
    v_max_f32 v34, 0, v34
    v_mfma_f32_16x16x32_bf16 v[188:191], v[172:175], v[80:83], v[188:191]
    ds_read_b128 v[172:175], v5 offset:48128
    ds_read_b32 v7, v6
    v_add_f32 v35, 0x3727c5ac, v34
    s_waitcnt vmcnt(17)
    s_waitcnt lgkmcnt(9)
    v_mfma_f32_16x16x32_bf16 v[176:179], v[36:39], v[84:87], v[176:179]
    ds_read_b128 v[36:39], v5 offset:49152
    v_rsq_f32 v35, v35
    v_mfma_f32_16x16x32_bf16 v[180:183], v[40:43], v[84:87], v[180:183]
    ds_read_b128 v[40:43], v5 offset:50176
    v_mul_f32 v28, 0xc0135761, v35
    v_mfma_f32_16x16x32_bf16 v[184:187], v[56:59], v[84:87], v[184:187]
    ds_read_b128 v[56:59], v5 offset:51200
    v_mul_f32 v29, v35, v35
    v_mfma_f32_16x16x32_bf16 v[188:191], v[60:63], v[84:87], v[188:191]
    ds_read_b128 v[60:63], v5 offset:52224
    v_mul_f32 v29, v29, v28
    s_waitcnt vmcnt(16)
    s_waitcnt lgkmcnt(9)
    v_mfma_f32_16x16x32_bf16 v[176:179], v[144:147], v[88:91], v[176:179]
    ds_read_b128 v[144:147], v5 offset:53248
    v_mul_f32 v29, 0x3d372713, v29
    v_mfma_f32_16x16x32_bf16 v[180:183], v[148:151], v[88:91], v[180:183]
    ds_read_b128 v[148:151], v5 offset:54272
    v_rcp_f32 v30, v35
    v_mfma_f32_16x16x32_bf16 v[184:187], v[152:155], v[88:91], v[184:187]
    ds_read_b128 v[152:155], v5 offset:55296
    s_waitcnt lgkmcnt(7)
    v_cmp_gt_u32 s[22:23], 32, v7
    v_mfma_f32_16x16x32_bf16 v[188:191], v[156:159], v[88:91], v[188:191]
    ds_read_b128 v[156:159], v5 offset:56320
    s_waitcnt vmcnt(15)
    v_mfma_f32_16x16x32_bf16 v[176:179], v[160:163], v[92:95], v[176:179]
    s_cmp_lg_u64 s[22:23], 0
    s_cbranch_scc1 Lw_54
Lw_54_ok:
    ds_read_b128 v[160:163], v2 offset:0
    v_mfma_f32_16x16x32_bf16 v[180:183], v[164:167], v[92:95], v[180:183]
    ds_read_b128 v[164:167], v2 offset:1024
    v_mfma_f32_16x16x32_bf16 v[184:187], v[168:171], v[92:95], v[184:187]
    ds_read_b128 v[168:171], v2 offset:2048
    v_mfma_f32_16x16x32_bf16 v[188:191], v[172:175], v[92:95], v[188:191]
    ds_read_b128 v[172:175], v2 offset:3072
    s_waitcnt vmcnt(14)
    s_waitcnt lgkmcnt(8)
    v_mfma_f32_16x16x32_bf16 v[176:179], v[36:39], v[96:99], v[176:179]
    ds_read_b128 v[36:39], v2 offset:4096
    v_mfma_f32_16x16x32_bf16 v[180:183], v[40:43], v[96:99], v[180:183]
    ds_read_b128 v[40:43], v2 offset:5120
    v_mfma_f32_16x16x32_bf16 v[184:187], v[56:59], v[96:99], v[184:187]
    ds_read_b128 v[56:59], v2 offset:6144
    v_mfma_f32_16x16x32_bf16 v[188:191], v[60:63], v[96:99], v[188:191]
    ds_read_b128 v[60:63], v2 offset:7168
    s_waitcnt vmcnt(12)
    s_waitcnt lgkmcnt(8)
    v_mfma_f32_16x16x32_bf16 v[176:179], v[144:147], v[100:103], v[176:179]
    ds_read_b128 v[144:147], v2 offset:8192
    v_mfma_f32_16x16x32_bf16 v[180:183], v[148:151], v[100:103], v[180:183]
    ds_read_b128 v[148:151], v2 offset:9216
    v_mfma_f32_16x16x32_bf16 v[184:187], v[152:155], v[100:103], v[184:187]
    ds_read_b128 v[152:155], v2 offset:10240
    v_mfma_f32_16x16x32_bf16 v[188:191], v[156:159], v[100:103], v[188:191]
    ds_read_b128 v[156:159], v2 offset:11264
    ds_read_b32 v7, v6
    s_waitcnt vmcnt(11)
    s_waitcnt lgkmcnt(9)
    v_mfma_f32_16x16x32_bf16 v[176:179], v[160:163], v[104:107], v[176:179]
    ds_read_b128 v[160:163], v2 offset:12288
    v_mfma_f32_16x16x32_bf16 v[180:183], v[164:167], v[104:107], v[180:183]
    ds_read_b128 v[164:167], v2 offset:13312
    v_mfma_f32_16x16x32_bf16 v[184:187], v[168:171], v[104:107], v[184:187]
    ds_read_b128 v[168:171], v2 offset:14336
    v_mfma_f32_16x16x32_bf16 v[188:191], v[172:175], v[104:107], v[188:191]
    ds_read_b128 v[172:175], v2 offset:15360
    s_waitcnt vmcnt(10)
    s_waitcnt lgkmcnt(9)
    v_mfma_f32_16x16x32_bf16 v[176:179], v[36:39], v[108:111], v[176:179]
    ds_read_b128 v[36:39], v2 offset:16384
    v_mfma_f32_16x16x32_bf16 v[180:183], v[40:43], v[108:111], v[180:183]
    ds_read_b128 v[40:43], v2 offset:17408
    v_mfma_f32_16x16x32_bf16 v[184:187], v[56:59], v[108:111], v[184:187]
    ds_read_b128 v[56:59], v2 offset:18432
    s_waitcnt lgkmcnt(7)
    v_cmp_gt_u32 s[22:23], 33, v7
    v_mfma_f32_16x16x32_bf16 v[188:191], v[60:63], v[108:111], v[188:191]
    ds_read_b128 v[60:63], v2 offset:19456
    v_mov_b32 v8, 32
    s_waitcnt vmcnt(9)
    v_mfma_f32_16x16x32_bf16 v[176:179], v[144:147], v[112:115], v[176:179]
    s_cmp_lg_u64 s[22:23], 0
    s_cbranch_scc1 Lw_55
Lw_55_ok:
    ds_read_b128 v[144:147], v2 offset:20480
    ds_write_b32 v15, v8
    v_mfma_f32_16x16x32_bf16 v[180:183], v[148:151], v[112:115], v[180:183]
    ds_read_b128 v[148:151], v2 offset:21504
    v_mfma_f32_16x16x32_bf16 v[184:187], v[152:155], v[112:115], v[184:187]
    ds_read_b128 v[152:155], v2 offset:22528
    v_mfma_f32_16x16x32_bf16 v[188:191], v[156:159], v[112:115], v[188:191]
    ds_read_b128 v[156:159], v2 offset:23552
    s_waitcnt vmcnt(8)
    s_waitcnt lgkmcnt(9)
    v_mfma_f32_16x16x32_bf16 v[176:179], v[160:163], v[116:119], v[176:179]
    ds_read_b128 v[160:163], v2 offset:24576
    v_mfma_f32_16x16x32_bf16 v[180:183], v[164:167], v[116:119], v[180:183]
    ds_read_b128 v[164:167], v2 offset:25600
    v_mfma_f32_16x16x32_bf16 v[184:187], v[168:171], v[116:119], v[184:187]
    ds_read_b128 v[168:171], v2 offset:26624
    v_mfma_f32_16x16x32_bf16 v[188:191], v[172:175], v[116:119], v[188:191]
    ds_read_b128 v[172:175], v2 offset:27648
    s_waitcnt vmcnt(6)
    s_waitcnt lgkmcnt(9)
    v_mfma_f32_16x16x32_bf16 v[176:179], v[36:39], v[120:123], v[176:179]
    ds_read_b128 v[36:39], v2 offset:28672
    v_mfma_f32_16x16x32_bf16 v[180:183], v[40:43], v[120:123], v[180:183]
    ds_read_b128 v[40:43], v2 offset:29696
    v_mfma_f32_16x16x32_bf16 v[184:187], v[56:59], v[120:123], v[184:187]
    ds_read_b128 v[56:59], v2 offset:30720
    v_mfma_f32_16x16x32_bf16 v[188:191], v[60:63], v[120:123], v[188:191]
    ds_read_b128 v[60:63], v2 offset:31744
    ds_read_b32 v7, v6
    s_waitcnt vmcnt(5)
    s_waitcnt lgkmcnt(9)
    v_mfma_f32_16x16x32_bf16 v[176:179], v[144:147], v[124:127], v[176:179]
    ds_read_b128 v[144:147], v2 offset:32768
    v_mfma_f32_16x16x32_bf16 v[180:183], v[148:151], v[124:127], v[180:183]
    ds_read_b128 v[148:151], v2 offset:33792
    v_mfma_f32_16x16x32_bf16 v[184:187], v[152:155], v[124:127], v[184:187]
    ds_read_b128 v[152:155], v2 offset:34816
    v_mfma_f32_16x16x32_bf16 v[188:191], v[156:159], v[124:127], v[188:191]
    ds_read_b128 v[156:159], v2 offset:35840
    s_waitcnt vmcnt(4)
    s_waitcnt lgkmcnt(9)
    v_mfma_f32_16x16x32_bf16 v[176:179], v[160:163], v[128:131], v[176:179]
    ds_read_b128 v[160:163], v2 offset:36864
    v_mfma_f32_16x16x32_bf16 v[180:183], v[164:167], v[128:131], v[180:183]
    ds_read_b128 v[164:167], v2 offset:37888
    v_mfma_f32_16x16x32_bf16 v[184:187], v[168:171], v[128:131], v[184:187]
    ds_read_b128 v[168:171], v2 offset:38912
    s_waitcnt lgkmcnt(7)
    v_cmp_gt_u32 s[22:23], 34, v7
    v_mfma_f32_16x16x32_bf16 v[188:191], v[172:175], v[128:131], v[188:191]
    ds_read_b128 v[172:175], v2 offset:39936
    s_waitcnt vmcnt(3)
    v_mfma_f32_16x16x32_bf16 v[176:179], v[36:39], v[132:135], v[176:179]
    s_cmp_lg_u64 s[22:23], 0
    s_cbranch_scc1 Lw_56
Lw_56_ok:
    ds_read_b128 v[36:39], v2 offset:40960
    v_mfma_f32_16x16x32_bf16 v[180:183], v[40:43], v[132:135], v[180:183]
    ds_read_b128 v[40:43], v2 offset:41984
    v_mfma_f32_16x16x32_bf16 v[184:187], v[56:59], v[132:135], v[184:187]
    ds_read_b128 v[56:59], v2 offset:43008
    v_mfma_f32_16x16x32_bf16 v[188:191], v[60:63], v[132:135], v[188:191]
    ds_read_b128 v[60:63], v2 offset:44032
    s_waitcnt vmcnt(2)
    s_waitcnt lgkmcnt(8)
    v_mfma_f32_16x16x32_bf16 v[176:179], v[144:147], v[136:139], v[176:179]
    ds_read_b128 v[144:147], v2 offset:45056
    v_mfma_f32_16x16x32_bf16 v[180:183], v[148:151], v[136:139], v[180:183]
    ds_read_b128 v[148:151], v2 offset:46080
    v_mfma_f32_16x16x32_bf16 v[184:187], v[152:155], v[136:139], v[184:187]
    ds_read_b128 v[152:155], v2 offset:47104
    v_mfma_f32_16x16x32_bf16 v[188:191], v[156:159], v[136:139], v[188:191]
    ds_read_b128 v[156:159], v2 offset:48128
    s_waitcnt vmcnt(0)
    s_waitcnt lgkmcnt(8)
    v_mfma_f32_16x16x32_bf16 v[176:179], v[160:163], v[140:143], v[176:179]
    ds_read_b128 v[160:163], v2 offset:49152
    v_mfma_f32_16x16x32_bf16 v[180:183], v[164:167], v[140:143], v[180:183]
    ds_read_b128 v[164:167], v2 offset:50176
    v_mfma_f32_16x16x32_bf16 v[184:187], v[168:171], v[140:143], v[184:187]
    ds_read_b128 v[168:171], v2 offset:51200
    v_mfma_f32_16x16x32_bf16 v[188:191], v[172:175], v[140:143], v[188:191]
    ds_read_b128 v[172:175], v2 offset:52224
    ds_read_b32 v7, v6
    s_waitcnt lgkmcnt(9)
    v_mfma_f32_16x16x32_bf16 v[192:195], v[36:39], v[64:67], v[192:195]
    ds_read_b128 v[36:39], v2 offset:53248
    v_mfma_f32_16x16x32_bf16 v[196:199], v[40:43], v[64:67], v[196:199]
    ds_read_b128 v[40:43], v2 offset:54272
    v_mfma_f32_16x16x32_bf16 v[200:203], v[56:59], v[64:67], v[200:203]
    ds_read_b128 v[56:59], v2 offset:55296
    v_mfma_f32_16x16x32_bf16 v[204:207], v[60:63], v[64:67], v[204:207]
    ds_read_b128 v[60:63], v2 offset:56320
    v_mul_f32 v240, v176, v176
    s_waitcnt lgkmcnt(9)
    v_mfma_f32_16x16x32_bf16 v[192:195], v[144:147], v[68:71], v[192:195]
    ds_read_b128 v[144:147], v2 offset:57344
    v_mul_f32 v241, v177, v177
    v_mul_f32 v242, v178, v178
    v_mfma_f32_16x16x32_bf16 v[196:199], v[148:151], v[68:71], v[196:199]
    ds_read_b128 v[148:151], v2 offset:58368
    v_mul_f32 v243, v179, v179
    v_fma_f32 v240, v240, v29, v28
    v_mfma_f32_16x16x32_bf16 v[200:203], v[152:155], v[68:71], v[200:203]
    ds_read_b128 v[152:155], v2 offset:59392
    s_waitcnt lgkmcnt(7)
    v_cmp_gt_u32 s[22:23], 35, v7
    v_fma_f32 v241, v241, v29, v28
    v_fma_f32 v242, v242, v29, v28
    v_mfma_f32_16x16x32_bf16 v[204:207], v[156:159], v[68:71], v[204:207]
    ds_read_b128 v[156:159], v2 offset:60416
    v_mov_b32 v8, 34
    v_fma_f32 v243, v243, v29, v28
    v_mul_f32 v240, v240, v176
    v_mfma_f32_16x16x32_bf16 v[192:195], v[160:163], v[72:75], v[192:195]
    s_cmp_lg_u64 s[22:23], 0
    s_cbranch_scc1 Lw_57
Lw_57_ok:
    ds_read_b128 v[160:163], v2 offset:61440
    ds_write_b32 v15, v8
    v_mul_f32 v241, v241, v177
    v_mul_f32 v242, v242, v178
    v_mfma_f32_16x16x32_bf16 v[196:199], v[164:167], v[72:75], v[196:199]
    ds_read_b128 v[164:167], v2 offset:62464
    v_mul_f32 v243, v243, v179
    v_exp_f32 v240, v240
    v_mfma_f32_16x16x32_bf16 v[200:203], v[168:171], v[72:75], v[200:203]
    ds_read_b128 v[168:171], v2 offset:63488
    v_exp_f32 v241, v241
    v_exp_f32 v242, v242
    v_mfma_f32_16x16x32_bf16 v[204:207], v[172:175], v[72:75], v[204:207]
    ds_read_b128 v[172:175], v2 offset:64512
    v_exp_f32 v243, v243
    v_fma_f32 v240, v240, v30, v30
    s_waitcnt lgkmcnt(9)
    v_mfma_f32_16x16x32_bf16 v[192:195], v[36:39], v[76:79], v[192:195]
    ds_read_b128 v[36:39], v5 offset:0
    v_fma_f32 v241, v241, v30, v30
    v_fma_f32 v242, v242, v30, v30
    v_mfma_f32_16x16x32_bf16 v[196:199], v[40:43], v[76:79], v[196:199]
    ds_read_b128 v[40:43], v5 offset:1024
    v_fma_f32 v243, v243, v30, v30
    v_rcp_f32 v240, v240
    v_mfma_f32_16x16x32_bf16 v[200:203], v[56:59], v[76:79], v[200:203]
    ds_read_b128 v[56:59], v5 offset:2048
    v_rcp_f32 v241, v241
    v_rcp_f32 v242, v242
    v_mfma_f32_16x16x32_bf16 v[204:207], v[60:63], v[76:79], v[204:207]
    ds_read_b128 v[60:63], v5 offset:3072
    v_rcp_f32 v243, v243
    v_mul_f32 v240, v240, v176
    s_waitcnt lgkmcnt(9)
    v_mfma_f32_16x16x32_bf16 v[192:195], v[144:147], v[80:83], v[192:195]
    ds_read_b128 v[144:147], v5 offset:4096
    v_mul_f32 v241, v241, v177
    v_mul_f32 v242, v242, v178
    v_mfma_f32_16x16x32_bf16 v[196:199], v[148:151], v[80:83], v[196:199]
    ds_read_b128 v[148:151], v5 offset:5120
    v_mul_f32 v243, v243, v179
    v_cvt_pk_bf16_f32 v228, v240, v241
    v_mfma_f32_16x16x32_bf16 v[200:203], v[152:155], v[80:83], v[200:203]
    ds_read_b128 v[152:155], v5 offset:6144
    v_cvt_pk_bf16_f32 v229, v242, v243
    v_mul_f32 v240, v180, v180
    v_mfma_f32_16x16x32_bf16 v[204:207], v[156:159], v[80:83], v[204:207]
    ds_read_b128 v[156:159], v5 offset:7168
    ds_read_b32 v7, v6
    v_mul_f32 v241, v181, v181
    v_mul_f32 v242, v182, v182
    s_waitcnt lgkmcnt(9)
    v_mfma_f32_16x16x32_bf16 v[192:195], v[160:163], v[84:87], v[192:195]
    ds_read_b128 v[160:163], v5 offset:8192
    v_mul_f32 v243, v183, v183
    v_fma_f32 v240, v240, v29, v28
    v_mfma_f32_16x16x32_bf16 v[196:199], v[164:167], v[84:87], v[196:199]
    ds_read_b128 v[164:167], v5 offset:9216
    v_fma_f32 v241, v241, v29, v28
    v_fma_f32 v242, v242, v29, v28
    v_mfma_f32_16x16x32_bf16 v[200:203], v[168:171], v[84:87], v[200:203]
    ds_read_b128 v[168:171], v5 offset:10240
    v_fma_f32 v243, v243, v29, v28
    v_mul_f32 v240, v240, v180
    v_mfma_f32_16x16x32_bf16 v[204:207], v[172:175], v[84:87], v[204:207]
    ds_read_b128 v[172:175], v5 offset:11264
    v_mul_f32 v241, v241, v181
    v_mul_f32 v242, v242, v182
    s_waitcnt lgkmcnt(9)
    v_mfma_f32_16x16x32_bf16 v[192:195], v[36:39], v[88:91], v[192:195]
    ds_read_b128 v[36:39], v5 offset:12288
    v_mul_f32 v243, v243, v183
    v_exp_f32 v240, v240
    v_mfma_f32_16x16x32_bf16 v[196:199], v[40:43], v[88:91], v[196:199]
    ds_read_b128 v[40:43], v5 offset:13312
    v_exp_f32 v241, v241
    v_exp_f32 v242, v242
    v_mfma_f32_16x16x32_bf16 v[200:203], v[56:59], v[88:91], v[200:203]
    ds_read_b128 v[56:59], v5 offset:14336
    s_waitcnt lgkmcnt(7)
    v_cmp_gt_u32 s[22:23], 36, v7
    v_exp_f32 v243, v243
    v_fma_f32 v240, v240, v30, v30
    v_mfma_f32_16x16x32_bf16 v[204:207], v[60:63], v[88:91], v[204:207]
    ds_read_b128 v[60:63], v5 offset:15360
    v_fma_f32 v241, v241, v30, v30
    v_fma_f32 v242, v242, v30, v30
    v_mfma_f32_16x16x32_bf16 v[192:195], v[144:147], v[92:95], v[192:195]
    s_cmp_lg_u64 s[22:23], 0
    s_cbranch_scc1 Lw_58
Lw_58_ok:
    ds_read_b128 v[144:147], v5 offset:57344
    v_fma_f32 v243, v243, v30, v30
    v_rcp_f32 v240, v240
    v_mfma_f32_16x16x32_bf16 v[196:199], v[148:151], v[92:95], v[196:199]
    ds_read_b128 v[148:151], v5 offset:58368
    v_rcp_f32 v241, v241
    v_rcp_f32 v242, v242
    v_mfma_f32_16x16x32_bf16 v[200:203], v[152:155], v[92:95], v[200:203]
    ds_read_b128 v[152:155], v5 offset:59392
    v_rcp_f32 v243, v243
    v_mul_f32 v240, v240, v180
    v_mfma_f32_16x16x32_bf16 v[204:207], v[156:159], v[92:95], v[204:207]
    ds_read_b128 v[156:159], v5 offset:60416
    v_mul_f32 v241, v241, v181
    v_mul_f32 v242, v242, v182
    s_waitcnt lgkmcnt(8)
    v_mfma_f32_16x16x32_bf16 v[192:195], v[160:163], v[96:99], v[192:195]
    ds_read_b128 v[160:163], v5 offset:61440
    v_mul_f32 v243, v243, v183
    v_cvt_pk_bf16_f32 v230, v240, v241
    v_mfma_f32_16x16x32_bf16 v[196:199], v[164:167], v[96:99], v[196:199]
    ds_read_b128 v[164:167], v5 offset:62464
    v_cvt_pk_bf16_f32 v231, v242, v243
    v_mfma_f32_16x16x32_bf16 v[200:203], v[168:171], v[96:99], v[200:203]
    ds_read_b128 v[168:171], v5 offset:63488
    v_mul_f32 v240, v184, v184
    v_mul_f32 v241, v185, v185
    v_mfma_f32_16x16x32_bf16 v[204:207], v[172:175], v[96:99], v[204:207]
    ds_read_b128 v[172:175], v5 offset:64512
    v_mul_f32 v242, v186, v186
    v_mul_f32 v243, v187, v187
    s_waitcnt lgkmcnt(8)
    v_mfma_f32_16x16x32_bf16 v[192:195], v[36:39], v[100:103], v[192:195]
    ds_read_b128 v[36:39], v9 offset:0
    v_fma_f32 v240, v240, v29, v28
    v_fma_f32 v241, v241, v29, v28
    v_mfma_f32_16x16x32_bf16 v[196:199], v[40:43], v[100:103], v[196:199]
    ds_read_b128 v[40:43], v9 offset:1024
    v_fma_f32 v242, v242, v29, v28
    v_fma_f32 v243, v243, v29, v28
    v_mfma_f32_16x16x32_bf16 v[200:203], v[56:59], v[100:103], v[200:203]
    ds_read_b128 v[56:59], v9 offset:2048
    v_mul_f32 v240, v240, v184
    v_mul_f32 v241, v241, v185
    v_mfma_f32_16x16x32_bf16 v[204:207], v[60:63], v[100:103], v[204:207]
    ds_read_b128 v[60:63], v9 offset:3072
    ds_read_b32 v7, v6
    v_mul_f32 v242, v242, v186
    v_mul_f32 v243, v243, v187
    s_waitcnt lgkmcnt(9)
    v_mfma_f32_16x16x32_bf16 v[192:195], v[144:147], v[104:107], v[192:195]
    ds_read_b128 v[144:147], v9 offset:4096
    v_exp_f32 v240, v240
    v_exp_f32 v241, v241
    v_mfma_f32_16x16x32_bf16 v[196:199], v[148:151], v[104:107], v[196:199]
    ds_read_b128 v[148:151], v9 offset:5120
    v_exp_f32 v242, v242
    v_exp_f32 v243, v243
    v_mfma_f32_16x16x32_bf16 v[200:203], v[152:155], v[104:107], v[200:203]
    ds_read_b128 v[152:155], v9 offset:6144
    v_fma_f32 v240, v240, v30, v30
    v_fma_f32 v241, v241, v30, v30
    v_mfma_f32_16x16x32_bf16 v[204:207], v[156:159], v[104:107], v[204:207]
    ds_read_b128 v[156:159], v9 offset:7168
    v_fma_f32 v242, v242, v30, v30
    v_fma_f32 v243, v243, v30, v30
    s_waitcnt lgkmcnt(9)
    v_mfma_f32_16x16x32_bf16 v[192:195], v[160:163], v[108:111], v[192:195]
    ds_read_b128 v[160:163], v9 offset:8192
    v_rcp_f32 v240, v240
    v_rcp_f32 v241, v241
    v_mfma_f32_16x16x32_bf16 v[196:199], v[164:167], v[108:111], v[196:199]
    ds_read_b128 v[164:167], v9 offset:9216
    v_rcp_f32 v242, v242
    v_rcp_f32 v243, v243
    v_mfma_f32_16x16x32_bf16 v[200:203], v[168:171], v[108:111], v[200:203]
    ds_read_b128 v[168:171], v9 offset:10240
    s_waitcnt lgkmcnt(7)
    v_cmp_gt_u32 s[22:23], 37, v7
    v_mul_f32 v240, v240, v184
    v_mul_f32 v241, v241, v185
    v_mfma_f32_16x16x32_bf16 v[204:207], v[172:175], v[108:111], v[204:207]
    ds_read_b128 v[172:175], v9 offset:11264
    v_mov_b32 v8, 36
    v_mul_f32 v242, v242, v186
    v_mul_f32 v243, v243, v187
    v_mfma_f32_16x16x32_bf16 v[192:195], v[36:39], v[112:115], v[192:195]
    s_cmp_lg_u64 s[22:23], 0
    s_cbranch_scc1 Lw_59
Lw_59_ok:
    ds_read_b128 v[36:39], v5 offset:16384
    ds_write_b32 v15, v8
    v_cvt_pk_bf16_f32 v232, v240, v241
    v_cvt_pk_bf16_f32 v233, v242, v243
    v_mfma_f32_16x16x32_bf16 v[196:199], v[40:43], v[112:115], v[196:199]
    ds_read_b128 v[40:43], v5 offset:17408
    v_mul_f32 v240, v188, v188
    v_mul_f32 v241, v189, v189
    v_mfma_f32_16x16x32_bf16 v[200:203], v[56:59], v[112:115], v[200:203]
    ds_read_b128 v[56:59], v5 offset:18432
    v_mul_f32 v242, v190, v190
    v_mul_f32 v243, v191, v191
    v_mfma_f32_16x16x32_bf16 v[204:207], v[60:63], v[112:115], v[204:207]
    ds_read_b128 v[60:63], v5 offset:19456
    v_fma_f32 v240, v240, v29, v28
    v_fma_f32 v241, v241, v29, v28
    s_waitcnt lgkmcnt(9)
    v_mfma_f32_16x16x32_bf16 v[192:195], v[144:147], v[116:119], v[192:195]
    ds_read_b128 v[144:147], v5 offset:20480
    v_fma_f32 v242, v242, v29, v28
    v_fma_f32 v243, v243, v29, v28
    v_mfma_f32_16x16x32_bf16 v[196:199], v[148:151], v[116:119], v[196:199]
    ds_read_b128 v[148:151], v5 offset:21504
    v_mul_f32 v240, v240, v188
    v_mul_f32 v241, v241, v189
    v_mfma_f32_16x16x32_bf16 v[200:203], v[152:155], v[116:119], v[200:203]
    ds_read_b128 v[152:155], v5 offset:22528
    v_mul_f32 v242, v242, v190
    v_mul_f32 v243, v243, v191
    v_mfma_f32_16x16x32_bf16 v[204:207], v[156:159], v[116:119], v[204:207]
    ds_read_b128 v[156:159], v5 offset:23552
    v_exp_f32 v240, v240
    v_exp_f32 v241, v241
    s_waitcnt lgkmcnt(9)
    v_mfma_f32_16x16x32_bf16 v[192:195], v[160:163], v[120:123], v[192:195]
    ds_read_b128 v[160:163], v5 offset:24576
    v_exp_f32 v242, v242
    v_exp_f32 v243, v243
    v_mfma_f32_16x16x32_bf16 v[196:199], v[164:167], v[120:123], v[196:199]
    ds_read_b128 v[164:167], v5 offset:25600
    v_fma_f32 v240, v240, v30, v30
    v_fma_f32 v241, v241, v30, v30
    v_mfma_f32_16x16x32_bf16 v[200:203], v[168:171], v[120:123], v[200:203]
    ds_read_b128 v[168:171], v5 offset:26624
    v_fma_f32 v242, v242, v30, v30
    v_fma_f32 v243, v243, v30, v30
    v_mfma_f32_16x16x32_bf16 v[204:207], v[172:175], v[120:123], v[204:207]
    ds_read_b128 v[172:175], v5 offset:27648
    ds_read_b32 v7, v6
    v_rcp_f32 v240, v240
    v_rcp_f32 v241, v241
    s_waitcnt lgkmcnt(9)
    v_mfma_f32_16x16x32_bf16 v[192:195], v[36:39], v[124:127], v[192:195]
    ds_read_b128 v[36:39], v5 offset:28672
    v_rcp_f32 v242, v242
    v_rcp_f32 v243, v243
    v_mfma_f32_16x16x32_bf16 v[196:199], v[40:43], v[124:127], v[196:199]
    ds_read_b128 v[40:43], v5 offset:29696
    v_mul_f32 v240, v240, v188
    v_mul_f32 v241, v241, v189
    v_mfma_f32_16x16x32_bf16 v[200:203], v[56:59], v[124:127], v[200:203]
    ds_read_b128 v[56:59], v5 offset:30720
    v_mul_f32 v242, v242, v190
    v_mul_f32 v243, v243, v191
    v_mfma_f32_16x16x32_bf16 v[204:207], v[60:63], v[124:127], v[204:207]
    ds_read_b128 v[60:63], v5 offset:31744
    v_cvt_pk_bf16_f32 v234, v240, v241
    v_cvt_pk_bf16_f32 v235, v242, v243
    s_lshl_b32 s57, s43, 11
    s_add_u32 s57, s57, s55
    s_add_u32 s57, s57, 40960
    s_cmp_lg_u32 s50, 1
    s_cbranch_scc1 Lm_60
    buffer_store_dwordx4 v[228:231], v2, s[28:31], s57 offen
    buffer_store_dwordx4 v[232:235], v2, s[28:31], s57 offen offset:1024
Lm_60_b:
    ds_read_b128 v[176:179], v21 offset:832
    ds_read_b128 v[180:183], v21 offset:896
    ds_read_b128 v[184:187], v21 offset:960
    ds_read_b128 v[188:191], v21 offset:1024
    s_waitcnt lgkmcnt(13)
    v_mfma_f32_16x16x32_bf16 v[192:195], v[144:147], v[128:131], v[192:195]
    ds_read_b128 v[144:147], v5 offset:32768
    v_mfma_f32_16x16x32_bf16 v[196:199], v[148:151], v[128:131], v[196:199]
    ds_read_b128 v[148:151], v5 offset:33792
    v_mfma_f32_16x16x32_bf16 v[200:203], v[152:155], v[128:131], v[200:203]
    ds_read_b128 v[152:155], v5 offset:34816
    s_waitcnt lgkmcnt(11)
    v_cmp_gt_u32 s[22:23], 38, v7
    v_mfma_f32_16x16x32_bf16 v[204:207], v[156:159], v[128:131], v[204:207]
    ds_read_b128 v[156:159], v5 offset:35840
    v_mfma_f32_16x16x32_bf16 v[192:195], v[160:163], v[132:135], v[192:195]
    s_cmp_lg_u64 s[22:23], 0
    s_cbranch_scc1 Lw_61
Lw_61_ok:
    ds_read_b128 v[160:163], v5 offset:36864
    v_mfma_f32_16x16x32_bf16 v[196:199], v[164:167], v[132:135], v[196:199]
    ds_read_b128 v[164:167], v5 offset:37888
    v_mfma_f32_16x16x32_bf16 v[200:203], v[168:171], v[132:135], v[200:203]
    ds_read_b128 v[168:171], v5 offset:38912
    v_mfma_f32_16x16x32_bf16 v[204:207], v[172:175], v[132:135], v[204:207]
    ds_read_b128 v[172:175], v5 offset:39936
    s_waitcnt lgkmcnt(8)
    v_mfma_f32_16x16x32_bf16 v[192:195], v[36:39], v[136:139], v[192:195]
    ds_read_b128 v[36:39], v5 offset:40960
    v_mul_f32 v176, v32, v176
    v_mul_f32 v177, v32, v177
    v_mfma_f32_16x16x32_bf16 v[196:199], v[40:43], v[136:139], v[196:199]
    ds_read_b128 v[40:43], v5 offset:41984
    v_mul_f32 v178, v32, v178
    v_mul_f32 v179, v32, v179
    v_mfma_f32_16x16x32_bf16 v[200:203], v[56:59], v[136:139], v[200:203]
    ds_read_b128 v[56:59], v5 offset:43008
    v_mul_f32 v180, v32, v180
    v_mul_f32 v181, v32, v181
    v_mfma_f32_16x16x32_bf16 v[204:207], v[60:63], v[136:139], v[204:207]
    ds_read_b128 v[60:63], v5 offset:44032
    v_mul_f32 v182, v32, v182
    v_mul_f32 v183, v32, v183
    s_waitcnt lgkmcnt(8)
    v_mfma_f32_16x16x32_bf16 v[192:195], v[144:147], v[140:143], v[192:195]
    ds_read_b128 v[144:147], v5 offset:45056
    v_mul_f32 v184, v32, v184
    v_mul_f32 v185, v32, v185
    v_mfma_f32_16x16x32_bf16 v[196:199], v[148:151], v[140:143], v[196:199]
    ds_read_b128 v[148:151], v5 offset:46080
    v_mul_f32 v186, v32, v186
    v_mul_f32 v187, v32, v187
    v_mfma_f32_16x16x32_bf16 v[200:203], v[152:155], v[140:143], v[200:203]
    ds_read_b128 v[152:155], v5 offset:47104
    v_mul_f32 v188, v32, v188
    v_mul_f32 v189, v32, v189
    v_mfma_f32_16x16x32_bf16 v[204:207], v[156:159], v[140:143], v[204:207]
    ds_read_b128 v[156:159], v5 offset:48128
    ds_read_b32 v7, v6
    v_mul_f32 v190, v32, v190
    v_mul_f32 v191, v32, v191
    s_waitcnt lgkmcnt(9)
    v_mfma_f32_16x16x32_bf16 v[176:179], v[160:163], v[64:67], v[176:179]
    ds_read_b128 v[160:163], v5 offset:49152
    v_mfma_f32_16x16x32_bf16 v[180:183], v[164:167], v[64:67], v[180:183]
    ds_read_b128 v[164:167], v5 offset:50176
    v_mfma_f32_16x16x32_bf16 v[184:187], v[168:171], v[64:67], v[184:187]
    ds_read_b128 v[168:171], v5 offset:51200
    v_mfma_f32_16x16x32_bf16 v[188:191], v[172:175], v[64:67], v[188:191]
    ds_read_b128 v[172:175], v5 offset:52224
    v_mul_f32 v240, v192, v192
    v_mul_f32 v241, v193, v193
    s_waitcnt lgkmcnt(9)
    v_mfma_f32_16x16x32_bf16 v[176:179], v[36:39], v[68:71], v[176:179]
    ds_read_b128 v[36:39], v5 offset:53248
    v_mul_f32 v242, v194, v194
    v_mul_f32 v243, v195, v195
    v_mfma_f32_16x16x32_bf16 v[180:183], v[40:43], v[68:71], v[180:183]
    ds_read_b128 v[40:43], v5 offset:54272
    v_fma_f32 v240, v240, v29, v28
    v_fma_f32 v241, v241, v29, v28
    v_mfma_f32_16x16x32_bf16 v[184:187], v[56:59], v[68:71], v[184:187]
    ds_read_b128 v[56:59], v5 offset:55296
    s_waitcnt lgkmcnt(7)
    v_cmp_gt_u32 s[22:23], 39, v7
    v_fma_f32 v242, v242, v29, v28
    v_fma_f32 v243, v243, v29, v28
    v_mul_f32 v240, v240, v192
    v_mfma_f32_16x16x32_bf16 v[188:191], v[60:63], v[68:71], v[188:191]
    ds_read_b128 v[60:63], v5 offset:56320
    v_mov_b32 v8, 38
    v_mul_f32 v241, v241, v193
    v_mul_f32 v242, v242, v194
    s_waitcnt vmcnt(0)
    s_lshl_b32 s57, s43, 3
    s_add_u32 s57, s57, s55
    s_add_u32 s57, s57, 110976
    s_mov_b64 exec, 1
    s_cmp_lg_u32 s50, 1
    s_cbranch_scc1 Lm_62
    buffer_store_dwordx2 v[12:13], v14, s[28:31], s57 offen
Lm_62_b:
    s_mov_b64 exec, -1
    v_mfma_f32_16x16x32_bf16 v[176:179], v[144:147], v[72:75], v[176:179]
    s_cmp_lg_u64 s[22:23], 0
    s_cbranch_scc1 Lw_63
Lw_63_ok:
    ds_read_b128 v[144:147], v2 offset:0
    ds_write_b32 v15, v8
    v_mul_f32 v243, v243, v195
    v_exp_f32 v240, v240
    v_mfma_f32_16x16x32_bf16 v[180:183], v[148:151], v[72:75], v[180:183]
    ds_read_b128 v[148:151], v2 offset:1024
    v_exp_f32 v241, v241
    v_exp_f32 v242, v242
    v_mfma_f32_16x16x32_bf16 v[184:187], v[152:155], v[72:75], v[184:187]
    ds_read_b128 v[152:155], v2 offset:2048
    v_exp_f32 v243, v243
    v_fma_f32 v240, v240, v30, v30
    v_fma_f32 v241, v241, v30, v30
    v_mfma_f32_16x16x32_bf16 v[188:191], v[156:159], v[72:75], v[188:191]
    ds_read_b128 v[156:159], v2 offset:3072
    v_fma_f32 v242, v242, v30, v30
    v_fma_f32 v243, v243, v30, v30
    s_waitcnt lgkmcnt(9)
    v_mfma_f32_16x16x32_bf16 v[176:179], v[160:163], v[76:79], v[176:179]
    ds_read_b128 v[160:163], v2 offset:4096
    v_rcp_f32 v240, v240
    v_rcp_f32 v241, v241
    v_mfma_f32_16x16x32_bf16 v[180:183], v[164:167], v[76:79], v[180:183]
    ds_read_b128 v[164:167], v2 offset:5120
    v_rcp_f32 v242, v242
    v_rcp_f32 v243, v243
    v_mfma_f32_16x16x32_bf16 v[184:187], v[168:171], v[76:79], v[184:187]
    ds_read_b128 v[168:171], v2 offset:6144
    v_mul_f32 v240, v240, v192
    v_mul_f32 v241, v241, v193
    v_mul_f32 v242, v242, v194
    v_mfma_f32_16x16x32_bf16 v[188:191], v[172:175], v[76:79], v[188:191]
    ds_read_b128 v[172:175], v2 offset:7168
    v_mul_f32 v243, v243, v195
    v_cvt_pk_bf16_f32 v228, v240, v241
    s_waitcnt lgkmcnt(9)
    v_mfma_f32_16x16x32_bf16 v[176:179], v[36:39], v[80:83], v[176:179]
    ds_read_b128 v[36:39], v2 offset:8192
    v_cvt_pk_bf16_f32 v229, v242, v243
    v_mul_f32 v240, v196, v196
    v_mfma_f32_16x16x32_bf16 v[180:183], v[40:43], v[80:83], v[180:183]
    ds_read_b128 v[40:43], v2 offset:9216
    v_mul_f32 v241, v197, v197
    v_mul_f32 v242, v198, v198
    v_mfma_f32_16x16x32_bf16 v[184:187], v[56:59], v[80:83], v[184:187]
    ds_read_b128 v[56:59], v2 offset:10240
    v_mul_f32 v243, v199, v199
    v_fma_f32 v240, v240, v29, v28
    v_fma_f32 v241, v241, v29, v28
    v_mfma_f32_16x16x32_bf16 v[188:191], v[60:63], v[80:83], v[188:191]
    ds_read_b128 v[60:63], v2 offset:11264
    ds_read_b32 v7, v6
    v_fma_f32 v242, v242, v29, v28
    v_fma_f32 v243, v243, v29, v28
    s_waitcnt lgkmcnt(9)
    v_mfma_f32_16x16x32_bf16 v[176:179], v[144:147], v[84:87], v[176:179]
    ds_read_b128 v[144:147], v2 offset:12288
    v_mul_f32 v240, v240, v196
    v_mul_f32 v241, v241, v197
    v_mfma_f32_16x16x32_bf16 v[180:183], v[148:151], v[84:87], v[180:183]
    ds_read_b128 v[148:151], v2 offset:13312
    v_mul_f32 v242, v242, v198
    v_mul_f32 v243, v243, v199
    v_exp_f32 v240, v240
    v_mfma_f32_16x16x32_bf16 v[184:187], v[152:155], v[84:87], v[184:187]
    ds_read_b128 v[152:155], v2 offset:14336
    v_exp_f32 v241, v241
    v_exp_f32 v242, v242
    v_mfma_f32_16x16x32_bf16 v[188:191], v[156:159], v[84:87], v[188:191]
    ds_read_b128 v[156:159], v2 offset:15360
    v_exp_f32 v243, v243
    v_fma_f32 v240, v240, v30, v30
    s_waitcnt lgkmcnt(9)
    v_mfma_f32_16x16x32_bf16 v[176:179], v[160:163], v[88:91], v[176:179]
    ds_read_b128 v[160:163], v2 offset:16384
    v_fma_f32 v241, v241, v30, v30
    v_fma_f32 v242, v242, v30, v30
    v_mfma_f32_16x16x32_bf16 v[180:183], v[164:167], v[88:91], v[180:183]
    ds_read_b128 v[164:167], v2 offset:17408
    v_fma_f32 v243, v243, v30, v30
    v_rcp_f32 v240, v240
    v_rcp_f32 v241, v241
    v_mfma_f32_16x16x32_bf16 v[184:187], v[168:171], v[88:91], v[184:187]
    ds_read_b128 v[168:171], v2 offset:18432
    s_waitcnt lgkmcnt(7)
    v_cmp_gt_u32 s[22:23], 40, v7
    v_rcp_f32 v242, v242
    v_rcp_f32 v243, v243
    v_mfma_f32_16x16x32_bf16 v[188:191], v[172:175], v[88:91], v[188:191]
    ds_read_b128 v[172:175], v2 offset:19456
    v_mul_f32 v240, v240, v196
    v_mul_f32 v241, v241, v197
    v_mfma_f32_16x16x32_bf16 v[176:179], v[36:39], v[92:95], v[176:179]
    s_cmp_lg_u64 s[22:23], 0
    s_cbranch_scc1 Lw_64
Lw_64_ok:
    ds_read_b128 v[36:39], v2 offset:20480
    v_mul_f32 v242, v242, v198
    v_mul_f32 v243, v243, v199
    v_mfma_f32_16x16x32_bf16 v[180:183], v[40:43], v[92:95], v[180:183]
    ds_read_b128 v[40:43], v2 offset:21504
    v_cvt_pk_bf16_f32 v230, v240, v241
    v_cvt_pk_bf16_f32 v231, v242, v243
    v_mul_f32 v240, v200, v200
    v_mfma_f32_16x16x32_bf16 v[184:187], v[56:59], v[92:95], v[184:187]
    ds_read_b128 v[56:59], v2 offset:22528
    v_mul_f32 v241, v201, v201
    v_mul_f32 v242, v202, v202
    v_mfma_f32_16x16x32_bf16 v[188:191], v[60:63], v[92:95], v[188:191]
    ds_read_b128 v[60:63], v2 offset:23552
    v_mul_f32 v243, v203, v203
    v_fma_f32 v240, v240, v29, v28
    s_mov_b32 s58, 110976
    buffer_load_dwordx2 v[244:245], v20, s[28:31], s58 offen sc1
    s_waitcnt lgkmcnt(8)
    v_mfma_f32_16x16x32_bf16 v[176:179], v[144:147], v[96:99], v[176:179]
    ds_read_b128 v[144:147], v2 offset:24576
    v_fma_f32 v241, v241, v29, v28
    v_fma_f32 v242, v242, v29, v28
    v_mfma_f32_16x16x32_bf16 v[180:183], v[148:151], v[96:99], v[180:183]
    ds_read_b128 v[148:151], v2 offset:25600
    v_fma_f32 v243, v243, v29, v28
    v_mul_f32 v240, v240, v200
    v_mul_f32 v241, v241, v201
    v_mfma_f32_16x16x32_bf16 v[184:187], v[152:155], v[96:99], v[184:187]
    ds_read_b128 v[152:155], v2 offset:26624
    v_mul_f32 v242, v242, v202
    v_mul_f32 v243, v243, v203
    v_mfma_f32_16x16x32_bf16 v[188:191], v[156:159], v[96:99], v[188:191]
    ds_read_b128 v[156:159], v2 offset:27648
    v_exp_f32 v240, v240
    v_exp_f32 v241, v241
    s_waitcnt lgkmcnt(8)
    v_mfma_f32_16x16x32_bf16 v[176:179], v[160:163], v[100:103], v[176:179]
    ds_read_b128 v[160:163], v2 offset:28672
    v_exp_f32 v242, v242
    v_exp_f32 v243, v243
    v_mfma_f32_16x16x32_bf16 v[180:183], v[164:167], v[100:103], v[180:183]
    ds_read_b128 v[164:167], v2 offset:29696
    v_fma_f32 v240, v240, v30, v30
    v_fma_f32 v241, v241, v30, v30
    v_fma_f32 v242, v242, v30, v30
    v_mfma_f32_16x16x32_bf16 v[184:187], v[168:171], v[100:103], v[184:187]
    ds_read_b128 v[168:171], v2 offset:30720
    v_fma_f32 v243, v243, v30, v30
    v_rcp_f32 v240, v240
    v_mfma_f32_16x16x32_bf16 v[188:191], v[172:175], v[100:103], v[188:191]
    ds_read_b128 v[172:175], v2 offset:31744
    ds_read_b32 v7, v6
    v_rcp_f32 v241, v241
    v_rcp_f32 v242, v242
    s_waitcnt lgkmcnt(9)
    v_mfma_f32_16x16x32_bf16 v[176:179], v[36:39], v[104:107], v[176:179]
    ds_read_b128 v[36:39], v2 offset:32768
    v_rcp_f32 v243, v243
    v_mul_f32 v240, v240, v200
    v_mul_f32 v241, v241, v201
    v_mfma_f32_16x16x32_bf16 v[180:183], v[40:43], v[104:107], v[180:183]
    ds_read_b128 v[40:43], v2 offset:33792
    v_mul_f32 v242, v242, v202
    v_mul_f32 v243, v243, v203
    v_mfma_f32_16x16x32_bf16 v[184:187], v[56:59], v[104:107], v[184:187]
    ds_read_b128 v[56:59], v2 offset:34816
    v_cvt_pk_bf16_f32 v232, v240, v241
    v_cvt_pk_bf16_f32 v233, v242, v243
    v_mfma_f32_16x16x32_bf16 v[188:191], v[60:63], v[104:107], v[188:191]
    ds_read_b128 v[60:63], v2 offset:35840
    v_mul_f32 v240, v204, v204
    v_mul_f32 v241, v205, v205
    s_waitcnt lgkmcnt(9)
    v_mfma_f32_16x16x32_bf16 v[176:179], v[144:147], v[108:111], v[176:179]
    ds_read_b128 v[144:147], v2 offset:36864
    v_mul_f32 v242, v206, v206
    v_mul_f32 v243, v207, v207
    v_fma_f32 v240, v240, v29, v28
    v_mfma_f32_16x16x32_bf16 v[180:183], v[148:151], v[108:111], v[180:183]
    ds_read_b128 v[148:151], v2 offset:37888
    v_fma_f32 v241, v241, v29, v28
    v_fma_f32 v242, v242, v29, v28
    v_mfma_f32_16x16x32_bf16 v[184:187], v[152:155], v[108:111], v[184:187]
    ds_read_b128 v[152:155], v2 offset:38912
    s_waitcnt lgkmcnt(7)
    v_cmp_gt_u32 s[22:23], 41, v7
    v_fma_f32 v243, v243, v29, v28
    v_mul_f32 v240, v240, v204
    v_mfma_f32_16x16x32_bf16 v[188:191], v[156:159], v[108:111], v[188:191]
    ds_read_b128 v[156:159], v2 offset:39936
    v_mov_b32 v8, 40
    v_mul_f32 v241, v241, v205
    v_mul_f32 v242, v242, v206
    s_waitcnt vmcnt(0)
    v_cmp_ne_u64 vcc, s[48:49], v[244:245]
    s_cbranch_vccnz Lg_65
Lg_65_ok:
    s_lshl_b32 s60, s51, 12
    s_add_u32 s60, s60, 40960
    buffer_load_dwordx4 v[64:67], v18, s[28:31], s60 offen offset:0 sc1
    buffer_load_dwordx4 v[68:71], v18, s[28:31], s60 offen offset:1024 sc1
    v_mfma_f32_16x16x32_bf16 v[176:179], v[160:163], v[112:115], v[176:179]
    s_cmp_lg_u64 s[22:23], 0
    s_cbranch_scc1 Lw_66
Lw_66_ok:
    ds_read_b128 v[160:163], v2 offset:40960
    ds_write_b32 v15, v8
    v_mul_f32 v243, v243, v207
    v_exp_f32 v240, v240
    v_exp_f32 v241, v241
    v_mfma_f32_16x16x32_bf16 v[180:183], v[164:167], v[112:115], v[180:183]
    ds_read_b128 v[164:167], v2 offset:41984
    v_exp_f32 v242, v242
    v_exp_f32 v243, v243
    v_mfma_f32_16x16x32_bf16 v[184:187], v[168:171], v[112:115], v[184:187]
    ds_read_b128 v[168:171], v2 offset:43008
    v_fma_f32 v240, v240, v30, v30
    v_fma_f32 v241, v241, v30, v30
    v_mfma_f32_16x16x32_bf16 v[188:191], v[172:175], v[112:115], v[188:191]
    ds_read_b128 v[172:175], v2 offset:44032
    v_fma_f32 v242, v242, v30, v30
    v_fma_f32 v243, v243, v30, v30
    buffer_load_dwordx4 v[72:75], v18, s[28:31], s60 offen offset:2048 sc1
    buffer_load_dwordx4 v[76:79], v18, s[28:31], s60 offen offset:3072 sc1
    s_waitcnt lgkmcnt(9)
    v_mfma_f32_16x16x32_bf16 v[176:179], v[36:39], v[116:119], v[176:179]
    ds_read_b128 v[36:39], v2 offset:45056
    v_rcp_f32 v240, v240
    v_rcp_f32 v241, v241
    v_rcp_f32 v242, v242
    v_mfma_f32_16x16x32_bf16 v[180:183], v[40:43], v[116:119], v[180:183]
    ds_read_b128 v[40:43], v2 offset:46080
    v_rcp_f32 v243, v243
    v_mul_f32 v240, v240, v204
    v_mfma_f32_16x16x32_bf16 v[184:187], v[56:59], v[116:119], v[184:187]
    ds_read_b128 v[56:59], v2 offset:47104
    v_mul_f32 v241, v241, v205
    v_mul_f32 v242, v242, v206
    v_mfma_f32_16x16x32_bf16 v[188:191], v[60:63], v[116:119], v[188:191]
    ds_read_b128 v[60:63], v2 offset:48128
    v_mul_f32 v243, v243, v207
    v_cvt_pk_bf16_f32 v234, v240, v241
    v_cvt_pk_bf16_f32 v235, v242, v243
    s_lshl_b32 s57, s43, 11
    s_add_u32 s57, s57, s55
    s_add_u32 s57, s57, 0
    s_cmp_lg_u32 s50, 1
    s_cbranch_scc1 Lm_67
    buffer_store_dwordx4 v[228:231], v2, s[28:31], s57 offen
    buffer_store_dwordx4 v[232:235], v2, s[28:31], s57 offen offset:1024
Lm_67_b:
    s_lshl_b32 s60, s52, 12
    s_add_u32 s60, s60, 40960
    buffer_load_dwordx4 v[80:83], v18, s[28:31], s60 offen offset:0 sc1
    buffer_load_dwordx4 v[84:87], v18, s[28:31], s60 offen offset:1024 sc1
    s_waitcnt lgkmcnt(9)
    v_mfma_f32_16x16x32_bf16 v[176:179], v[144:147], v[120:123], v[176:179]
    ds_read_b128 v[144:147], v2 offset:49152
    v_lshlrev_b32 v192, 16, v208
    v_and_b32 v193, 0xffff0000, v208
    v_mfma_f32_16x16x32_bf16 v[180:183], v[148:151], v[120:123], v[180:183]
    ds_read_b128 v[148:151], v2 offset:50176
    v_lshlrev_b32 v240, 16, v218
    v_and_b32 v241, 0xffff0000, v218
    v_add_f32 v192, v192, v240
    v_mfma_f32_16x16x32_bf16 v[184:187], v[152:155], v[120:123], v[184:187]
    ds_read_b128 v[152:155], v2 offset:51200
    v_add_f32 v193, v193, v241
    v_lshlrev_b32 v194, 16, v209
    v_mfma_f32_16x16x32_bf16 v[188:191], v[156:159], v[120:123], v[188:191]
    ds_read_b128 v[156:159], v2 offset:52224
    ds_read_b32 v7, v6
    v_and_b32 v195, 0xffff0000, v209
    v_lshlrev_b32 v240, 16, v219
    v_and_b32 v241, 0xffff0000, v219
    buffer_load_dwordx4 v[88:91], v18, s[28:31], s60 offen offset:2048 sc1
    buffer_load_dwordx4 v[92:95], v18, s[28:31], s60 offen offset:3072 sc1
    s_waitcnt lgkmcnt(9)
    v_mfma_f32_16x16x32_bf16 v[176:179], v[160:163], v[124:127], v[176:179]
    ds_read_b128 v[160:163], v2 offset:53248
    v_add_f32 v194, v194, v240
    v_add_f32 v195, v195, v241
    v_mfma_f32_16x16x32_bf16 v[180:183], v[164:167], v[124:127], v[180:183]
    ds_read_b128 v[164:167], v2 offset:54272
    v_lshlrev_b32 v196, 16, v210
    v_and_b32 v197, 0xffff0000, v210
    v_lshlrev_b32 v240, 16, v220
    v_mfma_f32_16x16x32_bf16 v[184:187], v[168:171], v[124:127], v[184:187]
    ds_read_b128 v[168:171], v2 offset:55296
    v_and_b32 v241, 0xffff0000, v220
    v_add_f32 v196, v196, v240
    v_mfma_f32_16x16x32_bf16 v[188:191], v[172:175], v[124:127], v[188:191]
    ds_read_b128 v[172:175], v2 offset:56320
    v_add_f32 v197, v197, v241
    v_lshlrev_b32 v198, 16, v211
    v_and_b32 v199, 0xffff0000, v211
    s_lshl_b32 s60, s53, 12
    s_add_u32 s60, s60, 40960
    buffer_load_dwordx4 v[96:99], v18, s[28:31], s60 offen offset:0 sc1
    buffer_load_dwordx4 v[100:103], v18, s[28:31], s60 offen offset:1024 sc1
    s_waitcnt lgkmcnt(9)
    v_mfma_f32_16x16x32_bf16 v[176:179], v[36:39], v[128:131], v[176:179]
    ds_read_b128 v[36:39], v2 offset:57344
    v_lshlrev_b32 v240, 16, v221
    v_and_b32 v241, 0xffff0000, v221
    v_mfma_f32_16x16x32_bf16 v[180:183], v[40:43], v[128:131], v[180:183]
    ds_read_b128 v[40:43], v2 offset:58368
    v_add_f32 v198, v198, v240
    v_add_f32 v199, v199, v241
    v_lshlrev_b32 v200, 16, v212
    v_mfma_f32_16x16x32_bf16 v[184:187], v[56:59], v[128:131], v[184:187]
    ds_read_b128 v[56:59], v2 offset:59392
    s_waitcnt lgkmcnt(7)
    v_cmp_gt_u32 s[22:23], 42, v7
    v_and_b32 v201, 0xffff0000, v212
    v_lshlrev_b32 v240, 16, v222
    v_mfma_f32_16x16x32_bf16 v[188:191], v[60:63], v[128:131], v[188:191]
    ds_read_b128 v[60:63], v2 offset:60416
    v_and_b32 v241, 0xffff0000, v222
    v_add_f32 v200, v200, v240
    v_add_f32 v201, v201, v241
    buffer_load_dwordx4 v[104:107], v18, s[28:31], s60 offen offset:2048 sc1
    buffer_load_dwordx4 v[108:111], v18, s[28:31], s60 offen offset:3072 sc1
    v_mfma_f32_16x16x32_bf16 v[176:179], v[144:147], v[132:135], v[176:179]
    s_cmp_lg_u64 s[22:23], 0
    s_cbranch_scc1 Lw_68
Lw_68_ok:
    ds_read_b128 v[144:147], v2 offset:61440
    v_lshlrev_b32 v202, 16, v213
    v_and_b32 v203, 0xffff0000, v213
    v_mfma_f32_16x16x32_bf16 v[180:183], v[148:151], v[132:135], v[180:183]
    ds_read_b128 v[148:151], v2 offset:62464
    v_lshlrev_b32 v240, 16, v223
    v_and_b32 v241, 0xffff0000, v223
    v_add_f32 v202, v202, v240
    v_mfma_f32_16x16x32_bf16 v[184:187], v[152:155], v[132:135], v[184:187]
    ds_read_b128 v[152:155], v2 offset:63488
    v_add_f32 v203, v203, v241
    v_lshlrev_b32 v204, 16, v214
    v_mfma_f32_16x16x32_bf16 v[188:191], v[156:159], v[132:135], v[188:191]
    ds_read_b128 v[156:159], v2 offset:64512
    v_and_b32 v205, 0xffff0000, v214
    v_lshlrev_b32 v240, 16, v224
    v_and_b32 v241, 0xffff0000, v224
    s_lshl_b32 s60, s54, 12
    s_add_u32 s60, s60, 40960
    buffer_load_dwordx4 v[112:115], v18, s[28:31], s60 offen offset:0 sc1
    buffer_load_dwordx4 v[116:119], v18, s[28:31], s60 offen offset:1024 sc1
    s_waitcnt lgkmcnt(8)
    v_mfma_f32_16x16x32_bf16 v[176:179], v[160:163], v[136:139], v[176:179]
    ds_read_b128 v[160:163], v5 offset:0
    v_add_f32 v204, v204, v240
    v_add_f32 v205, v205, v241
    v_mfma_f32_16x16x32_bf16 v[180:183], v[164:167], v[136:139], v[180:183]
    ds_read_b128 v[164:167], v5 offset:1024
    v_lshlrev_b32 v206, 16, v215
    v_and_b32 v207, 0xffff0000, v215
    v_lshlrev_b32 v240, 16, v225
    v_mfma_f32_16x16x32_bf16 v[184:187], v[168:171], v[136:139], v[184:187]
    ds_read_b128 v[168:171], v5 offset:2048
    v_and_b32 v241, 0xffff0000, v225
    v_add_f32 v206, v206, v240
    v_mfma_f32_16x16x32_bf16 v[188:191], v[172:175], v[136:139], v[188:191]
    ds_read_b128 v[172:175], v5 offset:3072
    v_add_f32 v207, v207, v241
    v_lshlrev_b32 v44, 16, v216
    v_and_b32 v45, 0xffff0000, v216
    buffer_load_dwordx4 v[120:123], v18, s[28:31], s60 offen offset:2048 sc1
    buffer_load_dwordx4 v[124:127], v18, s[28:31], s60 offen offset:3072 sc1
    s_waitcnt lgkmcnt(8)
    v_mfma_f32_16x16x32_bf16 v[176:179], v[36:39], v[140:143], v[176:179]
    ds_read_b128 v[36:39], v5 offset:4096
    v_lshlrev_b32 v240, 16, v226
    v_and_b32 v241, 0xffff0000, v226
    v_mfma_f32_16x16x32_bf16 v[180:183], v[40:43], v[140:143], v[180:183]
    ds_read_b128 v[40:43], v5 offset:5120
    v_add_f32 v44, v44, v240
    v_add_f32 v45, v45, v241
    v_lshlrev_b32 v46, 16, v217
    v_mfma_f32_16x16x32_bf16 v[184:187], v[56:59], v[140:143], v[184:187]
    ds_read_b128 v[56:59], v5 offset:6144
    v_and_b32 v47, 0xffff0000, v217
    v_lshlrev_b32 v240, 16, v227
    v_mfma_f32_16x16x32_bf16 v[188:191], v[60:63], v[140:143], v[188:191]
    ds_read_b128 v[60:63], v5 offset:7168
    ds_read_b32 v7, v6
    v_and_b32 v241, 0xffff0000, v227
    v_add_f32 v46, v46, v240
    v_add_f32 v47, v47, v241
L_P6:
    s_waitcnt vmcnt(17)
    s_waitcnt lgkmcnt(9)
    v_mfma_f32_16x16x32_bf16 v[192:195], v[144:147], v[64:67], v[192:195]
    ds_read_b128 v[144:147], v5 offset:8192
    v_mfma_f32_16x16x32_bf16 v[196:199], v[148:151], v[64:67], v[196:199]
    ds_read_b128 v[148:151], v5 offset:9216
    v_mfma_f32_16x16x32_bf16 v[200:203], v[152:155], v[64:67], v[200:203]
    ds_read_b128 v[152:155], v5 offset:10240
    v_mfma_f32_16x16x32_bf16 v[204:207], v[156:159], v[64:67], v[204:207]
    ds_read_b128 v[156:159], v5 offset:11264
    v_mul_f32 v240, v176, v176
    v_mul_f32 v241, v177, v177
    s_waitcnt lgkmcnt(9)
    v_mfma_f32_16x16x32_bf16 v[44:47], v[160:163], v[64:67], v[44:47]
    ds_read_b128 v[160:163], v5 offset:12288
    v_mul_f32 v242, v178, v178
    v_mul_f32 v243, v179, v179
    s_waitcnt vmcnt(12)
    s_lshl_b32 s57, s43, 3
    s_add_u32 s57, s57, s55
    s_add_u32 s57, s57, 111104
    s_mov_b64 exec, 1
    s_cmp_lg_u32 s50, 1
    s_cbranch_scc1 Lm_69
    buffer_store_dwordx2 v[12:13], v14, s[28:31], s57 offen
Lm_69_b:
    s_mov_b64 exec, -1
    v_mfma_f32_16x16x32_bf16 v[192:195], v[164:167], v[68:71], v[192:195]
    ds_read_b128 v[164:167], v5 offset:13312
    v_fma_f32 v240, v240, v29, v28
    v_fma_f32 v241, v241, v29, v28
    v_mfma_f32_16x16x32_bf16 v[196:199], v[168:171], v[68:71], v[196:199]
    ds_read_b128 v[168:171], v5 offset:14336
    s_waitcnt lgkmcnt(7)
    v_cmp_gt_u32 s[22:23], 43, v7
    v_fma_f32 v242, v242, v29, v28
    v_fma_f32 v243, v243, v29, v28
    v_mfma_f32_16x16x32_bf16 v[200:203], v[172:175], v[68:71], v[200:203]
    ds_read_b128 v[172:175], v5 offset:15360
    v_mov_b32 v8, 42
    v_mul_f32 v240, v240, v176
    v_mul_f32 v241, v241, v177
    v_mfma_f32_16x16x32_bf16 v[204:207], v[36:39], v[68:71], v[204:207]
    s_cmp_lg_u64 s[22:23], 0
    s_cbranch_scc1 Lw_70
Lw_70_ok:
    ds_read_b128 v[36:39], v5 offset:57344
    ds_write_b32 v15, v8
    v_mul_f32 v242, v242, v178
    v_mul_f32 v243, v243, v179
    v_mfma_f32_16x16x32_bf16 v[44:47], v[40:43], v[68:71], v[44:47]
    ds_read_b128 v[40:43], v5 offset:58368
    v_exp_f32 v240, v240
    v_exp_f32 v241, v241
    v_mfma_f32_16x16x32_bf16 v[192:195], v[56:59], v[72:75], v[192:195]
    ds_read_b128 v[56:59], v5 offset:59392
    v_exp_f32 v242, v242
    v_exp_f32 v243, v243
    v_mfma_f32_16x16x32_bf16 v[196:199], v[60:63], v[72:75], v[196:199]
    ds_read_b128 v[60:63], v5 offset:60416
    v_fma_f32 v240, v240, v30, v30
    v_fma_f32 v241, v241, v30, v30
    s_waitcnt lgkmcnt(9)
    v_mfma_f32_16x16x32_bf16 v[200:203], v[144:147], v[72:75], v[200:203]
    ds_read_b128 v[144:147], v5 offset:61440
    v_fma_f32 v242, v242, v30, v30
    v_fma_f32 v243, v243, v30, v30
    v_rcp_f32 v240, v240
    v_mfma_f32_16x16x32_bf16 v[204:207], v[148:151], v[72:75], v[204:207]
    ds_read_b128 v[148:151], v5 offset:62464
    v_rcp_f32 v241, v241
    v_rcp_f32 v242, v242
    v_mfma_f32_16x16x32_bf16 v[44:47], v[152:155], v[72:75], v[44:47]
    ds_read_b128 v[152:155], v5 offset:63488
    v_rcp_f32 v243, v243
    v_mul_f32 v240, v240, v176
    s_mov_b32 s58, 111104
    buffer_load_dwordx2 v[244:245], v20, s[28:31], s58 offen sc1
    v_mfma_f32_16x16x32_bf16 v[192:195], v[156:159], v[76:79], v[192:195]
    ds_read_b128 v[156:159], v5 offset:64512
    v_mul_f32 v241, v241, v177
    v_mul_f32 v242, v242, v178
    s_waitcnt lgkmcnt(9)
    v_mfma_f32_16x16x32_bf16 v[196:199], v[160:163], v[76:79], v[196:199]
    ds_read_b128 v[160:163], v9 offset:0
    v_mul_f32 v243, v243, v179
    v_cvt_pk_bf16_f32 v228, v240, v241
    v_mfma_f32_16x16x32_bf16 v[200:203], v[164:167], v[76:79], v[200:203]
    ds_read_b128 v[164:167], v9 offset:1024
    v_cvt_pk_bf16_f32 v229, v242, v243
    v_mul_f32 v240, v180, v180
    v_mfma_f32_16x16x32_bf16 v[204:207], v[168:171], v[76:79], v[204:207]
    ds_read_b128 v[168:171], v9 offset:2048
    v_mul_f32 v241, v181, v181
    v_mul_f32 v242, v182, v182
    v_mfma_f32_16x16x32_bf16 v[44:47], v[172:175], v[76:79], v[44:47]
    ds_read_b128 v[172:175], v9 offset:3072
    ds_read_b32 v7, v6
    v_mul_f32 v243, v183, v183
    v_fma_f32 v240, v240, v29, v28
    s_waitcnt vmcnt(13)
    s_waitcnt lgkmcnt(9)
    v_mfma_f32_16x16x32_bf16 v[192:195], v[36:39], v[80:83], v[192:195]
    ds_read_b128 v[36:39], v9 offset:4096
    v_fma_f32 v241, v241, v29, v28
    v_fma_f32 v242, v242, v29, v28
    v_mfma_f32_16x16x32_bf16 v[196:199], v[40:43], v[80:83], v[196:199]
    ds_read_b128 v[40:43], v9 offset:5120
    v_fma_f32 v243, v243, v29, v28
    v_mul_f32 v240, v240, v180
    v_mul_f32 v241, v241, v181
    v_mfma_f32_16x16x32_bf16 v[200:203], v[56:59], v[80:83], v[200:203]
    ds_read_b128 v[56:59], v9 offset:6144
    v_mul_f32 v242, v242, v182
    v_mul_f32 v243, v243, v183
    v_mfma_f32_16x16x32_bf16 v[204:207], v[60:63], v[80:83], v[204:207]
    ds_read_b128 v[60:63], v9 offset:7168
    v_exp_f32 v240, v240
    v_exp_f32 v241, v241
    s_waitcnt lgkmcnt(9)
    v_mfma_f32_16x16x32_bf16 v[44:47], v[144:147], v[80:83], v[44:47]
    ds_read_b128 v[144:147], v9 offset:8192
    v_exp_f32 v242, v242
    v_exp_f32 v243, v243
    s_waitcnt vmcnt(12)
    v_mfma_f32_16x16x32_bf16 v[192:195], v[148:151], v[84:87], v[192:195]
    ds_read_b128 v[148:151], v9 offset:9216
    v_fma_f32 v240, v240, v30, v30
    v_fma_f32 v241, v241, v30, v30
    v_mfma_f32_16x16x32_bf16 v[196:199], v[152:155], v[84:87], v[196:199]
    ds_read_b128 v[152:155], v9 offset:10240
    s_waitcnt lgkmcnt(7)
    v_cmp_gt_u32 s[22:23], 44, v7
    v_fma_f32 v242, v242, v30, v30
    v_fma_f32 v243, v243, v30, v30
    v_mfma_f32_16x16x32_bf16 v[200:203], v[156:159], v[84:87], v[200:203]
    ds_read_b128 v[156:159], v9 offset:11264
    v_rcp_f32 v240, v240
    v_rcp_f32 v241, v241
    v_mfma_f32_16x16x32_bf16 v[204:207], v[160:163], v[84:87], v[204:207]
    s_cmp_lg_u64 s[22:23], 0
    s_cbranch_scc1 Lw_71
Lw_71_ok:
    ds_read_b128 v[160:163], v5 offset:16384
    v_rcp_f32 v242, v242
    v_rcp_f32 v243, v243
    v_mfma_f32_16x16x32_bf16 v[44:47], v[164:167], v[84:87], v[44:47]
    ds_read_b128 v[164:167], v5 offset:17408
    v_mul_f32 v240, v240, v180
    v_mul_f32 v241, v241, v181
    s_waitcnt vmcnt(0)
    v_cmp_ne_u64 vcc, s[48:49], v[244:245]
    s_cbranch_vccnz Lg_72
Lg_72_ok:
    s_lshl_b32 s60, s51, 12
    s_add_u32 s60, s60, 0
    buffer_load_dwordx4 v[128:131], v18, s[28:31], s60 offen offset:0 sc1
    buffer_load_dwordx4 v[132:135], v18, s[28:31], s60 offen offset:1024 sc1
    buffer_load_dwordx4 v[136:139], v18, s[28:31], s60 offen offset:2048 sc1
    buffer_load_dwordx4 v[140:143], v18, s[28:31], s60 offen offset:3072 sc1
    v_mfma_f32_16x16x32_bf16 v[192:195], v[168:171], v[88:91], v[192:195]
    ds_read_b128 v[168:171], v5 offset:18432
    v_mul_f32 v242, v242, v182
    v_mul_f32 v243, v243, v183
    v_mfma_f32_16x16x32_bf16 v[196:199], v[172:175], v[88:91], v[196:199]
    ds_read_b128 v[172:175], v5 offset:19456
    v_cvt_pk_bf16_f32 v230, v240, v241
    v_cvt_pk_bf16_f32 v231, v242, v243
    v_mul_f32 v240, v184, v184
    s_waitcnt lgkmcnt(8)
    v_mfma_f32_16x16x32_bf16 v[200:203], v[36:39], v[88:91], v[200:203]
    ds_read_b128 v[36:39], v5 offset:20480
    v_mul_f32 v241, v185, v185
    v_mul_f32 v242, v186, v186
    v_mfma_f32_16x16x32_bf16 v[204:207], v[40:43], v[88:91], v[204:207]
    ds_read_b128 v[40:43], v5 offset:21504
    v_mul_f32 v243, v187, v187
    v_fma_f32 v240, v240, v29, v28
    v_mfma_f32_16x16x32_bf16 v[44:47], v[56:59], v[88:91], v[44:47]
    ds_read_b128 v[56:59], v5 offset:22528
    v_fma_f32 v241, v241, v29, v28
    v_fma_f32 v242, v242, v29, v28
    s_lshl_b32 s60, s52, 12
    s_add_u32 s60, s60, 0
    buffer_load_dwordx4 v[64:67], v18, s[28:31], s60 offen offset:0 sc1
    buffer_load_dwordx4 v[68:71], v18, s[28:31], s60 offen offset:1024 sc1
    buffer_load_dwordx4 v[72:75], v18, s[28:31], s60 offen offset:2048 sc1
    buffer_load_dwordx4 v[76:79], v18, s[28:31], s60 offen offset:3072 sc1
    v_mfma_f32_16x16x32_bf16 v[192:195], v[60:63], v[92:95], v[192:195]
    ds_read_b128 v[60:63], v5 offset:23552
    v_fma_f32 v243, v243, v29, v28
    v_mul_f32 v240, v240, v184
    s_waitcnt lgkmcnt(8)
    v_mfma_f32_16x16x32_bf16 v[196:199], v[144:147], v[92:95], v[196:199]
    ds_read_b128 v[144:147], v5 offset:24576
    v_mul_f32 v241, v241, v185
    v_mul_f32 v242, v242, v186
    v_mfma_f32_16x16x32_bf16 v[200:203], v[148:151], v[92:95], v[200:203]
    ds_read_b128 v[148:151], v5 offset:25600
    v_mul_f32 v243, v243, v187
    v_exp_f32 v240, v240
    v_mfma_f32_16x16x32_bf16 v[204:207], v[152:155], v[92:95], v[204:207]
    ds_read_b128 v[152:155], v5 offset:26624
    v_exp_f32 v241, v241
    v_exp_f32 v242, v242
    v_mfma_f32_16x16x32_bf16 v[44:47], v[156:159], v[92:95], v[44:47]
    ds_read_b128 v[156:159], v5 offset:27648
    ds_read_b32 v7, v6
    v_exp_f32 v243, v243
    v_fma_f32 v240, v240, v30, v30
    s_lshl_b32 s60, s53, 12
    s_add_u32 s60, s60, 0
    buffer_load_dwordx4 v[80:83], v18, s[28:31], s60 offen offset:0 sc1
    buffer_load_dwordx4 v[84:87], v18, s[28:31], s60 offen offset:1024 sc1
    buffer_load_dwordx4 v[88:91], v18, s[28:31], s60 offen offset:2048 sc1
    buffer_load_dwordx4 v[92:95], v18, s[28:31], s60 offen offset:3072 sc1
    s_waitcnt lgkmcnt(9)
    v_mfma_f32_16x16x32_bf16 v[192:195], v[160:163], v[96:99], v[192:195]
    ds_read_b128 v[160:163], v5 offset:28672
    v_fma_f32 v241, v241, v30, v30
    v_fma_f32 v242, v242, v30, v30
    v_fma_f32 v243, v243, v30, v30
    v_mfma_f32_16x16x32_bf16 v[196:199], v[164:167], v[96:99], v[196:199]
    ds_read_b128 v[164:167], v5 offset:29696
    v_rcp_f32 v240, v240
    v_rcp_f32 v241, v241
    v_mfma_f32_16x16x32_bf16 v[200:203], v[168:171], v[96:99], v[200:203]
    ds_read_b128 v[168:171], v5 offset:30720
    v_rcp_f32 v242, v242
    v_rcp_f32 v243, v243
    v_mfma_f32_16x16x32_bf16 v[204:207], v[172:175], v[96:99], v[204:207]
    ds_read_b128 v[172:175], v5 offset:31744
    v_mul_f32 v240, v240, v184
    v_mul_f32 v241, v241, v185
    s_waitcnt lgkmcnt(9)
    v_mfma_f32_16x16x32_bf16 v[44:47], v[36:39], v[96:99], v[44:47]
    ds_read_b128 v[36:39], v5 offset:32768
    v_mul_f32 v242, v242, v186
    v_mul_f32 v243, v243, v187
    s_lshl_b32 s60, s54, 12
    s_add_u32 s60, s60, 0
    buffer_load_dwordx4 v[96:99], v18, s[28:31], s60 offen offset:0 sc1
    v_mfma_f32_16x16x32_bf16 v[192:195], v[40:43], v[100:103], v[192:195]
    ds_read_b128 v[40:43], v5 offset:33792
    v_cvt_pk_bf16_f32 v232, v240, v241
    v_cvt_pk_bf16_f32 v233, v242, v243
    v_mfma_f32_16x16x32_bf16 v[196:199], v[56:59], v[100:103], v[196:199]
    ds_read_b128 v[56:59], v5 offset:34816
    s_waitcnt lgkmcnt(7)
    v_cmp_gt_u32 s[22:23], 45, v7
    v_mul_f32 v240, v188, v188
    v_mul_f32 v241, v189, v189
    v_mfma_f32_16x16x32_bf16 v[200:203], v[60:63], v[100:103], v[200:203]
    ds_read_b128 v[60:63], v5 offset:35840
    v_mov_b32 v8, 44
    v_mul_f32 v242, v190, v190
    v_mul_f32 v243, v191, v191
    v_mfma_f32_16x16x32_bf16 v[204:207], v[144:147], v[100:103], v[204:207]
    s_cmp_lg_u64 s[22:23], 0
    s_cbranch_scc1 Lw_73
Lw_73_ok:
    ds_read_b128 v[144:147], v5 offset:36864
    ds_write_b32 v15, v8
    v_fma_f32 v240, v240, v29, v28
    v_fma_f32 v241, v241, v29, v28
    v_mfma_f32_16x16x32_bf16 v[44:47], v[148:151], v[100:103], v[44:47]
    ds_read_b128 v[148:151], v5 offset:37888
    v_fma_f32 v242, v242, v29, v28
    v_fma_f32 v243, v243, v29, v28
    buffer_load_dwordx4 v[100:103], v18, s[28:31], s60 offen offset:1024 sc1
    v_mfma_f32_16x16x32_bf16 v[192:195], v[152:155], v[104:107], v[192:195]
    ds_read_b128 v[152:155], v5 offset:38912
    v_mul_f32 v240, v240, v188
    v_mul_f32 v241, v241, v189
    v_mul_f32 v242, v242, v190
    v_mfma_f32_16x16x32_bf16 v[196:199], v[156:159], v[104:107], v[196:199]
    ds_read_b128 v[156:159], v5 offset:39936
    v_mul_f32 v243, v243, v191
    v_exp_f32 v240, v240
    s_waitcnt lgkmcnt(9)
    v_mfma_f32_16x16x32_bf16 v[200:203], v[160:163], v[104:107], v[200:203]
    ds_read_b128 v[160:163], v5 offset:40960
    v_exp_f32 v241, v241
    v_exp_f32 v242, v242
    v_mfma_f32_16x16x32_bf16 v[204:207], v[164:167], v[104:107], v[204:207]
    ds_read_b128 v[164:167], v5 offset:41984
    v_exp_f32 v243, v243
    v_fma_f32 v240, v240, v30, v30
    v_mfma_f32_16x16x32_bf16 v[44:47], v[168:171], v[104:107], v[44:47]
    ds_read_b128 v[168:171], v5 offset:43008
    v_fma_f32 v241, v241, v30, v30
    v_fma_f32 v242, v242, v30, v30
    buffer_load_dwordx4 v[104:107], v18, s[28:31], s60 offen offset:2048 sc1
    v_mfma_f32_16x16x32_bf16 v[192:195], v[172:175], v[108:111], v[192:195]
    ds_read_b128 v[172:175], v5 offset:44032
    v_fma_f32 v243, v243, v30, v30
    v_rcp_f32 v240, v240
    s_waitcnt lgkmcnt(9)
    v_mfma_f32_16x16x32_bf16 v[196:199], v[36:39], v[108:111], v[196:199]
    ds_read_b128 v[36:39], v5 offset:45056
    v_rcp_f32 v241, v241
    v_rcp_f32 v242, v242
    v_mfma_f32_16x16x32_bf16 v[200:203], v[40:43], v[108:111], v[200:203]
    ds_read_b128 v[40:43], v5 offset:46080
    v_rcp_f32 v243, v243
    v_mul_f32 v240, v240, v188
    v_mfma_f32_16x16x32_bf16 v[204:207], v[56:59], v[108:111], v[204:207]
    ds_read_b128 v[56:59], v5 offset:47104
    v_mul_f32 v241, v241, v189
    v_mul_f32 v242, v242, v190
    v_mfma_f32_16x16x32_bf16 v[44:47], v[60:63], v[108:111], v[44:47]
    ds_read_b128 v[60:63], v5 offset:48128
    ds_read_b32 v7, v6
    v_mul_f32 v243, v243, v191
    v_cvt_pk_bf16_f32 v234, v240, v241
    v_cvt_pk_bf16_f32 v235, v242, v243
    s_lshl_b32 s57, s43, 11
    s_add_u32 s57, s57, s55
    s_add_u32 s57, s57, 20480
    s_cmp_lg_u32 s50, 1
    s_cbranch_scc1 Lm_74
    buffer_store_dwordx4 v[228:231], v2, s[28:31], s57 offen
    buffer_store_dwordx4 v[232:235], v2, s[28:31], s57 offen offset:1024
Lm_74_b:
    buffer_load_dwordx4 v[108:111], v18, s[28:31], s60 offen offset:3072 sc1
    s_waitcnt lgkmcnt(9)
    v_mfma_f32_16x16x32_bf16 v[192:195], v[144:147], v[112:115], v[192:195]
    ds_read_b128 v[144:147], v5 offset:49152
    v_mfma_f32_16x16x32_bf16 v[196:199], v[148:151], v[112:115], v[196:199]
    ds_read_b128 v[148:151], v5 offset:50176
    v_mfma_f32_16x16x32_bf16 v[200:203], v[152:155], v[112:115], v[200:203]
    ds_read_b128 v[152:155], v5 offset:51200
    v_mfma_f32_16x16x32_bf16 v[204:207], v[156:159], v[112:115], v[204:207]
    ds_read_b128 v[156:159], v5 offset:52224
    s_waitcnt lgkmcnt(9)
    v_mfma_f32_16x16x32_bf16 v[44:47], v[160:163], v[112:115], v[44:47]
    ds_read_b128 v[160:163], v5 offset:53248
    v_mfma_f32_16x16x32_bf16 v[192:195], v[164:167], v[116:119], v[192:195]
    ds_read_b128 v[164:167], v5 offset:54272
    v_mfma_f32_16x16x32_bf16 v[196:199], v[168:171], v[116:119], v[196:199]
    ds_read_b128 v[168:171], v5 offset:55296
    s_waitcnt lgkmcnt(7)
    v_cmp_gt_u32 s[22:23], 46, v7
    v_mfma_f32_16x16x32_bf16 v[200:203], v[172:175], v[116:119], v[200:203]
    ds_read_b128 v[172:175], v5 offset:56320
    v_mfma_f32_16x16x32_bf16 v[204:207], v[36:39], v[116:119], v[204:207]
    s_cmp_lg_u64 s[22:23], 0
    s_cbranch_scc1 Lw_75
Lw_75_ok:
    ds_read_b128 v[36:39], v2 offset:0
    v_mfma_f32_16x16x32_bf16 v[44:47], v[40:43], v[116:119], v[44:47]
    ds_read_b128 v[40:43], v2 offset:1024
    v_mfma_f32_16x16x32_bf16 v[192:195], v[56:59], v[120:123], v[192:195]
    ds_read_b128 v[56:59], v2 offset:2048
    v_mfma_f32_16x16x32_bf16 v[196:199], v[60:63], v[120:123], v[196:199]
    ds_read_b128 v[60:63], v2 offset:3072
    s_waitcnt lgkmcnt(8)
    v_mfma_f32_16x16x32_bf16 v[200:203], v[144:147], v[120:123], v[200:203]
    ds_read_b128 v[144:147], v2 offset:4096
    v_mfma_f32_16x16x32_bf16 v[204:207], v[148:151], v[120:123], v[204:207]
    ds_read_b128 v[148:151], v2 offset:5120
    v_mfma_f32_16x16x32_bf16 v[44:47], v[152:155], v[120:123], v[44:47]
    ds_read_b128 v[152:155], v2 offset:6144
    v_mfma_f32_16x16x32_bf16 v[192:195], v[156:159], v[124:127], v[192:195]
    ds_read_b128 v[156:159], v2 offset:7168
    s_waitcnt lgkmcnt(8)
    v_mfma_f32_16x16x32_bf16 v[196:199], v[160:163], v[124:127], v[196:199]
    ds_read_b128 v[160:163], v2 offset:8192
    v_mfma_f32_16x16x32_bf16 v[200:203], v[164:167], v[124:127], v[200:203]
    ds_read_b128 v[164:167], v2 offset:9216
    v_mfma_f32_16x16x32_bf16 v[204:207], v[168:171], v[124:127], v[204:207]
    ds_read_b128 v[168:171], v2 offset:10240
    v_mfma_f32_16x16x32_bf16 v[44:47], v[172:175], v[124:127], v[44:47]
    ds_read_b128 v[172:175], v2 offset:11264
    ds_read_b32 v7, v6
    s_waitcnt vmcnt(1)
    s_lshl_b32 s57, s43, 3
    s_add_u32 s57, s57, s55
    s_add_u32 s57, s57, 111232
    s_mov_b64 exec, 1
    s_cmp_lg_u32 s50, 1
    s_cbranch_scc1 Lm_76
    buffer_store_dwordx2 v[12:13], v14, s[28:31], s57 offen
Lm_76_b:
    s_mov_b64 exec, -1
    s_waitcnt lgkmcnt(9)
    v_mfma_f32_16x16x32_bf16 v[192:195], v[36:39], v[128:131], v[192:195]
    ds_read_b128 v[36:39], v2 offset:12288
    v_mfma_f32_16x16x32_bf16 v[196:199], v[40:43], v[128:131], v[196:199]
    ds_read_b128 v[40:43], v2 offset:13312
    v_mfma_f32_16x16x32_bf16 v[200:203], v[56:59], v[128:131], v[200:203]
    ds_read_b128 v[56:59], v2 offset:14336
    v_mfma_f32_16x16x32_bf16 v[204:207], v[60:63], v[128:131], v[204:207]
    ds_read_b128 v[60:63], v2 offset:15360
    s_waitcnt lgkmcnt(9)
    v_mfma_f32_16x16x32_bf16 v[44:47], v[144:147], v[128:131], v[44:47]
    ds_read_b128 v[144:147], v2 offset:16384
    v_mfma_f32_16x16x32_bf16 v[192:195], v[148:151], v[132:135], v[192:195]
    ds_read_b128 v[148:151], v2 offset:17408
    v_mfma_f32_16x16x32_bf16 v[196:199], v[152:155], v[132:135], v[196:199]
    ds_read_b128 v[152:155], v2 offset:18432
    s_waitcnt lgkmcnt(7)
    v_cmp_gt_u32 s[22:23], 47, v7
    v_mfma_f32_16x16x32_bf16 v[200:203], v[156:159], v[132:135], v[200:203]
    ds_read_b128 v[156:159], v2 offset:19456
    v_mov_b32 v8, 46
    v_mfma_f32_16x16x32_bf16 v[204:207], v[160:163], v[132:135], v[204:207]
    s_cmp_lg_u64 s[22:23], 0
    s_cbranch_scc1 Lw_77
Lw_77_ok:
    ds_read_b128 v[160:163], v2 offset:20480
    ds_write_b32 v15, v8
    v_mfma_f32_16x16x32_bf16 v[44:47], v[164:167], v[132:135], v[44:47]
    ds_read_b128 v[164:167], v2 offset:21504
    v_mfma_f32_16x16x32_bf16 v[192:195], v[168:171], v[136:139], v[192:195]
    ds_read_b128 v[168:171], v2 offset:22528
    v_mfma_f32_16x16x32_bf16 v[196:199], v[172:175], v[136:139], v[196:199]
    ds_read_b128 v[172:175], v2 offset:23552
    s_waitcnt lgkmcnt(9)
    v_mfma_f32_16x16x32_bf16 v[200:203], v[36:39], v[136:139], v[200:203]
    ds_read_b128 v[36:39], v2 offset:24576
    v_mfma_f32_16x16x32_bf16 v[204:207], v[40:43], v[136:139], v[204:207]
    ds_read_b128 v[40:43], v2 offset:25600
    v_mfma_f32_16x16x32_bf16 v[44:47], v[56:59], v[136:139], v[44:47]
    ds_read_b128 v[56:59], v2 offset:26624
    v_mfma_f32_16x16x32_bf16 v[192:195], v[60:63], v[140:143], v[192:195]
    ds_read_b128 v[60:63], v2 offset:27648
    s_waitcnt lgkmcnt(9)
    v_mfma_f32_16x16x32_bf16 v[196:199], v[144:147], v[140:143], v[196:199]
    ds_read_b128 v[144:147], v2 offset:28672
    v_mfma_f32_16x16x32_bf16 v[200:203], v[148:151], v[140:143], v[200:203]
    ds_read_b128 v[148:151], v2 offset:29696
    v_mfma_f32_16x16x32_bf16 v[204:207], v[152:155], v[140:143], v[204:207]
    ds_read_b128 v[152:155], v2 offset:30720
    v_mfma_f32_16x16x32_bf16 v[44:47], v[156:159], v[140:143], v[44:47]
    ds_read_b128 v[156:159], v2 offset:31744
    ds_read_b32 v7, v6
    s_waitcnt lgkmcnt(9)
    v_mfma_f32_16x16x32_bf16 v[192:195], v[160:163], v[64:67], v[192:195]
    ds_read_b128 v[160:163], v2 offset:32768
    v_mfma_f32_16x16x32_bf16 v[196:199], v[164:167], v[64:67], v[196:199]
    ds_read_b128 v[164:167], v2 offset:33792
    v_mfma_f32_16x16x32_bf16 v[200:203], v[168:171], v[64:67], v[200:203]
    ds_read_b128 v[168:171], v2 offset:34816
    v_mfma_f32_16x16x32_bf16 v[204:207], v[172:175], v[64:67], v[204:207]
    ds_read_b128 v[172:175], v2 offset:35840
    s_waitcnt lgkmcnt(9)
    v_mfma_f32_16x16x32_bf16 v[44:47], v[36:39], v[64:67], v[44:47]
    ds_read_b128 v[36:39], v2 offset:36864
    v_mfma_f32_16x16x32_bf16 v[192:195], v[40:43], v[68:71], v[192:195]
    ds_read_b128 v[40:43], v2 offset:37888
    v_mfma_f32_16x16x32_bf16 v[196:199], v[56:59], v[68:71], v[196:199]
    ds_read_b128 v[56:59], v2 offset:38912
    s_waitcnt lgkmcnt(7)
    v_cmp_gt_u32 s[22:23], 48, v7
    v_mfma_f32_16x16x32_bf16 v[200:203], v[60:63], v[68:71], v[200:203]
    ds_read_b128 v[60:63], v2 offset:39936
    v_mfma_f32_16x16x32_bf16 v[204:207], v[144:147], v[68:71], v[204:207]
    s_cmp_lg_u64 s[22:23], 0
    s_cbranch_scc1 Lw_78
Lw_78_ok:
    ds_read_b128 v[144:147], v2 offset:40960
    v_mfma_f32_16x16x32_bf16 v[44:47], v[148:151], v[68:71], v[44:47]
    ds_read_b128 v[148:151], v2 offset:41984
    s_mov_b32 s58, 111232
    buffer_load_dwordx2 v[244:245], v20, s[28:31], s58 offen sc1
    v_mfma_f32_16x16x32_bf16 v[192:195], v[152:155], v[72:75], v[192:195]
    ds_read_b128 v[152:155], v2 offset:43008
    v_mfma_f32_16x16x32_bf16 v[196:199], v[156:159], v[72:75], v[196:199]
    ds_read_b128 v[156:159], v2 offset:44032
    s_waitcnt lgkmcnt(8)
    v_mfma_f32_16x16x32_bf16 v[200:203], v[160:163], v[72:75], v[200:203]
    ds_read_b128 v[160:163], v2 offset:45056
    v_mfma_f32_16x16x32_bf16 v[204:207], v[164:167], v[72:75], v[204:207]
    ds_read_b128 v[164:167], v2 offset:46080
    v_mfma_f32_16x16x32_bf16 v[44:47], v[168:171], v[72:75], v[44:47]
    ds_read_b128 v[168:171], v2 offset:47104
    v_mfma_f32_16x16x32_bf16 v[192:195], v[172:175], v[76:79], v[192:195]
    ds_read_b128 v[172:175], v2 offset:48128
    s_waitcnt lgkmcnt(8)
    v_mfma_f32_16x16x32_bf16 v[196:199], v[36:39], v[76:79], v[196:199]
    ds_read_b128 v[36:39], v2 offset:49152
    v_mfma_f32_16x16x32_bf16 v[200:203], v[40:43], v[76:79], v[200:203]
    ds_read_b128 v[40:43], v2 offset:50176
    v_mfma_f32_16x16x32_bf16 v[204:207], v[56:59], v[76:79], v[204:207]
    ds_read_b128 v[56:59], v2 offset:51200
    v_mfma_f32_16x16x32_bf16 v[44:47], v[60:63], v[76:79], v[44:47]
    ds_read_b128 v[60:63], v2 offset:52224
    ds_read_b32 v7, v6
    s_waitcnt lgkmcnt(9)
    v_mfma_f32_16x16x32_bf16 v[192:195], v[144:147], v[80:83], v[192:195]
    ds_read_b128 v[144:147], v2 offset:53248
    v_mfma_f32_16x16x32_bf16 v[196:199], v[148:151], v[80:83], v[196:199]
    ds_read_b128 v[148:151], v2 offset:54272
    v_mfma_f32_16x16x32_bf16 v[200:203], v[152:155], v[80:83], v[200:203]
    ds_read_b128 v[152:155], v2 offset:55296
    v_mfma_f32_16x16x32_bf16 v[204:207], v[156:159], v[80:83], v[204:207]
    ds_read_b128 v[156:159], v2 offset:56320
    s_waitcnt lgkmcnt(9)
    v_mfma_f32_16x16x32_bf16 v[44:47], v[160:163], v[80:83], v[44:47]
    ds_read_b128 v[160:163], v2 offset:57344
    v_mfma_f32_16x16x32_bf16 v[192:195], v[164:167], v[84:87], v[192:195]
    ds_read_b128 v[164:167], v2 offset:58368
    v_mfma_f32_16x16x32_bf16 v[196:199], v[168:171], v[84:87], v[196:199]
    ds_read_b128 v[168:171], v2 offset:59392
    s_waitcnt lgkmcnt(7)
    v_cmp_gt_u32 s[22:23], 49, v7
    v_mfma_f32_16x16x32_bf16 v[200:203], v[172:175], v[84:87], v[200:203]
    ds_read_b128 v[172:175], v2 offset:60416
    v_mov_b32 v8, 48
    v_mfma_f32_16x16x32_bf16 v[204:207], v[36:39], v[84:87], v[204:207]
    s_cmp_lg_u64 s[22:23], 0
    s_cbranch_scc1 Lw_79
Lw_79_ok:
    ds_read_b128 v[36:39], v2 offset:61440
    ds_write_b32 v15, v8
    v_mfma_f32_16x16x32_bf16 v[44:47], v[40:43], v[84:87], v[44:47]
    ds_read_b128 v[40:43], v2 offset:62464
    s_waitcnt vmcnt(0)
    v_cmp_ne_u64 vcc, s[48:49], v[244:245]
    s_cbranch_vccnz Lg_80
Lg_80_ok:
    s_lshl_b32 s60, s51, 12
    s_add_u32 s60, s60, 20480
    buffer_load_dwordx4 v[112:115], v18, s[28:31], s60 offen offset:0 sc1
    buffer_load_dwordx4 v[116:119], v18, s[28:31], s60 offen offset:1024 sc1
    buffer_load_dwordx4 v[120:123], v18, s[28:31], s60 offen offset:2048 sc1
    buffer_load_dwordx4 v[124:127], v18, s[28:31], s60 offen offset:3072 sc1
    v_mfma_f32_16x16x32_bf16 v[192:195], v[56:59], v[88:91], v[192:195]
    ds_read_b128 v[56:59], v2 offset:63488
    v_mfma_f32_16x16x32_bf16 v[196:199], v[60:63], v[88:91], v[196:199]
    ds_read_b128 v[60:63], v2 offset:64512
    s_waitcnt lgkmcnt(9)
    v_mfma_f32_16x16x32_bf16 v[200:203], v[144:147], v[88:91], v[200:203]
    ds_read_b128 v[144:147], v5 offset:0
    v_mfma_f32_16x16x32_bf16 v[204:207], v[148:151], v[88:91], v[204:207]
    ds_read_b128 v[148:151], v5 offset:1024
    v_mfma_f32_16x16x32_bf16 v[44:47], v[152:155], v[88:91], v[44:47]
    ds_read_b128 v[152:155], v5 offset:2048
    s_lshl_b32 s60, s52, 12
    s_add_u32 s60, s60, 20480
    buffer_load_dwordx4 v[128:131], v18, s[28:31], s60 offen offset:0 sc1
    buffer_load_dwordx4 v[132:135], v18, s[28:31], s60 offen offset:1024 sc1
    buffer_load_dwordx4 v[136:139], v18, s[28:31], s60 offen offset:2048 sc1
    buffer_load_dwordx4 v[140:143], v18, s[28:31], s60 offen offset:3072 sc1
    v_mfma_f32_16x16x32_bf16 v[192:195], v[156:159], v[92:95], v[192:195]
    ds_read_b128 v[156:159], v5 offset:3072
    s_waitcnt lgkmcnt(9)
    v_mfma_f32_16x16x32_bf16 v[196:199], v[160:163], v[92:95], v[196:199]
    ds_read_b128 v[160:163], v5 offset:4096
    v_mfma_f32_16x16x32_bf16 v[200:203], v[164:167], v[92:95], v[200:203]
    ds_read_b128 v[164:167], v5 offset:5120
    v_mfma_f32_16x16x32_bf16 v[204:207], v[168:171], v[92:95], v[204:207]
    ds_read_b128 v[168:171], v5 offset:6144
    v_mfma_f32_16x16x32_bf16 v[44:47], v[172:175], v[92:95], v[44:47]
    ds_read_b128 v[172:175], v5 offset:7168
    ds_read_b32 v7, v6
    s_lshl_b32 s60, s53, 12
    s_add_u32 s60, s60, 20480
    buffer_load_dwordx4 v[64:67], v18, s[28:31], s60 offen offset:0 sc1
    buffer_load_dwordx4 v[68:71], v18, s[28:31], s60 offen offset:1024 sc1
    buffer_load_dwordx4 v[72:75], v18, s[28:31], s60 offen offset:2048 sc1
    buffer_load_dwordx4 v[76:79], v18, s[28:31], s60 offen offset:3072 sc1
    s_waitcnt lgkmcnt(9)
    v_mfma_f32_16x16x32_bf16 v[192:195], v[36:39], v[96:99], v[192:195]
    ds_read_b128 v[36:39], v5 offset:8192
    v_mfma_f32_16x16x32_bf16 v[196:199], v[40:43], v[96:99], v[196:199]
    ds_read_b128 v[40:43], v5 offset:9216
    v_mfma_f32_16x16x32_bf16 v[200:203], v[56:59], v[96:99], v[200:203]
    ds_read_b128 v[56:59], v5 offset:10240
    v_mfma_f32_16x16x32_bf16 v[204:207], v[60:63], v[96:99], v[204:207]
    ds_read_b128 v[60:63], v5 offset:11264
    s_waitcnt lgkmcnt(9)
    v_mfma_f32_16x16x32_bf16 v[44:47], v[144:147], v[96:99], v[44:47]
    ds_read_b128 v[144:147], v5 offset:12288
    s_lshl_b32 s60, s54, 12
    s_add_u32 s60, s60, 20480
    buffer_load_dwordx4 v[80:83], v18, s[28:31], s60 offen offset:0 sc1
    buffer_load_dwordx4 v[84:87], v18, s[28:31], s60 offen offset:1024 sc1
    buffer_load_dwordx4 v[88:91], v18, s[28:31], s60 offen offset:2048 sc1
    buffer_load_dwordx4 v[92:95], v18, s[28:31], s60 offen offset:3072 sc1
    v_mfma_f32_16x16x32_bf16 v[192:195], v[148:151], v[100:103], v[192:195]
    ds_read_b128 v[148:151], v5 offset:13312
    v_mfma_f32_16x16x32_bf16 v[196:199], v[152:155], v[100:103], v[196:199]
    ds_read_b128 v[152:155], v5 offset:14336
    s_waitcnt lgkmcnt(7)
    v_cmp_gt_u32 s[22:23], 50, v7
    v_mfma_f32_16x16x32_bf16 v[200:203], v[156:159], v[100:103], v[200:203]
    ds_read_b128 v[156:159], v5 offset:15360
    v_mfma_f32_16x16x32_bf16 v[204:207], v[160:163], v[100:103], v[204:207]
    s_cmp_lg_u64 s[22:23], 0
    s_cbranch_scc1 Lw_81
Lw_81_ok:
    ds_read_b128 v[160:163], v5 offset:57344
    v_mfma_f32_16x16x32_bf16 v[44:47], v[164:167], v[100:103], v[44:47]
    ds_read_b128 v[164:167], v5 offset:58368
    v_mfma_f32_16x16x32_bf16 v[192:195], v[168:171], v[104:107], v[192:195]
    ds_read_b128 v[168:171], v5 offset:59392
    v_mfma_f32_16x16x32_bf16 v[196:199], v[172:175], v[104:107], v[196:199]
    ds_read_b128 v[172:175], v5 offset:60416
    s_waitcnt lgkmcnt(8)
    v_mfma_f32_16x16x32_bf16 v[200:203], v[36:39], v[104:107], v[200:203]
    ds_read_b128 v[36:39], v5 offset:61440
    v_mfma_f32_16x16x32_bf16 v[204:207], v[40:43], v[104:107], v[204:207]
    ds_read_b128 v[40:43], v5 offset:62464
    v_mfma_f32_16x16x32_bf16 v[44:47], v[56:59], v[104:107], v[44:47]
    ds_read_b128 v[56:59], v5 offset:63488
    v_mfma_f32_16x16x32_bf16 v[192:195], v[60:63], v[108:111], v[192:195]
    ds_read_b128 v[60:63], v5 offset:64512
    s_waitcnt lgkmcnt(8)
    v_mfma_f32_16x16x32_bf16 v[196:199], v[144:147], v[108:111], v[196:199]
    ds_read_b128 v[144:147], v9 offset:0
    v_mfma_f32_16x16x32_bf16 v[200:203], v[148:151], v[108:111], v[200:203]
    ds_read_b128 v[148:151], v9 offset:1024
    v_mfma_f32_16x16x32_bf16 v[204:207], v[152:155], v[108:111], v[204:207]
    ds_read_b128 v[152:155], v9 offset:2048
    v_mfma_f32_16x16x32_bf16 v[44:47], v[156:159], v[108:111], v[44:47]
    ds_read_b128 v[156:159], v9 offset:3072
    ds_read_b32 v7, v6
    s_waitcnt vmcnt(15)
    s_waitcnt lgkmcnt(9)
    v_mfma_f32_16x16x32_bf16 v[192:195], v[160:163], v[112:115], v[192:195]
    ds_read_b128 v[160:163], v9 offset:4096
    v_mfma_f32_16x16x32_bf16 v[196:199], v[164:167], v[112:115], v[196:199]
    ds_read_b128 v[164:167], v9 offset:5120
    v_mfma_f32_16x16x32_bf16 v[200:203], v[168:171], v[112:115], v[200:203]
    ds_read_b128 v[168:171], v9 offset:6144
    v_mfma_f32_16x16x32_bf16 v[204:207], v[172:175], v[112:115], v[204:207]
    ds_read_b128 v[172:175], v9 offset:7168
    s_waitcnt lgkmcnt(9)
    v_mfma_f32_16x16x32_bf16 v[44:47], v[36:39], v[112:115], v[44:47]
    ds_read_b128 v[36:39], v9 offset:8192
    s_waitcnt vmcnt(14)
    v_mfma_f32_16x16x32_bf16 v[192:195], v[40:43], v[116:119], v[192:195]
    ds_read_b128 v[40:43], v9 offset:9216
    v_mfma_f32_16x16x32_bf16 v[196:199], v[56:59], v[116:119], v[196:199]
    ds_read_b128 v[56:59], v9 offset:10240
    s_waitcnt lgkmcnt(7)
    v_cmp_gt_u32 s[22:23], 51, v7
    v_mfma_f32_16x16x32_bf16 v[200:203], v[60:63], v[116:119], v[200:203]
    ds_read_b128 v[60:63], v9 offset:11264
    v_mfma_f32_16x16x32_bf16 v[204:207], v[144:147], v[116:119], v[204:207]
    s_cmp_lg_u64 s[22:23], 0
    s_cbranch_scc1 Lw_82
Lw_82_ok:
    ds_read_b128 v[144:147], v5 offset:16384
    v_mfma_f32_16x16x32_bf16 v[44:47], v[148:151], v[116:119], v[44:47]
    ds_read_b128 v[148:151], v5 offset:17408
    s_waitcnt vmcnt(13)
    v_mfma_f32_16x16x32_bf16 v[192:195], v[152:155], v[120:123], v[192:195]
    ds_read_b128 v[152:155], v5 offset:18432
    v_mfma_f32_16x16x32_bf16 v[196:199], v[156:159], v[120:123], v[196:199]
    ds_read_b128 v[156:159], v5 offset:19456
    s_waitcnt lgkmcnt(8)
    v_mfma_f32_16x16x32_bf16 v[200:203], v[160:163], v[120:123], v[200:203]
    ds_read_b128 v[160:163], v5 offset:20480
    v_mfma_f32_16x16x32_bf16 v[204:207], v[164:167], v[120:123], v[204:207]
    ds_read_b128 v[164:167], v5 offset:21504
    v_mfma_f32_16x16x32_bf16 v[44:47], v[168:171], v[120:123], v[44:47]
    ds_read_b128 v[168:171], v5 offset:22528
    s_waitcnt vmcnt(12)
    v_mfma_f32_16x16x32_bf16 v[192:195], v[172:175], v[124:127], v[192:195]
    ds_read_b128 v[172:175], v5 offset:23552
    s_waitcnt lgkmcnt(8)
    v_mfma_f32_16x16x32_bf16 v[196:199], v[36:39], v[124:127], v[196:199]
    ds_read_b128 v[36:39], v5 offset:24576
    v_mfma_f32_16x16x32_bf16 v[200:203], v[40:43], v[124:127], v[200:203]
    ds_read_b128 v[40:43], v5 offset:25600
    v_mfma_f32_16x16x32_bf16 v[204:207], v[56:59], v[124:127], v[204:207]
    ds_read_b128 v[56:59], v5 offset:26624
    v_mfma_f32_16x16x32_bf16 v[44:47], v[60:63], v[124:127], v[44:47]
    ds_read_b128 v[60:63], v5 offset:27648
    ds_read_b32 v7, v6
    s_waitcnt vmcnt(11)
    s_waitcnt lgkmcnt(9)
    v_mfma_f32_16x16x32_bf16 v[192:195], v[144:147], v[128:131], v[192:195]
    ds_read_b128 v[144:147], v5 offset:28672
    v_mfma_f32_16x16x32_bf16 v[196:199], v[148:151], v[128:131], v[196:199]
    ds_read_b128 v[148:151], v5 offset:29696
    v_mfma_f32_16x16x32_bf16 v[200:203], v[152:155], v[128:131], v[200:203]
    ds_read_b128 v[152:155], v5 offset:30720
    v_mfma_f32_16x16x32_bf16 v[204:207], v[156:159], v[128:131], v[204:207]
    ds_read_b128 v[156:159], v5 offset:31744
    s_waitcnt lgkmcnt(9)
    v_mfma_f32_16x16x32_bf16 v[44:47], v[160:163], v[128:131], v[44:47]
    ds_read_b128 v[160:163], v5 offset:32768
    s_waitcnt vmcnt(10)
    v_mfma_f32_16x16x32_bf16 v[192:195], v[164:167], v[132:135], v[192:195]
    ds_read_b128 v[164:167], v5 offset:33792
    v_mfma_f32_16x16x32_bf16 v[196:199], v[168:171], v[132:135], v[196:199]
    ds_read_b128 v[168:171], v5 offset:34816
    s_waitcnt lgkmcnt(7)
    v_cmp_gt_u32 s[22:23], 52, v7
    v_mfma_f32_16x16x32_bf16 v[200:203], v[172:175], v[132:135], v[200:203]
    ds_read_b128 v[172:175], v5 offset:35840
    v_mfma_f32_16x16x32_bf16 v[204:207], v[36:39], v[132:135], v[204:207]
    s_cmp_lg_u64 s[22:23], 0
    s_cbranch_scc1 Lw_83
Lw_83_ok:
    ds_read_b128 v[36:39], v5 offset:36864
    v_mfma_f32_16x16x32_bf16 v[44:47], v[40:43], v[132:135], v[44:47]
    ds_read_b128 v[40:43], v5 offset:37888
    s_waitcnt vmcnt(9)
    v_mfma_f32_16x16x32_bf16 v[192:195], v[56:59], v[136:139], v[192:195]
    ds_read_b128 v[56:59], v5 offset:38912
    v_mfma_f32_16x16x32_bf16 v[196:199], v[60:63], v[136:139], v[196:199]
    ds_read_b128 v[60:63], v5 offset:39936
    s_waitcnt lgkmcnt(8)
    v_mfma_f32_16x16x32_bf16 v[200:203], v[144:147], v[136:139], v[200:203]
    ds_read_b128 v[144:147], v5 offset:40960
    v_mfma_f32_16x16x32_bf16 v[204:207], v[148:151], v[136:139], v[204:207]
    ds_read_b128 v[148:151], v5 offset:41984
    v_mfma_f32_16x16x32_bf16 v[44:47], v[152:155], v[136:139], v[44:47]
    ds_read_b128 v[152:155], v5 offset:43008
    s_waitcnt vmcnt(8)
    v_mfma_f32_16x16x32_bf16 v[192:195], v[156:159], v[140:143], v[192:195]
    ds_read_b128 v[156:159], v5 offset:44032
    s_waitcnt lgkmcnt(8)
    v_mfma_f32_16x16x32_bf16 v[196:199], v[160:163], v[140:143], v[196:199]
    ds_read_b128 v[160:163], v5 offset:45056
    v_mfma_f32_16x16x32_bf16 v[200:203], v[164:167], v[140:143], v[200:203]
    ds_read_b128 v[164:167], v5 offset:46080
    v_mfma_f32_16x16x32_bf16 v[204:207], v[168:171], v[140:143], v[204:207]
    ds_read_b128 v[168:171], v5 offset:47104
    v_mfma_f32_16x16x32_bf16 v[44:47], v[172:175], v[140:143], v[44:47]
    ds_read_b128 v[172:175], v5 offset:48128
    ds_read_b32 v7, v6
    s_waitcnt vmcnt(7)
    s_waitcnt lgkmcnt(9)
    v_mfma_f32_16x16x32_bf16 v[192:195], v[36:39], v[64:67], v[192:195]
    ds_read_b128 v[36:39], v5 offset:49152
    v_mfma_f32_16x16x32_bf16 v[196:199], v[40:43], v[64:67], v[196:199]
    ds_read_b128 v[40:43], v5 offset:50176
    v_mfma_f32_16x16x32_bf16 v[200:203], v[56:59], v[64:67], v[200:203]
    ds_read_b128 v[56:59], v5 offset:51200
    v_mfma_f32_16x16x32_bf16 v[204:207], v[60:63], v[64:67], v[204:207]
    ds_read_b128 v[60:63], v5 offset:52224
    s_waitcnt lgkmcnt(9)
    v_mfma_f32_16x16x32_bf16 v[44:47], v[144:147], v[64:67], v[44:47]
    ds_read_b128 v[144:147], v5 offset:53248
    s_waitcnt vmcnt(6)
    v_mfma_f32_16x16x32_bf16 v[192:195], v[148:151], v[68:71], v[192:195]
    ds_read_b128 v[148:151], v5 offset:54272
    v_mfma_f32_16x16x32_bf16 v[196:199], v[152:155], v[68:71], v[196:199]
    ds_read_b128 v[152:155], v5 offset:55296
    s_waitcnt lgkmcnt(7)
    v_cmp_gt_u32 s[22:23], 53, v7
    v_mfma_f32_16x16x32_bf16 v[200:203], v[156:159], v[68:71], v[200:203]
    ds_read_b128 v[156:159], v5 offset:56320
    v_mfma_f32_16x16x32_bf16 v[204:207], v[160:163], v[68:71], v[204:207]
    s_cmp_lg_u64 s[22:23], 0
    s_cbranch_scc1 Lw_84
Lw_84_ok:
    ds_read_b128 v[160:163], v2 offset:0
    v_mfma_f32_16x16x32_bf16 v[44:47], v[164:167], v[68:71], v[44:47]
    ds_read_b128 v[164:167], v2 offset:1024
    s_waitcnt vmcnt(5)
    v_mfma_f32_16x16x32_bf16 v[192:195], v[168:171], v[72:75], v[192:195]
    ds_read_b128 v[168:171], v2 offset:2048
    v_mfma_f32_16x16x32_bf16 v[196:199], v[172:175], v[72:75], v[196:199]
    ds_read_b128 v[172:175], v2 offset:3072
    s_waitcnt lgkmcnt(8)
    v_mfma_f32_16x16x32_bf16 v[200:203], v[36:39], v[72:75], v[200:203]
    ds_read_b128 v[36:39], v2 offset:4096
    v_mfma_f32_16x16x32_bf16 v[204:207], v[40:43], v[72:75], v[204:207]
    ds_read_b128 v[40:43], v2 offset:5120
    v_mfma_f32_16x16x32_bf16 v[44:47], v[56:59], v[72:75], v[44:47]
    ds_read_b128 v[56:59], v2 offset:6144
    s_waitcnt vmcnt(4)
    v_mfma_f32_16x16x32_bf16 v[192:195], v[60:63], v[76:79], v[192:195]
    ds_read_b128 v[60:63], v2 offset:7168
    s_waitcnt lgkmcnt(8)
    v_mfma_f32_16x16x32_bf16 v[196:199], v[144:147], v[76:79], v[196:199]
    ds_read_b128 v[144:147], v2 offset:8192
    v_mfma_f32_16x16x32_bf16 v[200:203], v[148:151], v[76:79], v[200:203]
    ds_read_b128 v[148:151], v2 offset:9216
    v_mfma_f32_16x16x32_bf16 v[204:207], v[152:155], v[76:79], v[204:207]
    ds_read_b128 v[152:155], v2 offset:10240
    v_mfma_f32_16x16x32_bf16 v[44:47], v[156:159], v[76:79], v[44:47]
    ds_read_b128 v[156:159], v2 offset:11264
    s_waitcnt vmcnt(3)
    s_waitcnt lgkmcnt(8)
    v_mfma_f32_16x16x32_bf16 v[192:195], v[160:163], v[80:83], v[192:195]
    ds_read_b128 v[160:163], v2 offset:12288
    v_mfma_f32_16x16x32_bf16 v[196:199], v[164:167], v[80:83], v[196:199]
    ds_read_b128 v[164:167], v2 offset:13312
    v_mfma_f32_16x16x32_bf16 v[200:203], v[168:171], v[80:83], v[200:203]
    ds_read_b128 v[168:171], v2 offset:14336
    v_mfma_f32_16x16x32_bf16 v[204:207], v[172:175], v[80:83], v[204:207]
    ds_read_b128 v[172:175], v2 offset:15360
    s_waitcnt lgkmcnt(8)
    v_mfma_f32_16x16x32_bf16 v[44:47], v[36:39], v[80:83], v[44:47]
    ds_read_b128 v[36:39], v2 offset:16384
    s_waitcnt vmcnt(2)
    v_mfma_f32_16x16x32_bf16 v[192:195], v[40:43], v[84:87], v[192:195]
    ds_read_b128 v[40:43], v2 offset:17408
    v_mfma_f32_16x16x32_bf16 v[196:199], v[56:59], v[84:87], v[196:199]
    ds_read_b128 v[56:59], v2 offset:18432
    v_mfma_f32_16x16x32_bf16 v[200:203], v[60:63], v[84:87], v[200:203]
    ds_read_b128 v[60:63], v2 offset:19456
    s_waitcnt lgkmcnt(8)
    v_mfma_f32_16x16x32_bf16 v[204:207], v[144:147], v[84:87], v[204:207]
    v_mfma_f32_16x16x32_bf16 v[44:47], v[148:151], v[84:87], v[44:47]
    s_waitcnt vmcnt(1)
    v_mfma_f32_16x16x32_bf16 v[192:195], v[152:155], v[88:91], v[192:195]
    v_mfma_f32_16x16x32_bf16 v[196:199], v[156:159], v[88:91], v[196:199]
    s_waitcnt lgkmcnt(4)
    v_mfma_f32_16x16x32_bf16 v[200:203], v[160:163], v[88:91], v[200:203]
    v_mfma_f32_16x16x32_bf16 v[204:207], v[164:167], v[88:91], v[204:207]
    v_mfma_f32_16x16x32_bf16 v[44:47], v[168:171], v[88:91], v[44:47]
    s_waitcnt vmcnt(0)
    v_mfma_f32_16x16x32_bf16 v[192:195], v[172:175], v[92:95], v[192:195]
    s_waitcnt lgkmcnt(0)
    v_mfma_f32_16x16x32_bf16 v[196:199], v[36:39], v[92:95], v[196:199]
    v_mfma_f32_16x16x32_bf16 v[200:203], v[40:43], v[92:95], v[200:203]
    v_mfma_f32_16x16x32_bf16 v[204:207], v[56:59], v[92:95], v[204:207]
    v_mfma_f32_16x16x32_bf16 v[44:47], v[60:63], v[92:95], v[44:47]
    s_nop 2
    v_cvt_pk_bf16_f32 v228, v192, v193
    v_cvt_pk_bf16_f32 v229, v194, v195
    v_cvt_pk_bf16_f32 v230, v196, v197
    v_cvt_pk_bf16_f32 v231, v198, v199
    v_cvt_pk_bf16_f32 v232, v200, v201
    v_cvt_pk_bf16_f32 v233, v202, v203
    v_cvt_pk_bf16_f32 v234, v204, v205
    v_cvt_pk_bf16_f32 v235, v206, v207
    v_cvt_pk_bf16_f32 v236, v44, v45
    v_cvt_pk_bf16_f32 v237, v46, v47
    s_mul_i32 s58, s40, 2560
    s_add_u32 s58, s58, 143360
    v_mul_u32_u24 v48, 160, v17
    v_lshl_add_u32 v48, v16, 3, v48
    v_add_u32 v48, s58, v48
    v_add_u32 v49, s58, v2
    ds_write_b64 v48, v[228:229] offset:0
    ds_write_b64 v48, v[230:231] offset:32
    ds_write_b64 v48, v[232:233] offset:64
    ds_write_b64 v48, v[234:235] offset:96
    ds_write_b64 v48, v[236:237] offset:128
    ds_read_b128 v[64:67], v49 offset:0
    ds_read_b128 v[68:71], v49 offset:1024
    ds_read_b128 v[72:75], v49 offset:2048
    s_mov_b32 s36, s20
    s_mov_b32 s37, s21
    s_mov_b32 s38, 2621440
    s_mov_b32 s39, 0x20000
    s_mul_i32 s57, s45, 20480
    s_mul_i32 s58, s43, 160
    s_add_u32 s57, s57, s58
    v_add_u32 v50, 0, v1
    v_mul_u32_u24 v51, 6554, v50
    v_lshrrev_b32 v51, 16, v51
    v_mul_u32_u24 v51, 1120, v51
    v_lshl_add_u32 v52, v50, 4, v51
    v_add_u32 v50, 64, v1
    v_mul_u32_u24 v51, 6554, v50
    v_lshrrev_b32 v51, 16, v51
    v_mul_u32_u24 v51, 1120, v51
    v_lshl_add_u32 v53, v50, 4, v51
    v_add_u32 v50, 128, v1
    v_mul_u32_u24 v51, 6554, v50
    v_lshrrev_b32 v51, 16, v51
    v_mul_u32_u24 v51, 1120, v51
    v_lshl_add_u32 v54, v50, 4, v51
    s_waitcnt lgkmcnt(2)
    buffer_store_dwordx4 v[64:67], v52, s[36:39], s57 offen
    s_waitcnt lgkmcnt(1)
    buffer_store_dwordx4 v[68:71], v53, s[36:39], s57 offen
    s_waitcnt lgkmcnt(0)
    s_mov_b32 exec_hi, 0
    buffer_store_dwordx4 v[72:75], v54, s[36:39], s57 offen
    s_mov_b64 exec, -1
    s_endpgm
L_loader:
    s_and_b32 s50, s40, 1
    s_mov_b32 s32, s20
    s_mov_b32 s33, s21
    s_mov_b32 s34, 2621440
    s_mov_b32 s35, 0x20000
    v_and_b32 v13, 15, v1
    v_lshlrev_b32 v46, 19, v13
    v_lshlrev_b32 v47, 20, v13
    s_mov_b64 exec, 0x3ff
    buffer_load_dword v49, v47, s[28:31], 0 offen offset:128 sc1
    buffer_load_dword v50, v46, s[32:35], 0 offen
    s_mov_b64 exec, -1
    v_and_b32 v12, 3, v1
    v_mul_u32_u24 v12, 260, v12
    v_add_u32 v12, 161792, v12
    s_lshl_b32 s57, s50, 8
    s_add_u32 s57, s57, 155008
    v_lshl_add_u32 v11, v1, 2, s57
    s_add_u32 s64, s63, 0
    s_cmp_ge_u32 s64, 1680
    s_cbranch_scc1 Lpd_85_4
    s_mul_hi_u32 s66, s64, 214748365
    s_mul_i32 s57, s66, 20
    s_sub_u32 s65, s64, s57
    s_mul_hi_u32 s71, s66, 429496730
    s_min_u32 s71, s71, 6
    s_mul_i32 s57, s71, 10
    s_sub_u32 s66, s66, s57
    s_branch Lpd_85
Lpd_85_4:
    s_sub_u32 s57, s64, 1680
    s_mul_hi_u32 s66, s57, 89478486
    s_mul_i32 s58, s66, 48
    s_sub_u32 s65, s57, s58
    s_mov_b32 s71, 7
Lpd_85:
    v_add_u32 v32, s70, v2
    v_lshrrev_b32 v33, 2, v1
    v_lshlrev_b32 v33, 7, v33
    v_and_b32 v31, 3, v1
    v_lshl_add_u32 v33, v31, 3, v33
    v_add_u32 v33, s70, v33
    v_lshlrev_b32 v34, 2, v1
    s_cmp_eq_u32 s71, 6
    s_cbranch_scc1 Ld3_86
    s_mul_i32 s69, s71, 819200
    s_cmp_eq_u32 s71, 7
    s_cselect_b32 s69, 6881280, s69
    s_mov_b32 s60, 102400
    s_cselect_b32 s60, 245760, s60
    s_mul_i32 s57, s65, 5120
    s_add_u32 s69, s69, s57
    s_add_u32 s69, s69, 262144
    s_cmp_ge_u32 s64, 2160
    s_cselect_b32 s69, 1073741824, s69
    s_lshl_b32 s57, s66, 2
    s_add_u32 s57, s57, 0
    s_mul_hi_u32 s58, s57, 858993460
    s_mul_i32 s59, s58, 5
    s_sub_u32 s57, s57, s59
    s_lshl_b32 s57, s57, 10
    s_mul_i32 s58, s58, s60
    s_add_u32 s57, s57, s58
    s_add_u32 s67, s57, s69
    s_lshl_b32 s57, s66, 2
    s_add_u32 s57, s57, 1
    s_mul_hi_u32 s58, s57, 858993460
    s_mul_i32 s59, s58, 5
    s_sub_u32 s57, s57, s59
    s_lshl_b32 s57, s57, 10
    s_mul_i32 s58, s58, s60
    s_add_u32 s57, s57, s58
    s_add_u32 s68, s57, s69
    s_lshl_b32 s57, s66, 2
    s_add_u32 s57, s57, 2
    s_mul_hi_u32 s58, s57, 858993460
    s_mul_i32 s59, s58, 5
    s_sub_u32 s57, s57, s59
    s_lshl_b32 s57, s57, 10
    s_mul_i32 s58, s58, s60
    s_add_u32 s57, s57, s58
    s_add_u32 s74, s57, s69
    s_lshl_b32 s57, s66, 2
    s_add_u32 s57, s57, 3
    s_mul_hi_u32 s58, s57, 858993460
    s_mul_i32 s59, s58, 5
    s_sub_u32 s57, s57, s59
    s_lshl_b32 s57, s57, 10
    s_mul_i32 s58, s58, s60
    s_add_u32 s57, s57, s58
    s_add_u32 s75, s57, s69
    s_mul_i32 s57, s65, 2560
    s_add_u32 s57, s57, 32768
    s_cmp_eq_u32 s71, 4
    s_cselect_b32 s57, s57, 1073741824
    s_branch Ld3_86_c
Ld3_86:
    s_mul_i32 s57, s66, 81920
    s_lshl_b32 s58, s65, 12
    s_add_u32 s57, s57, s58
    s_add_u32 s67, s57, 5177344
    s_add_u32 s68, s57, 5178368
    s_add_u32 s74, s57, 5179392
    s_add_u32 s75, s57, 5180416
    s_mul_i32 s57, s65, 6144
    s_add_u32 s57, s57, 98304
Ld3_86_c:
    s_lshl_b32 s58, s66, 8
    s_add_u32 s57, s57, s58
    s_waitcnt vmcnt(2)
    ds_write_b128 v32, v[64:67] offset:0
    ds_write_b128 v32, v[68:71] offset:1024
    ds_read_b64_tr_b16 v[192:193], v33 offset:0
    ds_read_b64_tr_b16 v[196:197], v33 offset:32
    ds_read_b64_tr_b16 v[200:201], v33 offset:64
    ds_read_b64_tr_b16 v[204:205], v33 offset:96
    ds_write_b128 v32, v[72:75] offset:0
    ds_write_b128 v32, v[76:79] offset:1024
    ds_read_b64_tr_b16 v[194:195], v33 offset:0
    ds_read_b64_tr_b16 v[198:199], v33 offset:32
    ds_read_b64_tr_b16 v[202:203], v33 offset:64
    ds_read_b64_tr_b16 v[206:207], v33 offset:96
    s_waitcnt lgkmcnt(0)
    buffer_store_dwordx4 v[192:195], v2, s[28:31], s67 offen sc1
    buffer_store_dwordx4 v[196:199], v2, s[28:31], s68 offen sc1
    buffer_store_dwordx4 v[200:203], v2, s[28:31], s74 offen sc1
    buffer_store_dwordx4 v[204:207], v2, s[28:31], s75 offen sc1
Ltg_87:
    ds_read_b64 v[38:39], v4 offset:48
    s_waitcnt lgkmcnt(0)
    v_cmp_gt_u32 vcc, 1, v39
    s_cbranch_vccz Ltg_87_ok
    s_sleep 1
    s_cmp_eq_u32 s46, 0
    s_cbranch_scc1 Ltg_87_ok
    s_sub_u32 s46, s46, 1
    s_branch Ltg_87
Ltg_87_ok:
    v_readfirstlane_b32 s48, v38
    s_mul_i32 s49, s48, 0x9E3779B1
    s_xor_b32 s49, s49, 0x7F4A7C15
    v_mov_b32 v39, s49
    s_lshl_b32 s57, s63, 5
    s_add_u32 s57, s57, 9117696
    s_waitcnt vmcnt(0)
    s_mov_b64 exec, 1
    buffer_store_dwordx2 v[38:39], v35, s[28:31], s57 offen sc1
    s_mov_b64 exec, -1
    v_mov_b32 v13, 1
    s_mov_b64 exec, 1
    ds_add_u32 v4, v13 offset:60
    s_mov_b64 exec, -1
Lsp_88:
    ds_read_b32 v13, v4 offset:56
    s_waitcnt lgkmcnt(0)
    v_cmp_gt_u32 vcc, 4, v13
    s_cbranch_vccz Lsp_88_ok
    s_sleep 1
    s_cmp_eq_u32 s46, 0
    s_cbranch_scc1 Lsp_88_ok
    s_sub_u32 s46, s46, 1
    s_branch Lsp_88
Lsp_88_ok:
    s_add_u32 s64, s63, 768
    s_cmp_ge_u32 s64, 1680
    s_cbranch_scc1 Lpd_89_4
    s_mul_hi_u32 s66, s64, 214748365
    s_mul_i32 s57, s66, 20
    s_sub_u32 s65, s64, s57
    s_mul_hi_u32 s71, s66, 429496730
    s_min_u32 s71, s71, 6
    s_mul_i32 s57, s71, 10
    s_sub_u32 s66, s66, s57
    s_branch Lpd_89
Lpd_89_4:
    s_sub_u32 s57, s64, 1680
    s_mul_hi_u32 s66, s57, 89478486
    s_mul_i32 s58, s66, 48
    s_sub_u32 s65, s57, s58
    s_mov_b32 s71, 7
Lpd_89:
    s_lshl_b32 s59, s66, 7
    v_lshrrev_b32 v28, 3, v1
    v_and_b32 v29, 7, v1
    s_cmp_lt_u32 s71, 3
    s_cbranch_scc1 Lpa_90_q
    s_cmp_eq_u32 s71, 7
    s_cbranch_scc1 Lpa_90_4
    s_mul_hi_u32 s57, s65, 858993460
    s_mul_i32 s58, s57, 5
    s_sub_u32 s58, s65, s58
    s_mul_i32 s57, s57, 160
    s_lshr_b32 s60, s58, 1
    s_mul_i32 s60, s60, 80
    s_and_b32 s68, s58, 1
    s_lshl_b32 s68, s68, 5
    s_add_u32 s60, s60, s68
    s_cmp_eq_u32 s58, 4
    s_cselect_b32 s60, 64, s60
    s_cselect_b32 s68, 80, 16
    s_add_u32 s67, s57, s60
    s_add_u32 s68, s67, s68
    s_cmp_eq_u32 s71, 6
    s_movk_i32 s69, 1280
    s_cselect_b32 s69, 3072, s69
    s_lshl_b32 s60, s69, 3
    s_branch Lpa_90
Lpa_90_4:
    s_lshr_b32 s57, s65, 4
    s_lshl_b32 s67, s57, 6
    s_bfe_u32 s57, s65, 0x30001
    s_mul_i32 s57, s57, 192
    s_add_u32 s67, s67, s57
    s_and_b32 s57, s65, 1
    s_lshl_b32 s57, s57, 5
    s_add_u32 s67, s67, s57
    s_add_u32 s68, s67, 16
    s_movk_i32 s69, 1280
    s_movk_i32 s60, 10240
    s_branch Lpa_90
Lpa_90_q:
    s_lshl_b32 s67, s65, 5
    s_add_u32 s68, s67, 4
    s_movk_i32 s69, 3840
    s_mov_b32 s60, 61440
    s_add_u32 s57, s71, 1
    s_cmp_eq_u32 s57, 3
    s_cselect_b32 s57, 0, s57
    s_mul_i32 s57, s57, 1280
    s_add_u32 s59, s59, s57
    v_and_b32 v30, 4, v28
    v_add_u32 v28, v28, v30
Lpa_90:
    v_mul_lo_u32 v36, s69, v28
    v_lshl_add_u32 v36, v29, 4, v36
    v_add_u32 v37, s60, v36
    s_mul_i32 s67, s67, s69
    s_add_u32 s67, s67, s59
    s_mul_i32 s68, s68, s69
    s_add_u32 s68, s68, s59
    s_cmp_ge_u32 s64, 2160
    s_cselect_b32 s67, 1073741824, s67
    s_cselect_b32 s68, 1073741824, s68
    s_mov_b32 s36, s6
    s_mov_b32 s37, s7
    s_mov_b32 s38, 819200
    s_mov_b32 s39, 0x20000
    s_cmp_eq_u32 s71, 3
    s_cselect_b64 s[36:37], s[8:9], s[36:37]
    s_cmp_eq_u32 s71, 4
    s_cselect_b64 s[36:37], s[12:13], s[36:37]
    s_cmp_eq_u32 s71, 5
    s_cselect_b64 s[36:37], s[14:15], s[36:37]
    s_cmp_eq_u32 s71, 6
    s_cselect_b64 s[36:37], s[16:17], s[36:37]
    s_cmp_eq_u32 s71, 7
    s_cselect_b64 s[36:37], s[18:19], s[36:37]
    s_cmp_ge_u32 s71, 6
    s_cselect_b32 s38, 1966080, s38
    s_cmp_lt_u32 s71, 3
    s_cselect_b32 s38, 2457600, s38
    buffer_load_dwordx4 v[80:83], v36, s[36:39], s67 offen nt
    buffer_load_dwordx4 v[84:87], v37, s[36:39], s67 offen nt
    buffer_load_dwordx4 v[88:91], v36, s[36:39], s68 offen nt
    buffer_load_dwordx4 v[92:95], v37, s[36:39], s68 offen nt
    s_add_u32 s64, s63, 1536
    s_cmp_ge_u32 s64, 1680
    s_cbranch_scc1 Lpd_91_4
    s_mul_hi_u32 s66, s64, 214748365
    s_mul_i32 s57, s66, 20
    s_sub_u32 s65, s64, s57
    s_mul_hi_u32 s71, s66, 429496730
    s_min_u32 s71, s71, 6
    s_mul_i32 s57, s71, 10
    s_sub_u32 s66, s66, s57
    s_branch Lpd_91
Lpd_91_4:
    s_sub_u32 s57, s64, 1680
    s_mul_hi_u32 s66, s57, 89478486
    s_mul_i32 s58, s66, 48
    s_sub_u32 s65, s57, s58
    s_mov_b32 s71, 7
Lpd_91:
    s_lshl_b32 s59, s66, 7
    v_lshrrev_b32 v28, 3, v1
    v_and_b32 v29, 7, v1
    s_cmp_lt_u32 s71, 3
    s_cbranch_scc1 Lpa_92_q
    s_cmp_eq_u32 s71, 7
    s_cbranch_scc1 Lpa_92_4
    s_mul_hi_u32 s57, s65, 858993460
    s_mul_i32 s58, s57, 5
    s_sub_u32 s58, s65, s58
    s_mul_i32 s57, s57, 160
    s_lshr_b32 s60, s58, 1
    s_mul_i32 s60, s60, 80
    s_and_b32 s68, s58, 1
    s_lshl_b32 s68, s68, 5
    s_add_u32 s60, s60, s68
    s_cmp_eq_u32 s58, 4
    s_cselect_b32 s60, 64, s60
    s_cselect_b32 s68, 80, 16
    s_add_u32 s67, s57, s60
    s_add_u32 s68, s67, s68
    s_cmp_eq_u32 s71, 6
    s_movk_i32 s69, 1280
    s_cselect_b32 s69, 3072, s69
    s_lshl_b32 s60, s69, 3
    s_branch Lpa_92
Lpa_92_4:
    s_lshr_b32 s57, s65, 4
    s_lshl_b32 s67, s57, 6
    s_bfe_u32 s57, s65, 0x30001
    s_mul_i32 s57, s57, 192
    s_add_u32 s67, s67, s57
    s_and_b32 s57, s65, 1
    s_lshl_b32 s57, s57, 5
    s_add_u32 s67, s67, s57
    s_add_u32 s68, s67, 16
    s_movk_i32 s69, 1280
    s_movk_i32 s60, 10240
    s_branch Lpa_92
Lpa_92_q:
    s_lshl_b32 s67, s65, 5
    s_add_u32 s68, s67, 4
    s_movk_i32 s69, 3840
    s_mov_b32 s60, 61440
    s_add_u32 s57, s71, 1
    s_cmp_eq_u32 s57, 3
    s_cselect_b32 s57, 0, s57
    s_mul_i32 s57, s57, 1280
    s_add_u32 s59, s59, s57
    v_and_b32 v30, 4, v28
    v_add_u32 v28, v28, v30
Lpa_92:
    v_mul_lo_u32 v36, s69, v28
    v_lshl_add_u32 v36, v29, 4, v36
    v_add_u32 v37, s60, v36
    s_mul_i32 s67, s67, s69
    s_add_u32 s67, s67, s59
    s_mul_i32 s68, s68, s69
    s_add_u32 s68, s68, s59
    s_cmp_ge_u32 s64, 2160
    s_cselect_b32 s67, 1073741824, s67
    s_cselect_b32 s68, 1073741824, s68
    s_mov_b32 s36, s6
    s_mov_b32 s37, s7
    s_mov_b32 s38, 819200
    s_mov_b32 s39, 0x20000
    s_cmp_eq_u32 s71, 3
    s_cselect_b64 s[36:37], s[8:9], s[36:37]
    s_cmp_eq_u32 s71, 4
    s_cselect_b64 s[36:37], s[12:13], s[36:37]
    s_cmp_eq_u32 s71, 5
    s_cselect_b64 s[36:37], s[14:15], s[36:37]
    s_cmp_eq_u32 s71, 6
    s_cselect_b64 s[36:37], s[16:17], s[36:37]
    s_cmp_eq_u32 s71, 7
    s_cselect_b64 s[36:37], s[18:19], s[36:37]
    s_cmp_ge_u32 s71, 6
    s_cselect_b32 s38, 1966080, s38
    s_cmp_lt_u32 s71, 3
    s_cselect_b32 s38, 2457600, s38
    buffer_load_dwordx4 v[96:99], v36, s[36:39], s67 offen nt
    buffer_load_dwordx4 v[100:103], v37, s[36:39], s67 offen nt
    buffer_load_dwordx4 v[104:107], v36, s[36:39], s68 offen nt
    buffer_load_dwordx4 v[108:111], v37, s[36:39], s68 offen nt
    s_add_u32 s64, s63, 768
    s_cmp_ge_u32 s64, 1680
    s_cbranch_scc1 Lpd_93_4
    s_mul_hi_u32 s66, s64, 214748365
    s_mul_i32 s57, s66, 20
    s_sub_u32 s65, s64, s57
    s_mul_hi_u32 s71, s66, 429496730
    s_min_u32 s71, s71, 6
    s_mul_i32 s57, s71, 10
    s_sub_u32 s66, s66, s57
    s_branch Lpd_93
Lpd_93_4:
    s_sub_u32 s57, s64, 1680
    s_mul_hi_u32 s66, s57, 89478486
    s_mul_i32 s58, s66, 48
    s_sub_u32 s65, s57, s58
    s_mov_b32 s71, 7
Lpd_93:
    s_cmp_eq_u32 s71, 6
    s_cbranch_scc1 Ld3_94
    s_mul_i32 s69, s71, 819200
    s_cmp_eq_u32 s71, 7
    s_cselect_b32 s69, 6881280, s69
    s_mov_b32 s60, 102400
    s_cselect_b32 s60, 245760, s60
    s_mul_i32 s57, s65, 5120
    s_add_u32 s69, s69, s57
    s_add_u32 s69, s69, 262144
    s_cmp_ge_u32 s64, 2160
    s_cselect_b32 s69, 1073741824, s69
    s_lshl_b32 s57, s66, 2
    s_add_u32 s57, s57, 0
    s_mul_hi_u32 s58, s57, 858993460
    s_mul_i32 s59, s58, 5
    s_sub_u32 s57, s57, s59
    s_lshl_b32 s57, s57, 10
    s_mul_i32 s58, s58, s60
    s_add_u32 s57, s57, s58
    s_add_u32 s67, s57, s69
    s_lshl_b32 s57, s66, 2
    s_add_u32 s57, s57, 1
    s_mul_hi_u32 s58, s57, 858993460
    s_mul_i32 s59, s58, 5
    s_sub_u32 s57, s57, s59
    s_lshl_b32 s57, s57, 10
    s_mul_i32 s58, s58, s60
    s_add_u32 s57, s57, s58
    s_add_u32 s68, s57, s69
    s_lshl_b32 s57, s66, 2
    s_add_u32 s57, s57, 2
    s_mul_hi_u32 s58, s57, 858993460
    s_mul_i32 s59, s58, 5
    s_sub_u32 s57, s57, s59
    s_lshl_b32 s57, s57, 10
    s_mul_i32 s58, s58, s60
    s_add_u32 s57, s57, s58
    s_add_u32 s74, s57, s69
    s_lshl_b32 s57, s66, 2
    s_add_u32 s57, s57, 3
    s_mul_hi_u32 s58, s57, 858993460
    s_mul_i32 s59, s58, 5
    s_sub_u32 s57, s57, s59
    s_lshl_b32 s57, s57, 10
    s_mul_i32 s58, s58, s60
    s_add_u32 s57, s57, s58
    s_add_u32 s75, s57, s69
    s_mul_i32 s57, s65, 2560
    s_add_u32 s57, s57, 32768
    s_cmp_eq_u32 s71, 4
    s_cselect_b32 s57, s57, 1073741824
    s_branch Ld3_94_c
Ld3_94:
    s_mul_i32 s57, s66, 81920
    s_lshl_b32 s58, s65, 12
    s_add_u32 s57, s57, s58
    s_add_u32 s67, s57, 5177344
    s_add_u32 s68, s57, 5178368
    s_add_u32 s74, s57, 5179392
    s_add_u32 s75, s57, 5180416
    s_mul_i32 s57, s65, 6144
    s_add_u32 s57, s57, 98304
Ld3_94_c:
    s_lshl_b32 s58, s66, 8
    s_add_u32 s57, s57, s58
    s_waitcnt vmcnt(4)
    ds_write_b128 v32, v[80:83] offset:0
    ds_write_b128 v32, v[84:87] offset:1024
    ds_read_b64_tr_b16 v[208:209], v33 offset:0
    ds_read_b64_tr_b16 v[212:213], v33 offset:32
    ds_read_b64_tr_b16 v[216:217], v33 offset:64
    ds_read_b64_tr_b16 v[220:221], v33 offset:96
    ds_write_b128 v32, v[88:91] offset:0
    ds_write_b128 v32, v[92:95] offset:1024
    ds_read_b64_tr_b16 v[210:211], v33 offset:0
    ds_read_b64_tr_b16 v[214:215], v33 offset:32
    ds_read_b64_tr_b16 v[218:219], v33 offset:64
    ds_read_b64_tr_b16 v[222:223], v33 offset:96
    s_waitcnt lgkmcnt(0)
    buffer_store_dwordx4 v[208:211], v2, s[28:31], s67 offen sc1
    buffer_store_dwordx4 v[212:215], v2, s[28:31], s68 offen sc1
    buffer_store_dwordx4 v[216:219], v2, s[28:31], s74 offen sc1
    buffer_store_dwordx4 v[220:223], v2, s[28:31], s75 offen sc1
    v_mov_b32 v224, 0
    v_mov_b32 v225, 0
    v_mov_b32 v226, 0
    v_mov_b32 v227, 0
    v_dot2c_f32_bf16 v224, s72, v208
    v_dot2c_f32_bf16 v225, s72, v212
    v_dot2c_f32_bf16 v226, s72, v216
    v_dot2c_f32_bf16 v227, s72, v220
    v_dot2c_f32_bf16 v224, s72, v209
    v_dot2c_f32_bf16 v225, s72, v213
    v_dot2c_f32_bf16 v226, s72, v217
    v_dot2c_f32_bf16 v227, s72, v221
    v_dot2c_f32_bf16 v224, s72, v210
    v_dot2c_f32_bf16 v225, s72, v214
    v_dot2c_f32_bf16 v226, s72, v218
    v_dot2c_f32_bf16 v227, s72, v222
    v_dot2c_f32_bf16 v224, s72, v211
    v_dot2c_f32_bf16 v225, s72, v215
    v_dot2c_f32_bf16 v226, s72, v219
    v_dot2c_f32_bf16 v227, s72, v223
    s_nop 1
    v_permlane32_swap_b32 v224, v226
    v_permlane32_swap_b32 v225, v227
    v_add_f32 v224, v224, v226
    v_add_f32 v225, v225, v227
    s_nop 1
    v_permlane16_swap_b32 v224, v225
    v_add_f32 v224, v224, v225
    buffer_store_dword v224, v34, s[28:31], s57 offen sc1
    s_add_u32 s64, s63, 1536
    s_cmp_ge_u32 s64, 1680
    s_cbranch_scc1 Lpd_95_4
    s_mul_hi_u32 s66, s64, 214748365
    s_mul_i32 s57, s66, 20
    s_sub_u32 s65, s64, s57
    s_mul_hi_u32 s71, s66, 429496730
    s_min_u32 s71, s71, 6
    s_mul_i32 s57, s71, 10
    s_sub_u32 s66, s66, s57
    s_branch Lpd_95
Lpd_95_4:
    s_sub_u32 s57, s64, 1680
    s_mul_hi_u32 s66, s57, 89478486
    s_mul_i32 s58, s66, 48
    s_sub_u32 s65, s57, s58
    s_mov_b32 s71, 7
Lpd_95:
    s_cmp_eq_u32 s71, 6
    s_cbranch_scc1 Ld3_96
    s_mul_i32 s69, s71, 819200
    s_cmp_eq_u32 s71, 7
    s_cselect_b32 s69, 6881280, s69
    s_mov_b32 s60, 102400
    s_cselect_b32 s60, 245760, s60
    s_mul_i32 s57, s65, 5120
    s_add_u32 s69, s69, s57
    s_add_u32 s69, s69, 262144
    s_cmp_ge_u32 s64, 2160
    s_cselect_b32 s69, 1073741824, s69
    s_lshl_b32 s57, s66, 2
    s_add_u32 s57, s57, 0
    s_mul_hi_u32 s58, s57, 858993460
    s_mul_i32 s59, s58, 5
    s_sub_u32 s57, s57, s59
    s_lshl_b32 s57, s57, 10
    s_mul_i32 s58, s58, s60
    s_add_u32 s57, s57, s58
    s_add_u32 s67, s57, s69
    s_lshl_b32 s57, s66, 2
    s_add_u32 s57, s57, 1
    s_mul_hi_u32 s58, s57, 858993460
    s_mul_i32 s59, s58, 5
    s_sub_u32 s57, s57, s59
    s_lshl_b32 s57, s57, 10
    s_mul_i32 s58, s58, s60
    s_add_u32 s57, s57, s58
    s_add_u32 s68, s57, s69
    s_lshl_b32 s57, s66, 2
    s_add_u32 s57, s57, 2
    s_mul_hi_u32 s58, s57, 858993460
    s_mul_i32 s59, s58, 5
    s_sub_u32 s57, s57, s59
    s_lshl_b32 s57, s57, 10
    s_mul_i32 s58, s58, s60
    s_add_u32 s57, s57, s58
    s_add_u32 s74, s57, s69
    s_lshl_b32 s57, s66, 2
    s_add_u32 s57, s57, 3
    s_mul_hi_u32 s58, s57, 858993460
    s_mul_i32 s59, s58, 5
    s_sub_u32 s57, s57, s59
    s_lshl_b32 s57, s57, 10
    s_mul_i32 s58, s58, s60
    s_add_u32 s57, s57, s58
    s_add_u32 s75, s57, s69
    s_mul_i32 s57, s65, 2560
    s_add_u32 s57, s57, 32768
    s_cmp_eq_u32 s71, 4
    s_cselect_b32 s57, s57, 1073741824
    s_branch Ld3_96_c
Ld3_96:
    s_mul_i32 s57, s66, 81920
    s_lshl_b32 s58, s65, 12
    s_add_u32 s57, s57, s58
    s_add_u32 s67, s57, 5177344
    s_add_u32 s68, s57, 5178368
    s_add_u32 s74, s57, 5179392
    s_add_u32 s75, s57, 5180416
    s_mul_i32 s57, s65, 6144
    s_add_u32 s57, s57, 98304
Ld3_96_c:
    s_lshl_b32 s58, s66, 8
    s_add_u32 s57, s57, s58
    s_waitcnt vmcnt(5)
    ds_write_b128 v32, v[96:99] offset:0
    ds_write_b128 v32, v[100:103] offset:1024
    ds_read_b64_tr_b16 v[192:193], v33 offset:0
    ds_read_b64_tr_b16 v[196:197], v33 offset:32
    ds_read_b64_tr_b16 v[200:201], v33 offset:64
    ds_read_b64_tr_b16 v[204:205], v33 offset:96
    ds_write_b128 v32, v[104:107] offset:0
    ds_write_b128 v32, v[108:111] offset:1024
    ds_read_b64_tr_b16 v[194:195], v33 offset:0
    ds_read_b64_tr_b16 v[198:199], v33 offset:32
    ds_read_b64_tr_b16 v[202:203], v33 offset:64
    ds_read_b64_tr_b16 v[206:207], v33 offset:96
    s_waitcnt lgkmcnt(0)
    buffer_store_dwordx4 v[192:195], v2, s[28:31], s67 offen sc1
    buffer_store_dwordx4 v[196:199], v2, s[28:31], s68 offen sc1
    buffer_store_dwordx4 v[200:203], v2, s[28:31], s74 offen sc1
    buffer_store_dwordx4 v[204:207], v2, s[28:31], s75 offen sc1
    v_mov_b32 v224, 0
    v_mov_b32 v225, 0
    v_mov_b32 v226, 0
    v_mov_b32 v227, 0
    v_dot2c_f32_bf16 v224, s72, v192
    v_dot2c_f32_bf16 v225, s72, v196
    v_dot2c_f32_bf16 v226, s72, v200
    v_dot2c_f32_bf16 v227, s72, v204
    v_dot2c_f32_bf16 v224, s72, v193
    v_dot2c_f32_bf16 v225, s72, v197
    v_dot2c_f32_bf16 v226, s72, v201
    v_dot2c_f32_bf16 v227, s72, v205
    v_dot2c_f32_bf16 v224, s72, v194
    v_dot2c_f32_bf16 v225, s72, v198
    v_dot2c_f32_bf16 v226, s72, v202
    v_dot2c_f32_bf16 v227, s72, v206
    v_dot2c_f32_bf16 v224, s72, v195
    v_dot2c_f32_bf16 v225, s72, v199
    v_dot2c_f32_bf16 v226, s72, v203
    v_dot2c_f32_bf16 v227, s72, v207
    s_nop 1
    v_permlane32_swap_b32 v224, v226
    v_permlane32_swap_b32 v225, v227
    v_add_f32 v224, v224, v226
    v_add_f32 v225, v225, v227
    s_nop 1
    v_permlane16_swap_b32 v224, v225
    v_add_f32 v224, v224, v225
    buffer_store_dword v224, v34, s[28:31], s57 offen sc1
    s_mul_i32 s66, s50, 12288
    s_mul_i32 s67, s50, 10240
    s_mul_i32 s64, s43, 102400
    s_mul_i32 s65, s43, 245760
    s_add_u32 s58, s42, 0
    s_sub_u32 s57, s58, 5
    s_cmp_ge_u32 s58, 5
    s_cselect_b32 s58, s57, s58
    s_mul_i32 s58, s58, 20480
    s_add_u32 s58, s58, s64
    s_add_u32 s8, s58, s67
    s_add_u32 s58, s42, 1
    s_sub_u32 s57, s58, 5
    s_cmp_ge_u32 s58, 5
    s_cselect_b32 s58, s57, s58
    s_mul_i32 s58, s58, 20480
    s_add_u32 s58, s58, s64
    s_add_u32 s9, s58, s67
    s_add_u32 s58, s42, 2
    s_sub_u32 s57, s58, 5
    s_cmp_ge_u32 s58, 5
    s_cselect_b32 s58, s57, s58
    s_mul_i32 s58, s58, 20480
    s_add_u32 s58, s58, s64
    s_add_u32 s10, s58, s67
    s_add_u32 s58, s42, 3
    s_sub_u32 s57, s58, 5
    s_cmp_ge_u32 s58, 5
    s_cselect_b32 s58, s57, s58
    s_mul_i32 s58, s58, 20480
    s_add_u32 s58, s58, s64
    s_add_u32 s11, s58, s67
    s_add_u32 s58, s42, 4
    s_sub_u32 s57, s58, 5
    s_cmp_ge_u32 s58, 5
    s_cselect_b32 s58, s57, s58
    s_mul_i32 s58, s58, 20480
    s_add_u32 s58, s58, s64
    s_add_u32 s12, s58, s67
    s_mul_i32 s58, s51, 25600
    s_add_u32 s58, s58, s64
    s_add_u32 s13, s58, s66
    s_mul_i32 s58, s51, 20480
    s_add_u32 s58, s58, s65
    s_add_u32 s68, s58, s67
    s_mul_i32 s58, s52, 25600
    s_add_u32 s58, s58, s64
    s_add_u32 s14, s58, s66
    s_mul_i32 s58, s52, 20480
    s_add_u32 s58, s58, s65
    s_add_u32 s69, s58, s67
    s_mul_i32 s58, s53, 25600
    s_add_u32 s58, s58, s64
    s_add_u32 s15, s58, s66
    s_mul_i32 s58, s53, 20480
    s_add_u32 s58, s58, s65
    s_add_u32 s70, s58, s67
    s_mul_i32 s58, s54, 25600
    s_add_u32 s58, s58, s64
    s_add_u32 s16, s58, s66
    s_mul_i32 s58, s54, 20480
    s_add_u32 s58, s58, s65
    s_add_u32 s71, s58, s67
    s_getpc_b64 s[18:19]
L_pc2:
    s_add_u32 s18, s18, L_table-L_pc2
    s_addc_u32 s19, s19, 0
    s_lshl_b32 s17, s50, 8
    s_add_u32 s17, s17, 155008
    v_mov_b32 v15, 0
    s_setprio 2
    s_branch Lf_97
Lf_97_ok:
    s_add_u32 m0, s67, 0
    s_add_u32 s57, s8, 262144
    buffer_load_dwordx4 v2, s[28:31], s57 offen offset:0 sc1 lds
    buffer_load_dwordx4 v2, s[28:31], s57 offen offset:1024 sc1 lds
    buffer_load_dwordx4 v2, s[28:31], s57 offen offset:2048 sc1 lds
    buffer_load_dwordx4 v2, s[28:31], s57 offen offset:3072 sc1 lds
    s_add_u32 m0, s67, 4096
    s_add_u32 s57, s8, 266240
    buffer_load_dwordx4 v2, s[28:31], s57 offen offset:0 sc1 lds
    buffer_load_dwordx4 v2, s[28:31], s57 offen offset:1024 sc1 lds
    buffer_load_dwordx4 v2, s[28:31], s57 offen offset:2048 sc1 lds
    buffer_load_dwordx4 v2, s[28:31], s57 offen offset:3072 sc1 lds
    s_add_u32 m0, s67, 8192
    s_add_u32 s57, s8, 270336
    buffer_load_dwordx4 v2, s[28:31], s57 offen offset:0 sc1 lds
    buffer_load_dwordx4 v2, s[28:31], s57 offen offset:1024 sc1 lds
    s_sub_u32 m0, s17, 8
    s_nop 0
    global_load_lds_dword v15, s[18:19] offset:8
    s_add_u32 m0, s67, 20480
    s_add_u32 s57, s9, 262144
    buffer_load_dwordx4 v2, s[28:31], s57 offen offset:0 sc1 lds
    buffer_load_dwordx4 v2, s[28:31], s57 offen offset:1024 sc1 lds
    buffer_load_dwordx4 v2, s[28:31], s57 offen offset:2048 sc1 lds
    buffer_load_dwordx4 v2, s[28:31], s57 offen offset:3072 sc1 lds
    s_add_u32 m0, s67, 24576
    s_add_u32 s57, s9, 266240
    buffer_load_dwordx4 v2, s[28:31], s57 offen offset:0 sc1 lds
    buffer_load_dwordx4 v2, s[28:31], s57 offen offset:1024 sc1 lds
    buffer_load_dwordx4 v2, s[28:31], s57 offen offset:2048 sc1 lds
    buffer_load_dwordx4 v2, s[28:31], s57 offen offset:3072 sc1 lds
    s_add_u32 m0, s67, 28672
    s_add_u32 s57, s9, 270336
    buffer_load_dwordx4 v2, s[28:31], s57 offen offset:0 sc1 lds
    buffer_load_dwordx4 v2, s[28:31], s57 offen offset:1024 sc1 lds
    s_sub_u32 m0, s17, 12
    s_nop 0
    global_load_lds_dword v15, s[18:19] offset:12
    s_waitcnt vmcnt(24)
    s_add_u32 m0, s67, 40960
    s_add_u32 s57, s10, 262144
    buffer_load_dwordx4 v2, s[28:31], s57 offen offset:0 sc1 lds
    buffer_load_dwordx4 v2, s[28:31], s57 offen offset:1024 sc1 lds
    buffer_load_dwordx4 v2, s[28:31], s57 offen offset:2048 sc1 lds
    buffer_load_dwordx4 v2, s[28:31], s57 offen offset:3072 sc1 lds
    s_add_u32 m0, s67, 45056
    s_add_u32 s57, s10, 266240
    buffer_load_dwordx4 v2, s[28:31], s57 offen offset:0 sc1 lds
    buffer_load_dwordx4 v2, s[28:31], s57 offen offset:1024 sc1 lds
    ds_read_b32 v14, v12
    buffer_load_dwordx4 v2, s[28:31], s57 offen offset:2048 sc1 lds
    buffer_load_dwordx4 v2, s[28:31], s57 offen offset:3072 sc1 lds
    s_add_u32 m0, s67, 49152
    s_add_u32 s57, s10, 270336
    buffer_load_dwordx4 v2, s[28:31], s57 offen offset:0 sc1 lds
    buffer_load_dwordx4 v2, s[28:31], s57 offen offset:1024 sc1 lds
    s_sub_u32 m0, s17, 16
    s_nop 0
    global_load_lds_dword v15, s[18:19] offset:16
    s_waitcnt vmcnt(24)
    s_lshl_b32 s57, s63, 5
    s_add_u32 s57, s57, 9142272
    s_mov_b64 exec, 1
    buffer_store_dwordx2 v[38:39], v35, s[28:31], s57 offen sc1
    s_add_u32 s57, s57, 24576
    buffer_store_dwordx2 v[38:39], v35, s[28:31], s57 offen sc1
    s_mov_b64 exec, -1
    s_waitcnt lgkmcnt(0)
    v_cmp_gt_u32 vcc, 1, v14
    s_cbranch_vccnz Lf_98
Lf_98_ok:
    s_add_u32 m0, s67, 61440
    s_add_u32 s57, s11, 262144
    buffer_load_dwordx4 v2, s[28:31], s57 offen offset:0 sc1 lds
    buffer_load_dwordx4 v2, s[28:31], s57 offen offset:1024 sc1 lds
    buffer_load_dwordx4 v2, s[28:31], s57 offen offset:2048 sc1 lds
    buffer_load_dwordx4 v2, s[28:31], s57 offen offset:3072 sc1 lds
    s_add_u32 m0, s67, 65536
    s_add_u32 s57, s11, 266240
    buffer_load_dwordx4 v2, s[28:31], s57 offen offset:0 sc1 lds
    buffer_load_dwordx4 v2, s[28:31], s57 offen offset:1024 sc1 lds
    buffer_load_dwordx4 v2, s[28:31], s57 offen offset:2048 sc1 lds
    buffer_load_dwordx4 v2, s[28:31], s57 offen offset:3072 sc1 lds
    s_add_u32 m0, s67, 69632
    s_add_u32 s57, s11, 270336
    buffer_load_dwordx4 v2, s[28:31], s57 offen offset:0 sc1 lds
    buffer_load_dwordx4 v2, s[28:31], s57 offen offset:1024 sc1 lds
    s_sub_u32 m0, s17, 20
    s_nop 0
    global_load_lds_dword v15, s[18:19] offset:20
    s_waitcnt vmcnt(24)
    s_add_u32 m0, s67, 81920
    s_add_u32 s57, s12, 262144
    buffer_load_dwordx4 v2, s[28:31], s57 offen offset:0 sc1 lds
    buffer_load_dwordx4 v2, s[28:31], s57 offen offset:1024 sc1 lds
    buffer_load_dwordx4 v2, s[28:31], s57 offen offset:2048 sc1 lds
    buffer_load_dwordx4 v2, s[28:31], s57 offen offset:3072 sc1 lds
    s_add_u32 m0, s67, 86016
    s_add_u32 s57, s12, 266240
    buffer_load_dwordx4 v2, s[28:31], s57 offen offset:0 sc1 lds
    buffer_load_dwordx4 v2, s[28:31], s57 offen offset:1024 sc1 lds
    buffer_load_dwordx4 v2, s[28:31], s57 offen offset:2048 sc1 lds
    buffer_load_dwordx4 v2, s[28:31], s57 offen offset:3072 sc1 lds
    s_add_u32 m0, s67, 90112
    s_add_u32 s57, s12, 270336
    buffer_load_dwordx4 v2, s[28:31], s57 offen offset:0 sc1 lds
    buffer_load_dwordx4 v2, s[28:31], s57 offen offset:1024 sc1 lds
    s_sub_u32 m0, s17, 24
    s_nop 0
    global_load_lds_dword v15, s[18:19] offset:24
    s_waitcnt vmcnt(24)
    s_add_u32 m0, s67, 102400
    s_add_u32 s57, s8, 1081344
    buffer_load_dwordx4 v2, s[28:31], s57 offen offset:0 sc1 lds
    buffer_load_dwordx4 v2, s[28:31], s57 offen offset:1024 sc1 lds
    buffer_load_dwordx4 v2, s[28:31], s57 offen offset:2048 sc1 lds
    buffer_load_dwordx4 v2, s[28:31], s57 offen offset:3072 sc1 lds
    s_add_u32 m0, s67, 106496
    s_add_u32 s57, s8, 1085440
    buffer_load_dwordx4 v2, s[28:31], s57 offen offset:0 sc1 lds
    buffer_load_dwordx4 v2, s[28:31], s57 offen offset:1024 sc1 lds
    ds_read_b32 v14, v12
    buffer_load_dwordx4 v2, s[28:31], s57 offen offset:2048 sc1 lds
    buffer_load_dwordx4 v2, s[28:31], s57 offen offset:3072 sc1 lds
    s_add_u32 m0, s67, 110592
    s_add_u32 s57, s8, 1089536
    buffer_load_dwordx4 v2, s[28:31], s57 offen offset:0 sc1 lds
    buffer_load_dwordx4 v2, s[28:31], s57 offen offset:1024 sc1 lds
    s_sub_u32 m0, s17, 28
    s_nop 0
    global_load_lds_dword v15, s[18:19] offset:28
    s_waitcnt vmcnt(24)
    s_waitcnt lgkmcnt(0)
    v_cmp_gt_u32 vcc, 2, v14
    s_cbranch_vccnz Lf_99
Lf_99_ok:
    s_add_u32 m0, s67, 0
    s_add_u32 s57, s9, 1081344
    buffer_load_dwordx4 v2, s[28:31], s57 offen offset:0 sc1 lds
    buffer_load_dwordx4 v2, s[28:31], s57 offen offset:1024 sc1 lds
    buffer_load_dwordx4 v2, s[28:31], s57 offen offset:2048 sc1 lds
    buffer_load_dwordx4 v2, s[28:31], s57 offen offset:3072 sc1 lds
    s_add_u32 m0, s67, 4096
    s_add_u32 s57, s9, 1085440
    buffer_load_dwordx4 v2, s[28:31], s57 offen offset:0 sc1 lds
    buffer_load_dwordx4 v2, s[28:31], s57 offen offset:1024 sc1 lds
    ds_read_b32 v14, v12
    buffer_load_dwordx4 v2, s[28:31], s57 offen offset:2048 sc1 lds
    buffer_load_dwordx4 v2, s[28:31], s57 offen offset:3072 sc1 lds
    s_add_u32 m0, s67, 8192
    s_add_u32 s57, s9, 1089536
    buffer_load_dwordx4 v2, s[28:31], s57 offen offset:0 sc1 lds
    buffer_load_dwordx4 v2, s[28:31], s57 offen offset:1024 sc1 lds
    s_sub_u32 m0, s17, 32
    s_nop 0
    global_load_lds_dword v15, s[18:19] offset:32
    s_waitcnt vmcnt(24)
    s_waitcnt lgkmcnt(0)
    v_cmp_gt_u32 vcc, 4, v14
    s_cbranch_vccnz Lf_100
Lf_100_ok:
    s_add_u32 m0, s67, 20480
    s_add_u32 s57, s10, 1081344
    buffer_load_dwordx4 v2, s[28:31], s57 offen offset:0 sc1 lds
    buffer_load_dwordx4 v2, s[28:31], s57 offen offset:1024 sc1 lds
    buffer_load_dwordx4 v2, s[28:31], s57 offen offset:2048 sc1 lds
    buffer_load_dwordx4 v2, s[28:31], s57 offen offset:3072 sc1 lds
    s_add_u32 m0, s67, 24576
    s_add_u32 s57, s10, 1085440
    buffer_load_dwordx4 v2, s[28:31], s57 offen offset:0 sc1 lds
    buffer_load_dwordx4 v2, s[28:31], s57 offen offset:1024 sc1 lds
    buffer_load_dwordx4 v2, s[28:31], s57 offen offset:2048 sc1 lds
    buffer_load_dwordx4 v2, s[28:31], s57 offen offset:3072 sc1 lds
    s_add_u32 m0, s67, 28672
    s_add_u32 s57, s10, 1089536
    buffer_load_dwordx4 v2, s[28:31], s57 offen offset:0 sc1 lds
    buffer_load_dwordx4 v2, s[28:31], s57 offen offset:1024 sc1 lds
    s_sub_u32 m0, s17, 36
    s_nop 0
    global_load_lds_dword v15, s[18:19] offset:36
    s_waitcnt vmcnt(24)
    s_add_u32 m0, s67, 40960
    s_add_u32 s57, s11, 1081344
    buffer_load_dwordx4 v2, s[28:31], s57 offen offset:0 sc1 lds
    buffer_load_dwordx4 v2, s[28:31], s57 offen offset:1024 sc1 lds
    buffer_load_dwordx4 v2, s[28:31], s57 offen offset:2048 sc1 lds
    buffer_load_dwordx4 v2, s[28:31], s57 offen offset:3072 sc1 lds
    s_add_u32 m0, s67, 45056
    s_add_u32 s57, s11, 1085440
    buffer_load_dwordx4 v2, s[28:31], s57 offen offset:0 sc1 lds
    buffer_load_dwordx4 v2, s[28:31], s57 offen offset:1024 sc1 lds
    ds_read_b32 v14, v12
    buffer_load_dwordx4 v2, s[28:31], s57 offen offset:2048 sc1 lds
    buffer_load_dwordx4 v2, s[28:31], s57 offen offset:3072 sc1 lds
    s_add_u32 m0, s67, 49152
    s_add_u32 s57, s11, 1089536
    buffer_load_dwordx4 v2, s[28:31], s57 offen offset:0 sc1 lds
    buffer_load_dwordx4 v2, s[28:31], s57 offen offset:1024 sc1 lds
    s_sub_u32 m0, s17, 40
    s_nop 0
    global_load_lds_dword v15, s[18:19] offset:40
    s_waitcnt vmcnt(24)
    s_waitcnt lgkmcnt(0)
    v_cmp_gt_u32 vcc, 6, v14
    s_cbranch_vccnz Lf_101
Lf_101_ok:
    s_add_u32 m0, s67, 61440
    s_add_u32 s57, s12, 1081344
    buffer_load_dwordx4 v2, s[28:31], s57 offen offset:0 sc1 lds
    buffer_load_dwordx4 v2, s[28:31], s57 offen offset:1024 sc1 lds
    buffer_load_dwordx4 v2, s[28:31], s57 offen offset:2048 sc1 lds
    buffer_load_dwordx4 v2, s[28:31], s57 offen offset:3072 sc1 lds
    s_add_u32 m0, s67, 65536
    s_add_u32 s57, s12, 1085440
    buffer_load_dwordx4 v2, s[28:31], s57 offen offset:0 sc1 lds
    buffer_load_dwordx4 v2, s[28:31], s57 offen offset:1024 sc1 lds
    buffer_load_dwordx4 v2, s[28:31], s57 offen offset:2048 sc1 lds
    buffer_load_dwordx4 v2, s[28:31], s57 offen offset:3072 sc1 lds
    s_add_u32 m0, s67, 69632
    s_add_u32 s57, s12, 1089536
    buffer_load_dwordx4 v2, s[28:31], s57 offen offset:0 sc1 lds
    buffer_load_dwordx4 v2, s[28:31], s57 offen offset:1024 sc1 lds
    s_sub_u32 m0, s17, 44
    s_nop 0
    global_load_lds_dword v15, s[18:19] offset:44
    s_waitcnt vmcnt(24)
    s_add_u32 m0, s67, 81920
    s_add_u32 s57, s8, 1900544
    buffer_load_dwordx4 v2, s[28:31], s57 offen offset:0 sc1 lds
    buffer_load_dwordx4 v2, s[28:31], s57 offen offset:1024 sc1 lds
    buffer_load_dwordx4 v2, s[28:31], s57 offen offset:2048 sc1 lds
    buffer_load_dwordx4 v2, s[28:31], s57 offen offset:3072 sc1 lds
    s_add_u32 m0, s67, 86016
    s_add_u32 s57, s8, 1904640
    buffer_load_dwordx4 v2, s[28:31], s57 offen offset:0 sc1 lds
    buffer_load_dwordx4 v2, s[28:31], s57 offen offset:1024 sc1 lds
    ds_read_b32 v14, v12
    buffer_load_dwordx4 v2, s[28:31], s57 offen offset:2048 sc1 lds
    buffer_load_dwordx4 v2, s[28:31], s57 offen offset:3072 sc1 lds
    s_add_u32 m0, s67, 90112
    s_add_u32 s57, s8, 1908736
    buffer_load_dwordx4 v2, s[28:31], s57 offen offset:0 sc1 lds
    buffer_load_dwordx4 v2, s[28:31], s57 offen offset:1024 sc1 lds
    s_sub_u32 m0, s17, 48
    s_nop 0
    global_load_lds_dword v15, s[18:19] offset:48
    s_waitcnt vmcnt(24)
    s_waitcnt lgkmcnt(0)
    v_cmp_gt_u32 vcc, 8, v14
    s_cbranch_vccnz Lf_102
Lf_102_ok:
    s_add_u32 m0, s67, 102400
    s_add_u32 s57, s9, 1900544
    buffer_load_dwordx4 v2, s[28:31], s57 offen offset:0 sc1 lds
    buffer_load_dwordx4 v2, s[28:31], s57 offen offset:1024 sc1 lds
    buffer_load_dwordx4 v2, s[28:31], s57 offen offset:2048 sc1 lds
    buffer_load_dwordx4 v2, s[28:31], s57 offen offset:3072 sc1 lds
    s_add_u32 m0, s67, 106496
    s_add_u32 s57, s9, 1904640
    buffer_load_dwordx4 v2, s[28:31], s57 offen offset:0 sc1 lds
    buffer_load_dwordx4 v2, s[28:31], s57 offen offset:1024 sc1 lds
    buffer_load_dwordx4 v2, s[28:31], s57 offen offset:2048 sc1 lds
    buffer_load_dwordx4 v2, s[28:31], s57 offen offset:3072 sc1 lds
    s_add_u32 m0, s67, 110592
    s_add_u32 s57, s9, 1908736
    buffer_load_dwordx4 v2, s[28:31], s57 offen offset:0 sc1 lds
    buffer_load_dwordx4 v2, s[28:31], s57 offen offset:1024 sc1 lds
    s_sub_u32 m0, s17, 52
    s_nop 0
    global_load_lds_dword v15, s[18:19] offset:52
    s_waitcnt vmcnt(24)
    s_add_u32 m0, s67, 0
    s_add_u32 s57, s10, 1900544
    buffer_load_dwordx4 v2, s[28:31], s57 offen offset:0 sc1 lds
    buffer_load_dwordx4 v2, s[28:31], s57 offen offset:1024 sc1 lds
    buffer_load_dwordx4 v2, s[28:31], s57 offen offset:2048 sc1 lds
    buffer_load_dwordx4 v2, s[28:31], s57 offen offset:3072 sc1 lds
    s_add_u32 m0, s67, 4096
    s_add_u32 s57, s10, 1904640
    buffer_load_dwordx4 v2, s[28:31], s57 offen offset:0 sc1 lds
    buffer_load_dwordx4 v2, s[28:31], s57 offen offset:1024 sc1 lds
    ds_read_b32 v14, v12
    buffer_load_dwordx4 v2, s[28:31], s57 offen offset:2048 sc1 lds
    buffer_load_dwordx4 v2, s[28:31], s57 offen offset:3072 sc1 lds
    s_add_u32 m0, s67, 8192
    s_add_u32 s57, s10, 1908736
    buffer_load_dwordx4 v2, s[28:31], s57 offen offset:0 sc1 lds
    buffer_load_dwordx4 v2, s[28:31], s57 offen offset:1024 sc1 lds
    s_sub_u32 m0, s17, 56
    s_nop 0
    global_load_lds_dword v15, s[18:19] offset:56
    s_waitcnt vmcnt(24)
    s_waitcnt lgkmcnt(0)
    v_cmp_gt_u32 vcc, 10, v14
    s_cbranch_vccnz Lf_103
Lf_103_ok:
    s_add_u32 m0, s67, 20480
    s_add_u32 s57, s11, 1900544
    buffer_load_dwordx4 v2, s[28:31], s57 offen offset:0 sc1 lds
    buffer_load_dwordx4 v2, s[28:31], s57 offen offset:1024 sc1 lds
    buffer_load_dwordx4 v2, s[28:31], s57 offen offset:2048 sc1 lds
    buffer_load_dwordx4 v2, s[28:31], s57 offen offset:3072 sc1 lds
    s_add_u32 m0, s67, 24576
    s_add_u32 s57, s11, 1904640
    buffer_load_dwordx4 v2, s[28:31], s57 offen offset:0 sc1 lds
    buffer_load_dwordx4 v2, s[28:31], s57 offen offset:1024 sc1 lds
    buffer_load_dwordx4 v2, s[28:31], s57 offen offset:2048 sc1 lds
    buffer_load_dwordx4 v2, s[28:31], s57 offen offset:3072 sc1 lds
    s_add_u32 m0, s67, 28672
    s_add_u32 s57, s11, 1908736
    buffer_load_dwordx4 v2, s[28:31], s57 offen offset:0 sc1 lds
    buffer_load_dwordx4 v2, s[28:31], s57 offen offset:1024 sc1 lds
    s_sub_u32 m0, s17, 60
    s_nop 0
    global_load_lds_dword v15, s[18:19] offset:60
    s_waitcnt vmcnt(24)
    s_add_u32 m0, s67, 40960
    s_add_u32 s57, s12, 1900544
    buffer_load_dwordx4 v2, s[28:31], s57 offen offset:0 sc1 lds
    buffer_load_dwordx4 v2, s[28:31], s57 offen offset:1024 sc1 lds
    buffer_load_dwordx4 v2, s[28:31], s57 offen offset:2048 sc1 lds
    buffer_load_dwordx4 v2, s[28:31], s57 offen offset:3072 sc1 lds
    s_add_u32 m0, s67, 45056
    s_add_u32 s57, s12, 1904640
    buffer_load_dwordx4 v2, s[28:31], s57 offen offset:0 sc1 lds
    buffer_load_dwordx4 v2, s[28:31], s57 offen offset:1024 sc1 lds
    ds_read_b32 v14, v12
    buffer_load_dwordx4 v2, s[28:31], s57 offen offset:2048 sc1 lds
    buffer_load_dwordx4 v2, s[28:31], s57 offen offset:3072 sc1 lds
    s_add_u32 m0, s67, 49152
    s_add_u32 s57, s12, 1908736
    buffer_load_dwordx4 v2, s[28:31], s57 offen offset:0 sc1 lds
    buffer_load_dwordx4 v2, s[28:31], s57 offen offset:1024 sc1 lds
    s_sub_u32 m0, s17, 64
    s_nop 0
    global_load_lds_dword v15, s[18:19] offset:64
    s_waitcnt vmcnt(24)
    s_waitcnt lgkmcnt(0)
    v_cmp_gt_u32 vcc, 12, v14
    s_cbranch_vccnz Lf_104
Lf_104_ok:
    s_branch Lf_105
Lf_105_ok:
    s_add_u32 m0, s66, 76800
    s_add_u32 s57, s13, 2719744
    buffer_load_dwordx4 v2, s[28:31], s57 offen offset:0 sc1 lds
    buffer_load_dwordx4 v2, s[28:31], s57 offen offset:1024 sc1 lds
    buffer_load_dwordx4 v2, s[28:31], s57 offen offset:2048 sc1 lds
    buffer_load_dwordx4 v2, s[28:31], s57 offen offset:3072 sc1 lds
    s_add_u32 m0, s66, 80896
    s_add_u32 s57, s13, 2723840
    buffer_load_dwordx4 v2, s[28:31], s57 offen offset:0 sc1 lds
    buffer_load_dwordx4 v2, s[28:31], s57 offen offset:1024 sc1 lds
    buffer_load_dwordx4 v2, s[28:31], s57 offen offset:2048 sc1 lds
    buffer_load_dwordx4 v2, s[28:31], s57 offen offset:3072 sc1 lds
    s_add_u32 m0, s66, 84992
    s_add_u32 s57, s13, 2727936
    buffer_load_dwordx4 v2, s[28:31], s57 offen offset:0 sc1 lds
    ds_read_b32 v14, v12
    buffer_load_dwordx4 v2, s[28:31], s57 offen offset:1024 sc1 lds
    buffer_load_dwordx4 v2, s[28:31], s57 offen offset:2048 sc1 lds
    buffer_load_dwordx4 v2, s[28:31], s57 offen offset:3072 sc1 lds
    s_add_u32 m0, s66, 89088
    s_add_u32 s57, s13, 2732032
    buffer_load_dwordx4 v2, s[28:31], s57 offen offset:0 sc1 lds
    s_sub_u32 m0, s17, 72
    s_nop 0
    global_load_lds_dword v15, s[18:19] offset:72
    s_waitcnt vmcnt(24)
    s_waitcnt lgkmcnt(0)
    v_cmp_gt_u32 vcc, 14, v14
    s_cbranch_vccnz Lf_106
Lf_106_ok:
    s_add_u32 m0, s66, 102400
    s_add_u32 s57, s14, 2719744
    buffer_load_dwordx4 v2, s[28:31], s57 offen offset:0 sc1 lds
    buffer_load_dwordx4 v2, s[28:31], s57 offen offset:1024 sc1 lds
    buffer_load_dwordx4 v2, s[28:31], s57 offen offset:2048 sc1 lds
    buffer_load_dwordx4 v2, s[28:31], s57 offen offset:3072 sc1 lds
    s_add_u32 m0, s66, 106496
    s_add_u32 s57, s14, 2723840
    buffer_load_dwordx4 v2, s[28:31], s57 offen offset:0 sc1 lds
    buffer_load_dwordx4 v2, s[28:31], s57 offen offset:1024 sc1 lds
    buffer_load_dwordx4 v2, s[28:31], s57 offen offset:2048 sc1 lds
    buffer_load_dwordx4 v2, s[28:31], s57 offen offset:3072 sc1 lds
    s_add_u32 m0, s66, 110592
    s_add_u32 s57, s14, 2727936
    buffer_load_dwordx4 v2, s[28:31], s57 offen offset:0 sc1 lds
    ds_read_b32 v14, v12
    buffer_load_dwordx4 v2, s[28:31], s57 offen offset:1024 sc1 lds
    buffer_load_dwordx4 v2, s[28:31], s57 offen offset:2048 sc1 lds
    buffer_load_dwordx4 v2, s[28:31], s57 offen offset:3072 sc1 lds
    s_add_u32 m0, s66, 114688
    s_add_u32 s57, s14, 2732032
    buffer_load_dwordx4 v2, s[28:31], s57 offen offset:0 sc1 lds
    s_sub_u32 m0, s17, 76
    s_nop 0
    global_load_lds_dword v15, s[18:19] offset:76
    s_waitcnt vmcnt(24)
    s_waitcnt lgkmcnt(0)
    v_cmp_gt_u32 vcc, 16, v14
    s_cbranch_vccnz Lf_107
Lf_107_ok:
    s_add_u32 m0, s66, 0
    s_add_u32 s57, s15, 2719744
    buffer_load_dwordx4 v2, s[28:31], s57 offen offset:0 sc1 lds
    buffer_load_dwordx4 v2, s[28:31], s57 offen offset:1024 sc1 lds
    buffer_load_dwordx4 v2, s[28:31], s57 offen offset:2048 sc1 lds
    buffer_load_dwordx4 v2, s[28:31], s57 offen offset:3072 sc1 lds
    s_add_u32 m0, s66, 4096
    s_add_u32 s57, s15, 2723840
    buffer_load_dwordx4 v2, s[28:31], s57 offen offset:0 sc1 lds
    buffer_load_dwordx4 v2, s[28:31], s57 offen offset:1024 sc1 lds
    buffer_load_dwordx4 v2, s[28:31], s57 offen offset:2048 sc1 lds
    buffer_load_dwordx4 v2, s[28:31], s57 offen offset:3072 sc1 lds
    s_add_u32 m0, s66, 8192
    s_add_u32 s57, s15, 2727936
    buffer_load_dwordx4 v2, s[28:31], s57 offen offset:0 sc1 lds
    buffer_load_dwordx4 v2, s[28:31], s57 offen offset:1024 sc1 lds
    buffer_load_dwordx4 v2, s[28:31], s57 offen offset:2048 sc1 lds
    buffer_load_dwordx4 v2, s[28:31], s57 offen offset:3072 sc1 lds
    s_add_u32 m0, s66, 12288
    s_add_u32 s57, s15, 2732032
    buffer_load_dwordx4 v2, s[28:31], s57 offen offset:0 sc1 lds
    s_sub_u32 m0, s17, 80
    s_nop 0
    global_load_lds_dword v15, s[18:19] offset:80
    s_waitcnt vmcnt(24)
    s_add_u32 m0, s66, 25600
    s_add_u32 s57, s16, 2719744
    buffer_load_dwordx4 v2, s[28:31], s57 offen offset:0 sc1 lds
    buffer_load_dwordx4 v2, s[28:31], s57 offen offset:1024 sc1 lds
    buffer_load_dwordx4 v2, s[28:31], s57 offen offset:2048 sc1 lds
    buffer_load_dwordx4 v2, s[28:31], s57 offen offset:3072 sc1 lds
    s_add_u32 m0, s66, 29696
    s_add_u32 s57, s16, 2723840
    buffer_load_dwordx4 v2, s[28:31], s57 offen offset:0 sc1 lds
    buffer_load_dwordx4 v2, s[28:31], s57 offen offset:1024 sc1 lds
    buffer_load_dwordx4 v2, s[28:31], s57 offen offset:2048 sc1 lds
    buffer_load_dwordx4 v2, s[28:31], s57 offen offset:3072 sc1 lds
    s_add_u32 m0, s66, 33792
    s_add_u32 s57, s16, 2727936
    buffer_load_dwordx4 v2, s[28:31], s57 offen offset:0 sc1 lds
    buffer_load_dwordx4 v2, s[28:31], s57 offen offset:1024 sc1 lds
    buffer_load_dwordx4 v2, s[28:31], s57 offen offset:2048 sc1 lds
    buffer_load_dwordx4 v2, s[28:31], s57 offen offset:3072 sc1 lds
    s_add_u32 m0, s66, 37888
    s_add_u32 s57, s16, 2732032
    buffer_load_dwordx4 v2, s[28:31], s57 offen offset:0 sc1 lds
    s_sub_u32 m0, s17, 84
    s_nop 0
    global_load_lds_dword v15, s[18:19] offset:84
    s_waitcnt vmcnt(24)
    s_add_u32 m0, s66, 51200
    s_add_u32 s57, s13, 3538944
    buffer_load_dwordx4 v2, s[28:31], s57 offen offset:0 sc1 lds
    buffer_load_dwordx4 v2, s[28:31], s57 offen offset:1024 sc1 lds
    buffer_load_dwordx4 v2, s[28:31], s57 offen offset:2048 sc1 lds
    buffer_load_dwordx4 v2, s[28:31], s57 offen offset:3072 sc1 lds
    s_waitcnt vmcnt(8)
    s_add_u32 m0, s66, 55296
    s_add_u32 s57, s13, 3543040
    buffer_load_dwordx4 v2, s[28:31], s57 offen offset:0 sc1 lds
    buffer_load_dwordx4 v2, s[28:31], s57 offen offset:1024 sc1 lds
    buffer_load_dwordx4 v2, s[28:31], s57 offen offset:2048 sc1 lds
    buffer_load_dwordx4 v2, s[28:31], s57 offen offset:3072 sc1 lds
    s_waitcnt vmcnt(8)
    s_add_u32 m0, s66, 59392
    s_add_u32 s57, s13, 3547136
    buffer_load_dwordx4 v2, s[28:31], s57 offen offset:0 sc1 lds
    ds_read_b32 v14, v12
    buffer_load_dwordx4 v2, s[28:31], s57 offen offset:1024 sc1 lds
    buffer_load_dwordx4 v2, s[28:31], s57 offen offset:2048 sc1 lds
    buffer_load_dwordx4 v2, s[28:31], s57 offen offset:3072 sc1 lds
    s_waitcnt vmcnt(8)
    s_add_u32 m0, s66, 63488
    s_add_u32 s57, s13, 3551232
    buffer_load_dwordx4 v2, s[28:31], s57 offen offset:0 sc1 lds
    s_sub_u32 m0, s17, 88
    s_nop 0
    global_load_lds_dword v15, s[18:19] offset:88
    s_waitcnt vmcnt(8)
    s_waitcnt lgkmcnt(0)
    v_cmp_gt_u32 vcc, 17, v14
    s_cbranch_vccnz Lf_108
Lf_108_ok:
    s_add_u32 m0, s66, 128000
    s_add_u32 s57, s14, 3538944
    buffer_load_dwordx4 v2, s[28:31], s57 offen offset:0 sc1 lds
    buffer_load_dwordx4 v2, s[28:31], s57 offen offset:1024 sc1 lds
    buffer_load_dwordx4 v2, s[28:31], s57 offen offset:2048 sc1 lds
    buffer_load_dwordx4 v2, s[28:31], s57 offen offset:3072 sc1 lds
    s_waitcnt vmcnt(8)
    s_add_u32 m0, s66, 132096
    s_add_u32 s57, s14, 3543040
    buffer_load_dwordx4 v2, s[28:31], s57 offen offset:0 sc1 lds
    buffer_load_dwordx4 v2, s[28:31], s57 offen offset:1024 sc1 lds
    buffer_load_dwordx4 v2, s[28:31], s57 offen offset:2048 sc1 lds
    buffer_load_dwordx4 v2, s[28:31], s57 offen offset:3072 sc1 lds
    s_waitcnt vmcnt(8)
    s_add_u32 m0, s66, 136192
    s_add_u32 s57, s14, 3547136
    buffer_load_dwordx4 v2, s[28:31], s57 offen offset:0 sc1 lds
    ds_read_b32 v14, v12
    buffer_load_dwordx4 v2, s[28:31], s57 offen offset:1024 sc1 lds
    buffer_load_dwordx4 v2, s[28:31], s57 offen offset:2048 sc1 lds
    buffer_load_dwordx4 v2, s[28:31], s57 offen offset:3072 sc1 lds
    s_waitcnt vmcnt(8)
    s_add_u32 m0, s66, 140288
    s_add_u32 s57, s14, 3551232
    buffer_load_dwordx4 v2, s[28:31], s57 offen offset:0 sc1 lds
    s_sub_u32 m0, s17, 92
    s_nop 0
    global_load_lds_dword v15, s[18:19] offset:92
    s_waitcnt vmcnt(8)
    s_waitcnt lgkmcnt(0)
    v_cmp_gt_u32 vcc, 18, v14
    s_cbranch_vccnz Lf_109
Lf_109_ok:
    s_add_u32 m0, s66, 76800
    s_add_u32 s57, s15, 3538944
    buffer_load_dwordx4 v2, s[28:31], s57 offen offset:0 sc1 lds
    buffer_load_dwordx4 v2, s[28:31], s57 offen offset:1024 sc1 lds
    buffer_load_dwordx4 v2, s[28:31], s57 offen offset:2048 sc1 lds
    buffer_load_dwordx4 v2, s[28:31], s57 offen offset:3072 sc1 lds
    s_waitcnt vmcnt(8)
    s_add_u32 m0, s66, 80896
    s_add_u32 s57, s15, 3543040
    buffer_load_dwordx4 v2, s[28:31], s57 offen offset:0 sc1 lds
    buffer_load_dwordx4 v2, s[28:31], s57 offen offset:1024 sc1 lds
    buffer_load_dwordx4 v2, s[28:31], s57 offen offset:2048 sc1 lds
    buffer_load_dwordx4 v2, s[28:31], s57 offen offset:3072 sc1 lds
    s_waitcnt vmcnt(8)
    s_add_u32 m0, s66, 84992
    s_add_u32 s57, s15, 3547136
    buffer_load_dwordx4 v2, s[28:31], s57 offen offset:0 sc1 lds
    ds_read_b32 v14, v12
    buffer_load_dwordx4 v2, s[28:31], s57 offen offset:1024 sc1 lds
    buffer_load_dwordx4 v2, s[28:31], s57 offen offset:2048 sc1 lds
    buffer_load_dwordx4 v2, s[28:31], s57 offen offset:3072 sc1 lds
    s_waitcnt vmcnt(8)
    s_add_u32 m0, s66, 89088
    s_add_u32 s57, s15, 3551232
    buffer_load_dwordx4 v2, s[28:31], s57 offen offset:0 sc1 lds
    s_sub_u32 m0, s17, 96
    s_nop 0
    global_load_lds_dword v15, s[18:19] offset:96
    s_waitcnt vmcnt(8)
    s_waitcnt lgkmcnt(0)
    v_cmp_gt_u32 vcc, 20, v14
    s_cbranch_vccnz Lf_110
Lf_110_ok:
    s_add_u32 m0, s66, 102400
    s_add_u32 s57, s16, 3538944
    buffer_load_dwordx4 v2, s[28:31], s57 offen offset:0 sc1 lds
    buffer_load_dwordx4 v2, s[28:31], s57 offen offset:1024 sc1 lds
    buffer_load_dwordx4 v2, s[28:31], s57 offen offset:2048 sc1 lds
    buffer_load_dwordx4 v2, s[28:31], s57 offen offset:3072 sc1 lds
    s_waitcnt vmcnt(8)
    s_add_u32 m0, s66, 106496
    s_add_u32 s57, s16, 3543040
    buffer_load_dwordx4 v2, s[28:31], s57 offen offset:0 sc1 lds
    buffer_load_dwordx4 v2, s[28:31], s57 offen offset:1024 sc1 lds
    buffer_load_dwordx4 v2, s[28:31], s57 offen offset:2048 sc1 lds
    buffer_load_dwordx4 v2, s[28:31], s57 offen offset:3072 sc1 lds
    s_waitcnt vmcnt(8)
    s_add_u32 m0, s66, 110592
    s_add_u32 s57, s16, 3547136
    buffer_load_dwordx4 v2, s[28:31], s57 offen offset:0 sc1 lds
    buffer_load_dwordx4 v2, s[28:31], s57 offen offset:1024 sc1 lds
    buffer_load_dwordx4 v2, s[28:31], s57 offen offset:2048 sc1 lds
    buffer_load_dwordx4 v2, s[28:31], s57 offen offset:3072 sc1 lds
    s_waitcnt vmcnt(8)
    s_add_u32 m0, s66, 114688
    s_add_u32 s57, s16, 3551232
    buffer_load_dwordx4 v2, s[28:31], s57 offen offset:0 sc1 lds
    s_sub_u32 m0, s17, 100
    s_nop 0
    global_load_lds_dword v15, s[18:19] offset:100
    s_waitcnt vmcnt(8)
    s_add_u32 m0, s66, 0
    s_add_u32 s57, s13, 4358144
    buffer_load_dwordx4 v2, s[28:31], s57 offen offset:0 sc1 lds
    buffer_load_dwordx4 v2, s[28:31], s57 offen offset:1024 sc1 lds
    buffer_load_dwordx4 v2, s[28:31], s57 offen offset:2048 sc1 lds
    buffer_load_dwordx4 v2, s[28:31], s57 offen offset:3072 sc1 lds
    s_waitcnt vmcnt(8)
    s_add_u32 m0, s66, 4096
    s_add_u32 s57, s13, 4362240
    buffer_load_dwordx4 v2, s[28:31], s57 offen offset:0 sc1 lds
    buffer_load_dwordx4 v2, s[28:31], s57 offen offset:1024 sc1 lds
    buffer_load_dwordx4 v2, s[28:31], s57 offen offset:2048 sc1 lds
    buffer_load_dwordx4 v2, s[28:31], s57 offen offset:3072 sc1 lds
    s_waitcnt vmcnt(8)
    s_add_u32 m0, s66, 8192
    s_add_u32 s57, s13, 4366336
    buffer_load_dwordx4 v2, s[28:31], s57 offen offset:0 sc1 lds
    ds_read_b32 v14, v12
    buffer_load_dwordx4 v2, s[28:31], s57 offen offset:1024 sc1 lds
    buffer_load_dwordx4 v2, s[28:31], s57 offen offset:2048 sc1 lds
    buffer_load_dwordx4 v2, s[28:31], s57 offen offset:3072 sc1 lds
    s_waitcnt vmcnt(8)
    s_add_u32 m0, s66, 12288
    s_add_u32 s57, s13, 4370432
    buffer_load_dwordx4 v2, s[28:31], s57 offen offset:0 sc1 lds
    s_sub_u32 m0, s17, 104
    s_nop 0
    global_load_lds_dword v15, s[18:19] offset:104
    s_waitcnt vmcnt(8)
    s_waitcnt lgkmcnt(0)
    v_cmp_gt_u32 vcc, 22, v14
    s_cbranch_vccnz Lf_111
Lf_111_ok:
    s_add_u32 m0, s66, 25600
    s_add_u32 s57, s14, 4358144
    buffer_load_dwordx4 v2, s[28:31], s57 offen offset:0 sc1 lds
    buffer_load_dwordx4 v2, s[28:31], s57 offen offset:1024 sc1 lds
    buffer_load_dwordx4 v2, s[28:31], s57 offen offset:2048 sc1 lds
    buffer_load_dwordx4 v2, s[28:31], s57 offen offset:3072 sc1 lds
    s_waitcnt vmcnt(8)
    s_add_u32 m0, s66, 29696
    s_add_u32 s57, s14, 4362240
    buffer_load_dwordx4 v2, s[28:31], s57 offen offset:0 sc1 lds
    buffer_load_dwordx4 v2, s[28:31], s57 offen offset:1024 sc1 lds
    buffer_load_dwordx4 v2, s[28:31], s57 offen offset:2048 sc1 lds
    buffer_load_dwordx4 v2, s[28:31], s57 offen offset:3072 sc1 lds
    s_waitcnt vmcnt(8)
    s_add_u32 m0, s66, 33792
    s_add_u32 s57, s14, 4366336
    buffer_load_dwordx4 v2, s[28:31], s57 offen offset:0 sc1 lds
    buffer_load_dwordx4 v2, s[28:31], s57 offen offset:1024 sc1 lds
    buffer_load_dwordx4 v2, s[28:31], s57 offen offset:2048 sc1 lds
    buffer_load_dwordx4 v2, s[28:31], s57 offen offset:3072 sc1 lds
    s_waitcnt vmcnt(8)
    s_add_u32 m0, s66, 37888
    s_add_u32 s57, s14, 4370432
    buffer_load_dwordx4 v2, s[28:31], s57 offen offset:0 sc1 lds
    s_sub_u32 m0, s17, 108
    s_nop 0
    global_load_lds_dword v15, s[18:19] offset:108
    s_waitcnt vmcnt(8)
    s_add_u32 m0, s66, 51200
    s_add_u32 s57, s15, 4358144
    buffer_load_dwordx4 v2, s[28:31], s57 offen offset:0 sc1 lds
    buffer_load_dwordx4 v2, s[28:31], s57 offen offset:1024 sc1 lds
    buffer_load_dwordx4 v2, s[28:31], s57 offen offset:2048 sc1 lds
    buffer_load_dwordx4 v2, s[28:31], s57 offen offset:3072 sc1 lds
    s_waitcnt vmcnt(8)
    s_add_u32 m0, s66, 55296
    s_add_u32 s57, s15, 4362240
    buffer_load_dwordx4 v2, s[28:31], s57 offen offset:0 sc1 lds
    buffer_load_dwordx4 v2, s[28:31], s57 offen offset:1024 sc1 lds
    buffer_load_dwordx4 v2, s[28:31], s57 offen offset:2048 sc1 lds
    buffer_load_dwordx4 v2, s[28:31], s57 offen offset:3072 sc1 lds
    s_waitcnt vmcnt(8)
    s_add_u32 m0, s66, 59392
    s_add_u32 s57, s15, 4366336
    buffer_load_dwordx4 v2, s[28:31], s57 offen offset:0 sc1 lds
    ds_read_b32 v14, v12
    buffer_load_dwordx4 v2, s[28:31], s57 offen offset:1024 sc1 lds
    buffer_load_dwordx4 v2, s[28:31], s57 offen offset:2048 sc1 lds
    buffer_load_dwordx4 v2, s[28:31], s57 offen offset:3072 sc1 lds
    s_waitcnt vmcnt(8)
    s_add_u32 m0, s66, 63488
    s_add_u32 s57, s15, 4370432
    buffer_load_dwordx4 v2, s[28:31], s57 offen offset:0 sc1 lds
    s_sub_u32 m0, s17, 112
    s_nop 0
    global_load_lds_dword v15, s[18:19] offset:112
    s_waitcnt vmcnt(8)
    s_waitcnt lgkmcnt(0)
    v_cmp_gt_u32 vcc, 24, v14
    s_cbranch_vccnz Lf_112
Lf_112_ok:
    s_add_u32 m0, s66, 128000
    s_add_u32 s57, s16, 4358144
    buffer_load_dwordx4 v2, s[28:31], s57 offen offset:0 sc1 lds
    buffer_load_dwordx4 v2, s[28:31], s57 offen offset:1024 sc1 lds
    buffer_load_dwordx4 v2, s[28:31], s57 offen offset:2048 sc1 lds
    buffer_load_dwordx4 v2, s[28:31], s57 offen offset:3072 sc1 lds
    s_waitcnt vmcnt(8)
    s_add_u32 m0, s66, 132096
    s_add_u32 s57, s16, 4362240
    buffer_load_dwordx4 v2, s[28:31], s57 offen offset:0 sc1 lds
    buffer_load_dwordx4 v2, s[28:31], s57 offen offset:1024 sc1 lds
    buffer_load_dwordx4 v2, s[28:31], s57 offen offset:2048 sc1 lds
    buffer_load_dwordx4 v2, s[28:31], s57 offen offset:3072 sc1 lds
    s_waitcnt vmcnt(8)
    s_add_u32 m0, s66, 136192
    s_add_u32 s57, s16, 4366336
    buffer_load_dwordx4 v2, s[28:31], s57 offen offset:0 sc1 lds
    buffer_load_dwordx4 v2, s[28:31], s57 offen offset:1024 sc1 lds
    buffer_load_dwordx4 v2, s[28:31], s57 offen offset:2048 sc1 lds
    buffer_load_dwordx4 v2, s[28:31], s57 offen offset:3072 sc1 lds
    s_waitcnt vmcnt(8)
    s_add_u32 m0, s66, 140288
    s_add_u32 s57, s16, 4370432
    buffer_load_dwordx4 v2, s[28:31], s57 offen offset:0 sc1 lds
    s_sub_u32 m0, s17, 116
    s_nop 0
    global_load_lds_dword v15, s[18:19] offset:116
    s_waitcnt vmcnt(8)
    s_add_u32 m0, s67, 81920
    s_add_u32 s57, s68, 5177344
    buffer_load_dwordx4 v2, s[28:31], s57 offen offset:0 sc1 lds
    buffer_load_dwordx4 v2, s[28:31], s57 offen offset:1024 sc1 lds
    buffer_load_dwordx4 v2, s[28:31], s57 offen offset:2048 sc1 lds
    buffer_load_dwordx4 v2, s[28:31], s57 offen offset:3072 sc1 lds
    s_waitcnt vmcnt(8)
    s_add_u32 m0, s67, 86016
    s_add_u32 s57, s68, 5181440
    buffer_load_dwordx4 v2, s[28:31], s57 offen offset:0 sc1 lds
    buffer_load_dwordx4 v2, s[28:31], s57 offen offset:1024 sc1 lds
    ds_read_b32 v14, v12
    buffer_load_dwordx4 v2, s[28:31], s57 offen offset:2048 sc1 lds
    buffer_load_dwordx4 v2, s[28:31], s57 offen offset:3072 sc1 lds
    s_waitcnt vmcnt(8)
    s_add_u32 m0, s67, 90112
    s_add_u32 s57, s68, 5185536
    buffer_load_dwordx4 v2, s[28:31], s57 offen offset:0 sc1 lds
    buffer_load_dwordx4 v2, s[28:31], s57 offen offset:1024 sc1 lds
    s_sub_u32 m0, s17, 120
    s_nop 0
    global_load_lds_dword v15, s[18:19] offset:120
    s_waitcnt vmcnt(8)
    s_waitcnt lgkmcnt(0)
    v_cmp_gt_u32 vcc, 26, v14
    s_cbranch_vccnz Lf_113
Lf_113_ok:
    s_add_u32 m0, s67, 102400
    s_add_u32 s57, s69, 5177344
    buffer_load_dwordx4 v2, s[28:31], s57 offen offset:0 sc1 lds
    buffer_load_dwordx4 v2, s[28:31], s57 offen offset:1024 sc1 lds
    buffer_load_dwordx4 v2, s[28:31], s57 offen offset:2048 sc1 lds
    buffer_load_dwordx4 v2, s[28:31], s57 offen offset:3072 sc1 lds
    s_waitcnt vmcnt(8)
    s_add_u32 m0, s67, 106496
    s_add_u32 s57, s69, 5181440
    buffer_load_dwordx4 v2, s[28:31], s57 offen offset:0 sc1 lds
    buffer_load_dwordx4 v2, s[28:31], s57 offen offset:1024 sc1 lds
    buffer_load_dwordx4 v2, s[28:31], s57 offen offset:2048 sc1 lds
    buffer_load_dwordx4 v2, s[28:31], s57 offen offset:3072 sc1 lds
    s_waitcnt vmcnt(8)
    s_add_u32 m0, s67, 110592
    s_add_u32 s57, s69, 5185536
    buffer_load_dwordx4 v2, s[28:31], s57 offen offset:0 sc1 lds
    buffer_load_dwordx4 v2, s[28:31], s57 offen offset:1024 sc1 lds
    s_sub_u32 m0, s17, 124
    s_nop 0
    global_load_lds_dword v15, s[18:19] offset:124
    s_waitcnt vmcnt(8)
    s_add_u32 m0, s67, 0
    s_add_u32 s57, s70, 5177344
    buffer_load_dwordx4 v2, s[28:31], s57 offen offset:0 sc1 lds
    buffer_load_dwordx4 v2, s[28:31], s57 offen offset:1024 sc1 lds
    buffer_load_dwordx4 v2, s[28:31], s57 offen offset:2048 sc1 lds
    buffer_load_dwordx4 v2, s[28:31], s57 offen offset:3072 sc1 lds
    s_waitcnt vmcnt(8)
    s_add_u32 m0, s67, 4096
    s_add_u32 s57, s70, 5181440
    buffer_load_dwordx4 v2, s[28:31], s57 offen offset:0 sc1 lds
    buffer_load_dwordx4 v2, s[28:31], s57 offen offset:1024 sc1 lds
    ds_read_b32 v14, v12
    buffer_load_dwordx4 v2, s[28:31], s57 offen offset:2048 sc1 lds
    buffer_load_dwordx4 v2, s[28:31], s57 offen offset:3072 sc1 lds
    s_waitcnt vmcnt(8)
    s_add_u32 m0, s67, 8192
    s_add_u32 s57, s70, 5185536
    buffer_load_dwordx4 v2, s[28:31], s57 offen offset:0 sc1 lds
    buffer_load_dwordx4 v2, s[28:31], s57 offen offset:1024 sc1 lds
    s_sub_u32 m0, s17, 128
    s_nop 0
    global_load_lds_dword v15, s[18:19] offset:128
    s_waitcnt vmcnt(8)
    s_waitcnt lgkmcnt(0)
    v_cmp_gt_u32 vcc, 28, v14
    s_cbranch_vccnz Lf_114
Lf_114_ok:
    s_add_u32 m0, s67, 20480
    s_add_u32 s57, s71, 5177344
    buffer_load_dwordx4 v2, s[28:31], s57 offen offset:0 sc1 lds
    buffer_load_dwordx4 v2, s[28:31], s57 offen offset:1024 sc1 lds
    buffer_load_dwordx4 v2, s[28:31], s57 offen offset:2048 sc1 lds
    buffer_load_dwordx4 v2, s[28:31], s57 offen offset:3072 sc1 lds
    s_waitcnt vmcnt(8)
    s_add_u32 m0, s67, 24576
    s_add_u32 s57, s71, 5181440
    buffer_load_dwordx4 v2, s[28:31], s57 offen offset:0 sc1 lds
    buffer_load_dwordx4 v2, s[28:31], s57 offen offset:1024 sc1 lds
    buffer_load_dwordx4 v2, s[28:31], s57 offen offset:2048 sc1 lds
    buffer_load_dwordx4 v2, s[28:31], s57 offen offset:3072 sc1 lds
    s_waitcnt vmcnt(8)
    s_add_u32 m0, s67, 28672
    s_add_u32 s57, s71, 5185536
    buffer_load_dwordx4 v2, s[28:31], s57 offen offset:0 sc1 lds
    buffer_load_dwordx4 v2, s[28:31], s57 offen offset:1024 sc1 lds
    s_sub_u32 m0, s17, 132
    s_nop 0
    global_load_lds_dword v15, s[18:19] offset:132
    s_waitcnt vmcnt(8)
    s_add_u32 m0, s67, 40960
    s_add_u32 s57, s68, 5259264
    buffer_load_dwordx4 v2, s[28:31], s57 offen offset:0 sc1 lds
    buffer_load_dwordx4 v2, s[28:31], s57 offen offset:1024 sc1 lds
    buffer_load_dwordx4 v2, s[28:31], s57 offen offset:2048 sc1 lds
    buffer_load_dwordx4 v2, s[28:31], s57 offen offset:3072 sc1 lds
    s_waitcnt vmcnt(8)
    s_add_u32 m0, s67, 45056
    s_add_u32 s57, s68, 5263360
    buffer_load_dwordx4 v2, s[28:31], s57 offen offset:0 sc1 lds
    buffer_load_dwordx4 v2, s[28:31], s57 offen offset:1024 sc1 lds
    buffer_load_dwordx4 v2, s[28:31], s57 offen offset:2048 sc1 lds
    buffer_load_dwordx4 v2, s[28:31], s57 offen offset:3072 sc1 lds
    s_waitcnt vmcnt(8)
    s_add_u32 m0, s67, 49152
    s_add_u32 s57, s68, 5267456
    buffer_load_dwordx4 v2, s[28:31], s57 offen offset:0 sc1 lds
    buffer_load_dwordx4 v2, s[28:31], s57 offen offset:1024 sc1 lds
    s_sub_u32 m0, s17, 136
    s_nop 0
    global_load_lds_dword v15, s[18:19] offset:136
    s_waitcnt vmcnt(8)
    s_add_u32 m0, s67, 61440
    s_add_u32 s57, s69, 5259264
    buffer_load_dwordx4 v2, s[28:31], s57 offen offset:0 sc1 lds
    buffer_load_dwordx4 v2, s[28:31], s57 offen offset:1024 sc1 lds
    buffer_load_dwordx4 v2, s[28:31], s57 offen offset:2048 sc1 lds
    buffer_load_dwordx4 v2, s[28:31], s57 offen offset:3072 sc1 lds
    s_waitcnt vmcnt(8)
    s_add_u32 m0, s67, 65536
    s_add_u32 s57, s69, 5263360
    buffer_load_dwordx4 v2, s[28:31], s57 offen offset:0 sc1 lds
    buffer_load_dwordx4 v2, s[28:31], s57 offen offset:1024 sc1 lds
    ds_read_b32 v14, v12
    buffer_load_dwordx4 v2, s[28:31], s57 offen offset:2048 sc1 lds
    buffer_load_dwordx4 v2, s[28:31], s57 offen offset:3072 sc1 lds
    s_waitcnt vmcnt(8)
    s_add_u32 m0, s67, 69632
    s_add_u32 s57, s69, 5267456
    buffer_load_dwordx4 v2, s[28:31], s57 offen offset:0 sc1 lds
    buffer_load_dwordx4 v2, s[28:31], s57 offen offset:1024 sc1 lds
    s_sub_u32 m0, s17, 140
    s_nop 0
    global_load_lds_dword v15, s[18:19] offset:140
    s_waitcnt vmcnt(8)
    s_waitcnt lgkmcnt(0)
    v_cmp_gt_u32 vcc, 30, v14
    s_cbranch_vccnz Lf_115
Lf_115_ok:
    s_add_u32 m0, s67, 122880
    s_add_u32 s57, s70, 5259264
    buffer_load_dwordx4 v2, s[28:31], s57 offen offset:0 sc1 lds
    buffer_load_dwordx4 v2, s[28:31], s57 offen offset:1024 sc1 lds
    buffer_load_dwordx4 v2, s[28:31], s57 offen offset:2048 sc1 lds
    buffer_load_dwordx4 v2, s[28:31], s57 offen offset:3072 sc1 lds
    s_waitcnt vmcnt(8)
    s_add_u32 m0, s67, 126976
    s_add_u32 s57, s70, 5263360
    buffer_load_dwordx4 v2, s[28:31], s57 offen offset:0 sc1 lds
    buffer_load_dwordx4 v2, s[28:31], s57 offen offset:1024 sc1 lds
    buffer_load_dwordx4 v2, s[28:31], s57 offen offset:2048 sc1 lds
    buffer_load_dwordx4 v2, s[28:31], s57 offen offset:3072 sc1 lds
    s_waitcnt vmcnt(8)
    s_add_u32 m0, s67, 131072
    s_add_u32 s57, s70, 5267456
    buffer_load_dwordx4 v2, s[28:31], s57 offen offset:0 sc1 lds
    buffer_load_dwordx4 v2, s[28:31], s57 offen offset:1024 sc1 lds
    s_sub_u32 m0, s17, 144
    s_nop 0
    global_load_lds_dword v15, s[18:19] offset:144
    s_waitcnt vmcnt(8)
    s_add_u32 m0, s67, 81920
    s_add_u32 s57, s71, 5259264
    buffer_load_dwordx4 v2, s[28:31], s57 offen offset:0 sc1 lds
    buffer_load_dwordx4 v2, s[28:31], s57 offen offset:1024 sc1 lds
    buffer_load_dwordx4 v2, s[28:31], s57 offen offset:2048 sc1 lds
    buffer_load_dwordx4 v2, s[28:31], s57 offen offset:3072 sc1 lds
    s_add_u32 m0, s67, 86016
    s_add_u32 s57, s71, 5263360
    buffer_load_dwordx4 v2, s[28:31], s57 offen offset:0 sc1 lds
    buffer_load_dwordx4 v2, s[28:31], s57 offen offset:1024 sc1 lds
    ds_read_b32 v14, v12
    buffer_load_dwordx4 v2, s[28:31], s57 offen offset:2048 sc1 lds
    buffer_load_dwordx4 v2, s[28:31], s57 offen offset:3072 sc1 lds
    s_add_u32 m0, s67, 90112
    s_add_u32 s57, s71, 5267456
    buffer_load_dwordx4 v2, s[28:31], s57 offen offset:0 sc1 lds
    buffer_load_dwordx4 v2, s[28:31], s57 offen offset:1024 sc1 lds
    s_sub_u32 m0, s17, 148
    s_nop 0
    global_load_lds_dword v15, s[18:19] offset:148
    s_waitcnt lgkmcnt(0)
    v_cmp_gt_u32 vcc, 32, v14
    s_cbranch_vccnz Lf_116
Lf_116_ok:
    s_add_u32 m0, s67, 102400
    s_add_u32 s57, s68, 5341184
    buffer_load_dwordx4 v2, s[28:31], s57 offen offset:0 sc1 lds
    buffer_load_dwordx4 v2, s[28:31], s57 offen offset:1024 sc1 lds
    buffer_load_dwordx4 v2, s[28:31], s57 offen offset:2048 sc1 lds
    buffer_load_dwordx4 v2, s[28:31], s57 offen offset:3072 sc1 lds
    s_add_u32 m0, s67, 106496
    s_add_u32 s57, s68, 5345280
    buffer_load_dwordx4 v2, s[28:31], s57 offen offset:0 sc1 lds
    buffer_load_dwordx4 v2, s[28:31], s57 offen offset:1024 sc1 lds
    buffer_load_dwordx4 v2, s[28:31], s57 offen offset:2048 sc1 lds
    buffer_load_dwordx4 v2, s[28:31], s57 offen offset:3072 sc1 lds
    s_add_u32 m0, s67, 110592
    s_add_u32 s57, s68, 5349376
    buffer_load_dwordx4 v2, s[28:31], s57 offen offset:0 sc1 lds
    buffer_load_dwordx4 v2, s[28:31], s57 offen offset:1024 sc1 lds
    s_sub_u32 m0, s17, 152
    s_nop 0
    global_load_lds_dword v15, s[18:19] offset:152
    s_waitcnt vmcnt(24)
    s_add_u32 m0, s67, 0
    s_add_u32 s57, s69, 5341184
    buffer_load_dwordx4 v2, s[28:31], s57 offen offset:0 sc1 lds
    buffer_load_dwordx4 v2, s[28:31], s57 offen offset:1024 sc1 lds
    buffer_load_dwordx4 v2, s[28:31], s57 offen offset:2048 sc1 lds
    buffer_load_dwordx4 v2, s[28:31], s57 offen offset:3072 sc1 lds
    s_add_u32 m0, s67, 4096
    s_add_u32 s57, s69, 5345280
    buffer_load_dwordx4 v2, s[28:31], s57 offen offset:0 sc1 lds
    buffer_load_dwordx4 v2, s[28:31], s57 offen offset:1024 sc1 lds
    ds_read_b32 v14, v12
    buffer_load_dwordx4 v2, s[28:31], s57 offen offset:2048 sc1 lds
    buffer_load_dwordx4 v2, s[28:31], s57 offen offset:3072 sc1 lds
    s_add_u32 m0, s67, 8192
    s_add_u32 s57, s69, 5349376
    buffer_load_dwordx4 v2, s[28:31], s57 offen offset:0 sc1 lds
    buffer_load_dwordx4 v2, s[28:31], s57 offen offset:1024 sc1 lds
    s_sub_u32 m0, s17, 156
    s_nop 0
    global_load_lds_dword v15, s[18:19] offset:156
    s_waitcnt vmcnt(24)
    s_waitcnt lgkmcnt(0)
    v_cmp_gt_u32 vcc, 34, v14
    s_cbranch_vccnz Lf_117
Lf_117_ok:
    s_add_u32 m0, s67, 20480
    s_add_u32 s57, s70, 5341184
    buffer_load_dwordx4 v2, s[28:31], s57 offen offset:0 sc1 lds
    buffer_load_dwordx4 v2, s[28:31], s57 offen offset:1024 sc1 lds
    buffer_load_dwordx4 v2, s[28:31], s57 offen offset:2048 sc1 lds
    buffer_load_dwordx4 v2, s[28:31], s57 offen offset:3072 sc1 lds
    s_add_u32 m0, s67, 24576
    s_add_u32 s57, s70, 5345280
    buffer_load_dwordx4 v2, s[28:31], s57 offen offset:0 sc1 lds
    buffer_load_dwordx4 v2, s[28:31], s57 offen offset:1024 sc1 lds
    buffer_load_dwordx4 v2, s[28:31], s57 offen offset:2048 sc1 lds
    buffer_load_dwordx4 v2, s[28:31], s57 offen offset:3072 sc1 lds
    s_add_u32 m0, s67, 28672
    s_add_u32 s57, s70, 5349376
    buffer_load_dwordx4 v2, s[28:31], s57 offen offset:0 sc1 lds
    buffer_load_dwordx4 v2, s[28:31], s57 offen offset:1024 sc1 lds
    s_sub_u32 m0, s17, 160
    s_nop 0
    global_load_lds_dword v15, s[18:19] offset:160
    s_waitcnt vmcnt(24)
    s_add_u32 m0, s67, 40960
    s_add_u32 s57, s71, 5341184
    buffer_load_dwordx4 v2, s[28:31], s57 offen offset:0 sc1 lds
    buffer_load_dwordx4 v2, s[28:31], s57 offen offset:1024 sc1 lds
    buffer_load_dwordx4 v2, s[28:31], s57 offen offset:2048 sc1 lds
    buffer_load_dwordx4 v2, s[28:31], s57 offen offset:3072 sc1 lds
    s_add_u32 m0, s67, 45056
    s_add_u32 s57, s71, 5345280
    buffer_load_dwordx4 v2, s[28:31], s57 offen offset:0 sc1 lds
    buffer_load_dwordx4 v2, s[28:31], s57 offen offset:1024 sc1 lds
    ds_read_b32 v14, v12
    buffer_load_dwordx4 v2, s[28:31], s57 offen offset:2048 sc1 lds
    buffer_load_dwordx4 v2, s[28:31], s57 offen offset:3072 sc1 lds
    s_add_u32 m0, s67, 49152
    s_add_u32 s57, s71, 5349376
    buffer_load_dwordx4 v2, s[28:31], s57 offen offset:0 sc1 lds
    buffer_load_dwordx4 v2, s[28:31], s57 offen offset:1024 sc1 lds
    s_sub_u32 m0, s17, 164
    s_nop 0
    global_load_lds_dword v15, s[18:19] offset:164
    s_waitcnt vmcnt(24)
    s_waitcnt lgkmcnt(0)
    v_cmp_gt_u32 vcc, 36, v14
    s_cbranch_vccnz Lf_118
Lf_118_ok:
    s_add_u32 m0, s67, 61440
    s_add_u32 s57, s68, 7143424
    buffer_load_dwordx4 v2, s[28:31], s57 offen offset:0 sc1 lds
    buffer_load_dwordx4 v2, s[28:31], s57 offen offset:1024 sc1 lds
    buffer_load_dwordx4 v2, s[28:31], s57 offen offset:2048 sc1 lds
    buffer_load_dwordx4 v2, s[28:31], s57 offen offset:3072 sc1 lds
    s_add_u32 m0, s67, 65536
    s_add_u32 s57, s68, 7147520
    buffer_load_dwordx4 v2, s[28:31], s57 offen offset:0 sc1 lds
    buffer_load_dwordx4 v2, s[28:31], s57 offen offset:1024 sc1 lds
    buffer_load_dwordx4 v2, s[28:31], s57 offen offset:2048 sc1 lds
    buffer_load_dwordx4 v2, s[28:31], s57 offen offset:3072 sc1 lds
    s_add_u32 m0, s67, 69632
    s_add_u32 s57, s68, 7151616
    buffer_load_dwordx4 v2, s[28:31], s57 offen offset:0 sc1 lds
    buffer_load_dwordx4 v2, s[28:31], s57 offen offset:1024 sc1 lds
    s_sub_u32 m0, s17, 168
    s_nop 0
    global_load_lds_dword v15, s[18:19] offset:168
    s_waitcnt vmcnt(24)
    s_add_u32 m0, s67, 122880
    s_add_u32 s57, s69, 7143424
    buffer_load_dwordx4 v2, s[28:31], s57 offen offset:0 sc1 lds
    buffer_load_dwordx4 v2, s[28:31], s57 offen offset:1024 sc1 lds
    buffer_load_dwordx4 v2, s[28:31], s57 offen offset:2048 sc1 lds
    buffer_load_dwordx4 v2, s[28:31], s57 offen offset:3072 sc1 lds
    s_add_u32 m0, s67, 126976
    s_add_u32 s57, s69, 7147520
    buffer_load_dwordx4 v2, s[28:31], s57 offen offset:0 sc1 lds
    buffer_load_dwordx4 v2, s[28:31], s57 offen offset:1024 sc1 lds
    ds_read_b32 v14, v12
    buffer_load_dwordx4 v2, s[28:31], s57 offen offset:2048 sc1 lds
    buffer_load_dwordx4 v2, s[28:31], s57 offen offset:3072 sc1 lds
    s_add_u32 m0, s67, 131072
    s_add_u32 s57, s69, 7151616
    buffer_load_dwordx4 v2, s[28:31], s57 offen offset:0 sc1 lds
    buffer_load_dwordx4 v2, s[28:31], s57 offen offset:1024 sc1 lds
    s_sub_u32 m0, s17, 172
    s_nop 0
    global_load_lds_dword v15, s[18:19] offset:172
    s_waitcnt vmcnt(24)
    s_waitcnt lgkmcnt(0)
    v_cmp_gt_u32 vcc, 38, v14
    s_cbranch_vccnz Lf_119
Lf_119_ok:
    s_add_u32 m0, s67, 81920
    s_add_u32 s57, s70, 7143424
    buffer_load_dwordx4 v2, s[28:31], s57 offen offset:0 sc1 lds
    buffer_load_dwordx4 v2, s[28:31], s57 offen offset:1024 sc1 lds
    buffer_load_dwordx4 v2, s[28:31], s57 offen offset:2048 sc1 lds
    buffer_load_dwordx4 v2, s[28:31], s57 offen offset:3072 sc1 lds
    s_add_u32 m0, s67, 86016
    s_add_u32 s57, s70, 7147520
    buffer_load_dwordx4 v2, s[28:31], s57 offen offset:0 sc1 lds
    buffer_load_dwordx4 v2, s[28:31], s57 offen offset:1024 sc1 lds
    buffer_load_dwordx4 v2, s[28:31], s57 offen offset:2048 sc1 lds
    buffer_load_dwordx4 v2, s[28:31], s57 offen offset:3072 sc1 lds
    s_add_u32 m0, s67, 90112
    s_add_u32 s57, s70, 7151616
    buffer_load_dwordx4 v2, s[28:31], s57 offen offset:0 sc1 lds
    buffer_load_dwordx4 v2, s[28:31], s57 offen offset:1024 sc1 lds
    s_sub_u32 m0, s17, 176
    s_nop 0
    global_load_lds_dword v15, s[18:19] offset:176
    s_waitcnt vmcnt(24)
    s_add_u32 m0, s67, 102400
    s_add_u32 s57, s71, 7143424
    buffer_load_dwordx4 v2, s[28:31], s57 offen offset:0 sc1 lds
    buffer_load_dwordx4 v2, s[28:31], s57 offen offset:1024 sc1 lds
    buffer_load_dwordx4 v2, s[28:31], s57 offen offset:2048 sc1 lds
    buffer_load_dwordx4 v2, s[28:31], s57 offen offset:3072 sc1 lds
    s_add_u32 m0, s67, 106496
    s_add_u32 s57, s71, 7147520
    buffer_load_dwordx4 v2, s[28:31], s57 offen offset:0 sc1 lds
    buffer_load_dwordx4 v2, s[28:31], s57 offen offset:1024 sc1 lds
    ds_read_b32 v14, v12
    buffer_load_dwordx4 v2, s[28:31], s57 offen offset:2048 sc1 lds
    buffer_load_dwordx4 v2, s[28:31], s57 offen offset:3072 sc1 lds
    s_add_u32 m0, s67, 110592
    s_add_u32 s57, s71, 7151616
    buffer_load_dwordx4 v2, s[28:31], s57 offen offset:0 sc1 lds
    buffer_load_dwordx4 v2, s[28:31], s57 offen offset:1024 sc1 lds
    s_sub_u32 m0, s17, 180
    s_nop 0
    global_load_lds_dword v15, s[18:19] offset:180
    s_waitcnt vmcnt(24)
    s_waitcnt lgkmcnt(0)
    v_cmp_gt_u32 vcc, 40, v14
    s_cbranch_vccnz Lf_120
Lf_120_ok:
    s_add_u32 m0, s67, 0
    s_add_u32 s57, s68, 7225344
    buffer_load_dwordx4 v2, s[28:31], s57 offen offset:0 sc1 lds
    buffer_load_dwordx4 v2, s[28:31], s57 offen offset:1024 sc1 lds
    buffer_load_dwordx4 v2, s[28:31], s57 offen offset:2048 sc1 lds
    buffer_load_dwordx4 v2, s[28:31], s57 offen offset:3072 sc1 lds
    s_add_u32 m0, s67, 4096
    s_add_u32 s57, s68, 7229440
    buffer_load_dwordx4 v2, s[28:31], s57 offen offset:0 sc1 lds
    buffer_load_dwordx4 v2, s[28:31], s57 offen offset:1024 sc1 lds
    buffer_load_dwordx4 v2, s[28:31], s57 offen offset:2048 sc1 lds
    buffer_load_dwordx4 v2, s[28:31], s57 offen offset:3072 sc1 lds
    s_add_u32 m0, s67, 8192
    s_add_u32 s57, s68, 7233536
    buffer_load_dwordx4 v2, s[28:31], s57 offen offset:0 sc1 lds
    buffer_load_dwordx4 v2, s[28:31], s57 offen offset:1024 sc1 lds
    s_sub_u32 m0, s17, 184
    s_nop 0
    global_load_lds_dword v15, s[18:19] offset:184
    s_waitcnt vmcnt(24)
    s_add_u32 m0, s67, 20480
    s_add_u32 s57, s69, 7225344
    buffer_load_dwordx4 v2, s[28:31], s57 offen offset:0 sc1 lds
    buffer_load_dwordx4 v2, s[28:31], s57 offen offset:1024 sc1 lds
    buffer_load_dwordx4 v2, s[28:31], s57 offen offset:2048 sc1 lds
    buffer_load_dwordx4 v2, s[28:31], s57 offen offset:3072 sc1 lds
    s_add_u32 m0, s67, 24576
    s_add_u32 s57, s69, 7229440
    buffer_load_dwordx4 v2, s[28:31], s57 offen offset:0 sc1 lds
    buffer_load_dwordx4 v2, s[28:31], s57 offen offset:1024 sc1 lds
    ds_read_b32 v14, v12
    buffer_load_dwordx4 v2, s[28:31], s57 offen offset:2048 sc1 lds
    buffer_load_dwordx4 v2, s[28:31], s57 offen offset:3072 sc1 lds
    s_add_u32 m0, s67, 28672
    s_add_u32 s57, s69, 7233536
    buffer_load_dwordx4 v2, s[28:31], s57 offen offset:0 sc1 lds
    buffer_load_dwordx4 v2, s[28:31], s57 offen offset:1024 sc1 lds
    s_sub_u32 m0, s17, 188
    s_nop 0
    global_load_lds_dword v15, s[18:19] offset:188
    s_waitcnt vmcnt(24)
    s_waitcnt lgkmcnt(0)
    v_cmp_gt_u32 vcc, 42, v14
    s_cbranch_vccnz Lf_121
Lf_121_ok:
    s_add_u32 m0, s67, 40960
    s_add_u32 s57, s70, 7225344
    buffer_load_dwordx4 v2, s[28:31], s57 offen offset:0 sc1 lds
    buffer_load_dwordx4 v2, s[28:31], s57 offen offset:1024 sc1 lds
    buffer_load_dwordx4 v2, s[28:31], s57 offen offset:2048 sc1 lds
    buffer_load_dwordx4 v2, s[28:31], s57 offen offset:3072 sc1 lds
    s_add_u32 m0, s67, 45056
    s_add_u32 s57, s70, 7229440
    buffer_load_dwordx4 v2, s[28:31], s57 offen offset:0 sc1 lds
    buffer_load_dwordx4 v2, s[28:31], s57 offen offset:1024 sc1 lds
    buffer_load_dwordx4 v2, s[28:31], s57 offen offset:2048 sc1 lds
    buffer_load_dwordx4 v2, s[28:31], s57 offen offset:3072 sc1 lds
    s_add_u32 m0, s67, 49152
    s_add_u32 s57, s70, 7233536
    buffer_load_dwordx4 v2, s[28:31], s57 offen offset:0 sc1 lds
    buffer_load_dwordx4 v2, s[28:31], s57 offen offset:1024 sc1 lds
    s_sub_u32 m0, s17, 192
    s_nop 0
    global_load_lds_dword v15, s[18:19] offset:192
    s_waitcnt vmcnt(24)
    s_add_u32 m0, s67, 61440
    s_add_u32 s57, s71, 7225344
    buffer_load_dwordx4 v2, s[28:31], s57 offen offset:0 sc1 lds
    buffer_load_dwordx4 v2, s[28:31], s57 offen offset:1024 sc1 lds
    buffer_load_dwordx4 v2, s[28:31], s57 offen offset:2048 sc1 lds
    buffer_load_dwordx4 v2, s[28:31], s57 offen offset:3072 sc1 lds
    s_add_u32 m0, s67, 65536
    s_add_u32 s57, s71, 7229440
    buffer_load_dwordx4 v2, s[28:31], s57 offen offset:0 sc1 lds
    buffer_load_dwordx4 v2, s[28:31], s57 offen offset:1024 sc1 lds
    ds_read_b32 v14, v12
    buffer_load_dwordx4 v2, s[28:31], s57 offen offset:2048 sc1 lds
    buffer_load_dwordx4 v2, s[28:31], s57 offen offset:3072 sc1 lds
    s_add_u32 m0, s67, 69632
    s_add_u32 s57, s71, 7233536
    buffer_load_dwordx4 v2, s[28:31], s57 offen offset:0 sc1 lds
    buffer_load_dwordx4 v2, s[28:31], s57 offen offset:1024 sc1 lds
    s_sub_u32 m0, s17, 196
    s_nop 0
    global_load_lds_dword v15, s[18:19] offset:196
    s_waitcnt vmcnt(24)
    s_waitcnt lgkmcnt(0)
    v_cmp_gt_u32 vcc, 44, v14
    s_cbranch_vccnz Lf_122
Lf_122_ok:
    s_add_u32 m0, s67, 122880
    s_add_u32 s57, s68, 7307264
    buffer_load_dwordx4 v2, s[28:31], s57 offen offset:0 sc1 lds
    buffer_load_dwordx4 v2, s[28:31], s57 offen offset:1024 sc1 lds
    buffer_load_dwordx4 v2, s[28:31], s57 offen offset:2048 sc1 lds
    buffer_load_dwordx4 v2, s[28:31], s57 offen offset:3072 sc1 lds
    s_add_u32 m0, s67, 126976
    s_add_u32 s57, s68, 7311360
    buffer_load_dwordx4 v2, s[28:31], s57 offen offset:0 sc1 lds
    buffer_load_dwordx4 v2, s[28:31], s57 offen offset:1024 sc1 lds
    buffer_load_dwordx4 v2, s[28:31], s57 offen offset:2048 sc1 lds
    buffer_load_dwordx4 v2, s[28:31], s57 offen offset:3072 sc1 lds
    s_add_u32 m0, s67, 131072
    s_add_u32 s57, s68, 7315456
    buffer_load_dwordx4 v2, s[28:31], s57 offen offset:0 sc1 lds
    buffer_load_dwordx4 v2, s[28:31], s57 offen offset:1024 sc1 lds
    s_sub_u32 m0, s17, 200
    s_nop 0
    global_load_lds_dword v15, s[18:19] offset:200
    s_waitcnt vmcnt(24)
    s_add_u32 m0, s67, 81920
    s_add_u32 s57, s69, 7307264
    buffer_load_dwordx4 v2, s[28:31], s57 offen offset:0 sc1 lds
    buffer_load_dwordx4 v2, s[28:31], s57 offen offset:1024 sc1 lds
    buffer_load_dwordx4 v2, s[28:31], s57 offen offset:2048 sc1 lds
    buffer_load_dwordx4 v2, s[28:31], s57 offen offset:3072 sc1 lds
    s_add_u32 m0, s67, 86016
    s_add_u32 s57, s69, 7311360
    buffer_load_dwordx4 v2, s[28:31], s57 offen offset:0 sc1 lds
    buffer_load_dwordx4 v2, s[28:31], s57 offen offset:1024 sc1 lds
    ds_read_b32 v14, v12
    buffer_load_dwordx4 v2, s[28:31], s57 offen offset:2048 sc1 lds
    buffer_load_dwordx4 v2, s[28:31], s57 offen offset:3072 sc1 lds
    s_add_u32 m0, s67, 90112
    s_add_u32 s57, s69, 7315456
    buffer_load_dwordx4 v2, s[28:31], s57 offen offset:0 sc1 lds
    buffer_load_dwordx4 v2, s[28:31], s57 offen offset:1024 sc1 lds
    s_sub_u32 m0, s17, 204
    s_nop 0
    global_load_lds_dword v15, s[18:19] offset:204
    s_waitcnt vmcnt(24)
    s_waitcnt lgkmcnt(0)
    v_cmp_gt_u32 vcc, 46, v14
    s_cbranch_vccnz Lf_123
Lf_123_ok:
    s_add_u32 m0, s67, 102400
    s_add_u32 s57, s70, 7307264
    buffer_load_dwordx4 v2, s[28:31], s57 offen offset:0 sc1 lds
    buffer_load_dwordx4 v2, s[28:31], s57 offen offset:1024 sc1 lds
    buffer_load_dwordx4 v2, s[28:31], s57 offen offset:2048 sc1 lds
    buffer_load_dwordx4 v2, s[28:31], s57 offen offset:3072 sc1 lds
    s_add_u32 m0, s67, 106496
    s_add_u32 s57, s70, 7311360
    buffer_load_dwordx4 v2, s[28:31], s57 offen offset:0 sc1 lds
    buffer_load_dwordx4 v2, s[28:31], s57 offen offset:1024 sc1 lds
    buffer_load_dwordx4 v2, s[28:31], s57 offen offset:2048 sc1 lds
    buffer_load_dwordx4 v2, s[28:31], s57 offen offset:3072 sc1 lds
    s_add_u32 m0, s67, 110592
    s_add_u32 s57, s70, 7315456
    buffer_load_dwordx4 v2, s[28:31], s57 offen offset:0 sc1 lds
    buffer_load_dwordx4 v2, s[28:31], s57 offen offset:1024 sc1 lds
    s_sub_u32 m0, s17, 208
    s_nop 0
    global_load_lds_dword v15, s[18:19] offset:208
    s_waitcnt vmcnt(24)
    s_add_u32 m0, s67, 0
    s_add_u32 s57, s71, 7307264
    buffer_load_dwordx4 v2, s[28:31], s57 offen offset:0 sc1 lds
    buffer_load_dwordx4 v2, s[28:31], s57 offen offset:1024 sc1 lds
    buffer_load_dwordx4 v2, s[28:31], s57 offen offset:2048 sc1 lds
    buffer_load_dwordx4 v2, s[28:31], s57 offen offset:3072 sc1 lds
    s_add_u32 m0, s67, 4096
    s_add_u32 s57, s71, 7311360
    buffer_load_dwordx4 v2, s[28:31], s57 offen offset:0 sc1 lds
    buffer_load_dwordx4 v2, s[28:31], s57 offen offset:1024 sc1 lds
    buffer_load_dwordx4 v2, s[28:31], s57 offen offset:2048 sc1 lds
    buffer_load_dwordx4 v2, s[28:31], s57 offen offset:3072 sc1 lds
    s_add_u32 m0, s67, 8192
    s_add_u32 s57, s71, 7315456
    buffer_load_dwordx4 v2, s[28:31], s57 offen offset:0 sc1 lds
    buffer_load_dwordx4 v2, s[28:31], s57 offen offset:1024 sc1 lds
    s_sub_u32 m0, s17, 212
    s_nop 0
    global_load_lds_dword v15, s[18:19] offset:212
    s_waitcnt vmcnt(24)
    s_endpgm
L_relay:
    s_setprio 2
    s_waitcnt lgkmcnt(0)
    s_mov_b32 s28, s24
    s_mov_b32 s29, s25
    s_mov_b32 s30, 26902528
    s_mov_b32 s31, 0x20000
    s_mul_i32 s57, s43, 5
    s_lshr_b32 s57, s57, 2
    s_mul_i32 s56, s57, 640
    s_add_u32 s56, s56, 9117696
    v_min_u32 v58, 39, v1
    v_lshlrev_b32 v58, 5, v58
    v_add_u32 v59, 6400, v58
    v_add_u32 v60, 12800, v58
    s_lshl_b32 s74, s44, 2
    s_mul_i32 s74, s74, 115712
    s_add_u32 s74, s74, 9207808
    v_lshrrev_b32 v48, 4, v1
    s_mov_b32 s58, 115712
    v_mul_lo_u32 v48, s58, v48
    v_and_b32 v46, 15, v1
    v_lshl_add_u32 v46, v46, 7, v48
    v_and_b32 v47, 3, v1
    v_lshl_add_u32 v47, v47, 7, v48
    v_and_b32 v49, 1, v1
    v_lshlrev_b32 v49, 7, v49
    v_bfe_u32 v50, v1, 1, 1
    v_mul_u32_u24 v50, 2048, v50
    v_add_u32 v49, v49, v50
    s_lshl_b32 s57, s43, 8
    s_add_u32 s57, s57, 111616
    v_add_u32 v49, s57, v49
    s_min_u32 s57, s43, 5
    s_lshl_b32 s57, s57, 7
    s_add_u32 s57, s57, 110592
    v_mov_b32 v50, s57
    v_and_b32 v51, 12, v1
    v_cmp_eq_u32 vcc, 0, v51
    s_nop 1
    v_cndmask_b32 v49, v50, v49, vcc
    v_add_u32 v52, v49, v48
Ltg_200001:
    ds_read_b64 v[28:29], v4 offset:48
    s_waitcnt lgkmcnt(0)
    v_cmp_gt_u32 vcc, 1, v29
    s_cbranch_vccz Ltg_200001_ok
    s_sleep 1
    s_cmp_eq_u32 s46, 0
    s_cbranch_scc1 Ltg_200001_ok
    s_sub_u32 s46, s46, 1
    s_branch Ltg_200001
Ltg_200001_ok:
    v_readfirstlane_b32 s48, v28
    s_mul_i32 s49, s48, 0x9E3779B1
    s_xor_b32 s49, s49, 0x7F4A7C15
Lsp_200002:
    ds_read_b32 v13, v4 offset:60
    s_waitcnt lgkmcnt(0)
    v_cmp_gt_u32 vcc, 3, v13
    s_cbranch_vccz Lsp_200002_ok
    s_sleep 2
    s_cmp_eq_u32 s46, 0
    s_cbranch_scc1 Lsp_200002_ok
    s_sub_u32 s46, s46, 1
    s_branch Lsp_200002
Lsp_200002_ok:
    s_sleep 20
L_pfa:
    buffer_load_dwordx2 v[128:129], v58, s[28:31], s56 offen sc1
    buffer_load_dwordx2 v[130:131], v59, s[28:31], s56 offen sc1
    buffer_load_dwordx2 v[132:133], v60, s[28:31], s56 offen sc1
    s_waitcnt vmcnt(0)
    v_cmp_ne_u64 vcc, s[48:49], v[128:129]
    v_cmp_ne_u64 s[26:27], s[48:49], v[130:131]
    s_or_b64 vcc, vcc, s[26:27]
    v_cmp_ne_u64 s[26:27], s[48:49], v[132:133]
    s_or_b64 vcc, vcc, s[26:27]
    s_cbranch_vccz L_pfa_ok
    s_sleep 4
    s_cmp_eq_u32 s46, 0
    s_cbranch_scc1 L_pfa_ok
    s_sub_u32 s46, s46, 1
    s_branch L_pfa
L_pfa_ok:
    v_mov_b32 v56, 3
    s_mov_b64 exec, 1
    ds_write_b32 v4, v56 offset:96
    s_mov_b64 exec, -1
    s_lshl_b32 s74, s44, 2
    s_mul_i32 s74, s74, 115712
    s_add_u32 s74, s74, 9207808
    v_lshrrev_b32 v48, 4, v1
    s_mov_b32 s58, 115712
    v_mul_lo_u32 v48, s58, v48
    v_and_b32 v46, 15, v1
    v_lshl_add_u32 v46, v46, 7, v48
    v_and_b32 v47, 3, v1
    v_lshl_add_u32 v47, v47, 7, v48
    v_and_b32 v6, 1, v1
    v_mul_u32_u24 v6, 260, v6
    v_add_u32 v6, 155008, v6
Lsp_200003:
    ds_read_b32 v13, v6 offset:0
    s_waitcnt lgkmcnt(0)
    v_cmp_gt_u32 vcc, 5, v13
    s_cbranch_vccz Lsp_200003_ok
    s_sleep 2
    s_cmp_eq_u32 s46, 0
    s_cbranch_scc1 Lsp_200003_ok
    s_sub_u32 s46, s46, 1
    s_branch Lsp_200003
Lsp_200003_ok:
    buffer_load_dword v50, v52, s[28:31], s74 offen sc1
    s_mul_i32 s58, s43, 2560
    s_add_u32 s58, s58, s74
    s_add_u32 s58, s58, 0
    buffer_load_dword v50, v46, s[28:31], s58 offen sc1
    buffer_load_dword v50, v47, s[28:31], s58 offen offset:2048 sc1
    s_mul_i32 s58, s43, 2560
    s_add_u32 s58, s58, s74
    s_add_u32 s58, s58, 20480
    buffer_load_dword v50, v46, s[28:31], s58 offen sc1
    buffer_load_dword v50, v47, s[28:31], s58 offen offset:2048 sc1
    s_lshl_b32 s58, s43, 11
    s_add_u32 s58, s58, s74
    s_add_u32 s58, s58, 40960
    buffer_load_dword v50, v46, s[28:31], s58 offen sc1
    s_endpgm
L_service:
    buffer_load_dword v38, v35, s[28:31], 0 offen sc1
    s_lshl_b32 s74, s44, 2
    s_mul_i32 s74, s74, 115712
    s_add_u32 s74, s74, 9207808
    v_lshrrev_b32 v46, 4, v1
    s_mov_b32 s58, 115712
    v_mul_lo_u32 v46, s58, v46
    v_and_b32 v44, 15, v1
    v_lshl_add_u32 v44, v44, 7, v46
    v_and_b32 v45, 3, v1
    v_lshl_add_u32 v45, v45, 7, v46
    s_mov_b32 s55, s74
    v_and_b32 v6, 1, v1
    v_mul_u32_u24 v6, 260, v6
    v_add_u32 v6, 155008, v6
    s_mul_i32 s57, s43, 5
    s_lshr_b32 s57, s57, 2
    s_mul_i32 s56, s57, 640
    s_add_u32 s56, s56, 9117696
    s_mul_i32 s45, s43, 1920
    s_add_u32 s45, s45, 9156096
    s_mul_i32 s61, s57, 1536
    s_add_u32 s61, s61, 9171456
    v_min_u32 v58, 39, v1
    v_lshlrev_b32 v58, 5, v58
    v_add_u32 v59, 6400, v58
    v_add_u32 v60, 12800, v58
    v_add_u32 v61, 19200, v58
    v_add_u32 v62, 25600, v58
    v_add_u32 v63, 32000, v58
    v_min_u32 v53, 59, v1
    v_lshlrev_b32 v53, 5, v53
    v_min_u32 v54, 47, v1
    v_lshlrev_b32 v54, 5, v54
    s_waitcnt vmcnt(0)
    v_add_u32 v38, 1, v38
    v_mov_b32 v39, 1
    ds_write_b64 v4, v[38:39] offset:48
    v_readfirstlane_b32 s48, v38
    s_mul_i32 s49, s48, 0x9E3779B1
    s_xor_b32 s49, s49, 0x7F4A7C15
    s_waitcnt lgkmcnt(0)
    v_mov_b32 v39, s49
    s_add_u32 s64, s63, 0
    s_cmp_ge_u32 s64, 1680
    s_cbranch_scc1 Lpd_200004_4
    s_mul_hi_u32 s66, s64, 214748365
    s_mul_i32 s57, s66, 20
    s_sub_u32 s65, s64, s57
    s_mul_hi_u32 s71, s66, 429496730
    s_min_u32 s71, s71, 6
    s_mul_i32 s57, s71, 10
    s_sub_u32 s66, s66, s57
    s_branch Lpd_200004
Lpd_200004_4:
    s_sub_u32 s57, s64, 1680
    s_mul_hi_u32 s66, s57, 89478486
    s_mul_i32 s58, s66, 48
    s_sub_u32 s65, s57, s58
    s_mov_b32 s71, 7
Lpd_200004:
    v_add_u32 v32, s70, v2
    v_lshrrev_b32 v33, 2, v1
    v_lshlrev_b32 v33, 7, v33
    v_and_b32 v31, 3, v1
    v_lshl_add_u32 v33, v31, 3, v33
    v_add_u32 v33, s70, v33
    v_lshlrev_b32 v34, 2, v1
    s_cmp_eq_u32 s71, 6
    s_cbranch_scc1 Ld3_200005
    s_mul_i32 s69, s71, 819200
    s_cmp_eq_u32 s71, 7
    s_cselect_b32 s69, 6881280, s69
    s_mov_b32 s60, 102400
    s_cselect_b32 s60, 245760, s60
    s_mul_i32 s57, s65, 5120
    s_add_u32 s69, s69, s57
    s_add_u32 s69, s69, 262144
    s_cmp_ge_u32 s64, 2160
    s_cselect_b32 s69, 1073741824, s69
    s_lshl_b32 s57, s66, 2
    s_add_u32 s57, s57, 0
    s_mul_hi_u32 s58, s57, 858993460
    s_mul_i32 s59, s58, 5
    s_sub_u32 s57, s57, s59
    s_lshl_b32 s57, s57, 10
    s_mul_i32 s58, s58, s60
    s_add_u32 s57, s57, s58
    s_add_u32 s67, s57, s69
    s_lshl_b32 s57, s66, 2
    s_add_u32 s57, s57, 1
    s_mul_hi_u32 s58, s57, 858993460
    s_mul_i32 s59, s58, 5
    s_sub_u32 s57, s57, s59
    s_lshl_b32 s57, s57, 10
    s_mul_i32 s58, s58, s60
    s_add_u32 s57, s57, s58
    s_add_u32 s68, s57, s69
    s_lshl_b32 s57, s66, 2
    s_add_u32 s57, s57, 2
    s_mul_hi_u32 s58, s57, 858993460
    s_mul_i32 s59, s58, 5
    s_sub_u32 s57, s57, s59
    s_lshl_b32 s57, s57, 10
    s_mul_i32 s58, s58, s60
    s_add_u32 s57, s57, s58
    s_add_u32 s74, s57, s69
    s_lshl_b32 s57, s66, 2
    s_add_u32 s57, s57, 3
    s_mul_hi_u32 s58, s57, 858993460
    s_mul_i32 s59, s58, 5
    s_sub_u32 s57, s57, s59
    s_lshl_b32 s57, s57, 10
    s_mul_i32 s58, s58, s60
    s_add_u32 s57, s57, s58
    s_add_u32 s75, s57, s69
    s_mul_i32 s57, s65, 2560
    s_add_u32 s57, s57, 32768
    s_cmp_eq_u32 s71, 4
    s_cselect_b32 s57, s57, 1073741824
    s_branch Ld3_200005_c
Ld3_200005:
    s_mul_i32 s57, s66, 81920
    s_lshl_b32 s58, s65, 12
    s_add_u32 s57, s57, s58
    s_add_u32 s67, s57, 5177344
    s_add_u32 s68, s57, 5178368
    s_add_u32 s74, s57, 5179392
    s_add_u32 s75, s57, 5180416
    s_mul_i32 s57, s65, 6144
    s_add_u32 s57, s57, 98304
Ld3_200005_c:
    s_lshl_b32 s58, s66, 8
    s_add_u32 s57, s57, s58
    ds_write_b128 v32, v[64:67] offset:0
    ds_write_b128 v32, v[68:71] offset:1024
    ds_read_b64_tr_b16 v[192:193], v33 offset:0
    ds_read_b64_tr_b16 v[196:197], v33 offset:32
    ds_read_b64_tr_b16 v[200:201], v33 offset:64
    ds_read_b64_tr_b16 v[204:205], v33 offset:96
    ds_write_b128 v32, v[72:75] offset:0
    ds_write_b128 v32, v[76:79] offset:1024
    ds_read_b64_tr_b16 v[194:195], v33 offset:0
    ds_read_b64_tr_b16 v[198:199], v33 offset:32
    ds_read_b64_tr_b16 v[202:203], v33 offset:64
    ds_read_b64_tr_b16 v[206:207], v33 offset:96
    s_waitcnt lgkmcnt(0)
    buffer_store_dwordx4 v[192:195], v2, s[28:31], s67 offen sc1
    buffer_store_dwordx4 v[196:199], v2, s[28:31], s68 offen sc1
    buffer_store_dwordx4 v[200:203], v2, s[28:31], s74 offen sc1
    buffer_store_dwordx4 v[204:207], v2, s[28:31], s75 offen sc1
    s_getreg_b32 s62, hwreg(HW_REG_XCC_ID)
    s_and_b32 s62, s62, 15
    v_mov_b32 v40, s62
    v_mov_b32 v41, 0
    s_lshl_b32 s57, s44, 3
    s_add_u32 s57, s57, s43
    s_lshl_b32 s57, s57, 4
    s_add_u32 s57, s57, 4096
    s_mov_b64 exec, 1
    buffer_store_dwordx4 v[38:41], v35, s[28:31], s57 offen sc1
    s_mov_b64 exec, -1
    s_lshl_b32 s57, s63, 5
    s_add_u32 s57, s57, 9117696
    s_waitcnt vmcnt(1)
    s_mov_b64 exec, 1
    buffer_store_dwordx2 v[38:39], v35, s[28:31], s57 offen sc1
    s_mov_b64 exec, -1
    v_mov_b32 v13, 1
    s_mov_b64 exec, 1
    ds_add_u32 v4, v13 offset:60
    s_mov_b64 exec, -1
Lsp_200006:
    ds_read_b32 v13, v4 offset:56
    s_waitcnt lgkmcnt(0)
    v_cmp_gt_u32 vcc, 4, v13
    s_cbranch_vccz Lsp_200006_ok
    s_sleep 1
    s_cmp_eq_u32 s46, 0
    s_cbranch_scc1 Lsp_200006_ok
    s_sub_u32 s46, s46, 1
    s_branch Lsp_200006
Lsp_200006_ok:
    s_add_u32 s64, s63, 768
    s_cmp_ge_u32 s64, 1680
    s_cbranch_scc1 Lpd_200007_4
    s_mul_hi_u32 s66, s64, 214748365
    s_mul_i32 s57, s66, 20
    s_sub_u32 s65, s64, s57
    s_mul_hi_u32 s71, s66, 429496730
    s_min_u32 s71, s71, 6
    s_mul_i32 s57, s71, 10
    s_sub_u32 s66, s66, s57
    s_branch Lpd_200007
Lpd_200007_4:
    s_sub_u32 s57, s64, 1680
    s_mul_hi_u32 s66, s57, 89478486
    s_mul_i32 s58, s66, 48
    s_sub_u32 s65, s57, s58
    s_mov_b32 s71, 7
Lpd_200007:
    s_lshl_b32 s59, s66, 7
    v_lshrrev_b32 v28, 3, v1
    v_and_b32 v29, 7, v1
    s_cmp_lt_u32 s71, 3
    s_cbranch_scc1 Lpa_200008_q
    s_cmp_eq_u32 s71, 7
    s_cbranch_scc1 Lpa_200008_4
    s_mul_hi_u32 s57, s65, 858993460
    s_mul_i32 s58, s57, 5
    s_sub_u32 s58, s65, s58
    s_mul_i32 s57, s57, 160
    s_lshr_b32 s60, s58, 1
    s_mul_i32 s60, s60, 80
    s_and_b32 s68, s58, 1
    s_lshl_b32 s68, s68, 5
    s_add_u32 s60, s60, s68
    s_cmp_eq_u32 s58, 4
    s_cselect_b32 s60, 64, s60
    s_cselect_b32 s68, 80, 16
    s_add_u32 s67, s57, s60
    s_add_u32 s68, s67, s68
    s_cmp_eq_u32 s71, 6
    s_movk_i32 s69, 1280
    s_cselect_b32 s69, 3072, s69
    s_lshl_b32 s60, s69, 3
    s_branch Lpa_200008
Lpa_200008_4:
    s_lshr_b32 s57, s65, 4
    s_lshl_b32 s67, s57, 6
    s_bfe_u32 s57, s65, 0x30001
    s_mul_i32 s57, s57, 192
    s_add_u32 s67, s67, s57
    s_and_b32 s57, s65, 1
    s_lshl_b32 s57, s57, 5
    s_add_u32 s67, s67, s57
    s_add_u32 s68, s67, 16
    s_movk_i32 s69, 1280
    s_movk_i32 s60, 10240
    s_branch Lpa_200008
Lpa_200008_q:
    s_lshl_b32 s67, s65, 5
    s_add_u32 s68, s67, 4
    s_movk_i32 s69, 3840
    s_mov_b32 s60, 61440
    s_add_u32 s57, s71, 1
    s_cmp_eq_u32 s57, 3
    s_cselect_b32 s57, 0, s57
    s_mul_i32 s57, s57, 1280
    s_add_u32 s59, s59, s57
    v_and_b32 v30, 4, v28
    v_add_u32 v28, v28, v30
Lpa_200008:
    v_mul_lo_u32 v36, s69, v28
    v_lshl_add_u32 v36, v29, 4, v36
    v_add_u32 v37, s60, v36
    s_mul_i32 s67, s67, s69
    s_add_u32 s67, s67, s59
    s_mul_i32 s68, s68, s69
    s_add_u32 s68, s68, s59
    s_cmp_ge_u32 s64, 2160
    s_cselect_b32 s67, 1073741824, s67
    s_cselect_b32 s68, 1073741824, s68
    s_mov_b32 s36, s6
    s_mov_b32 s37, s7
    s_mov_b32 s38, 819200
    s_mov_b32 s39, 0x20000
    s_cmp_eq_u32 s71, 3
    s_cselect_b64 s[36:37], s[8:9], s[36:37]
    s_cmp_eq_u32 s71, 4
    s_cselect_b64 s[36:37], s[12:13], s[36:37]
    s_cmp_eq_u32 s71, 5
    s_cselect_b64 s[36:37], s[14:15], s[36:37]
    s_cmp_eq_u32 s71, 6
    s_cselect_b64 s[36:37], s[16:17], s[36:37]
    s_cmp_eq_u32 s71, 7
    s_cselect_b64 s[36:37], s[18:19], s[36:37]
    s_cmp_ge_u32 s71, 6
    s_cselect_b32 s38, 1966080, s38
    s_cmp_lt_u32 s71, 3
    s_cselect_b32 s38, 2457600, s38
    buffer_load_dwordx4 v[80:83], v36, s[36:39], s67 offen nt
    buffer_load_dwordx4 v[84:87], v37, s[36:39], s67 offen nt
    buffer_load_dwordx4 v[88:91], v36, s[36:39], s68 offen nt
    buffer_load_dwordx4 v[92:95], v37, s[36:39], s68 offen nt
    s_add_u32 s64, s63, 1536
    s_cmp_ge_u32 s64, 1680
    s_cbranch_scc1 Lpd_200009_4
    s_mul_hi_u32 s66, s64, 214748365
    s_mul_i32 s57, s66, 20
    s_sub_u32 s65, s64, s57
    s_mul_hi_u32 s71, s66, 429496730
    s_min_u32 s71, s71, 6
    s_mul_i32 s57, s71, 10
    s_sub_u32 s66, s66, s57
    s_branch Lpd_200009
Lpd_200009_4:
    s_sub_u32 s57, s64, 1680
    s_mul_hi_u32 s66, s57, 89478486
    s_mul_i32 s58, s66, 48
    s_sub_u32 s65, s57, s58
    s_mov_b32 s71, 7
Lpd_200009:
    s_lshl_b32 s59, s66, 7
    v_lshrrev_b32 v28, 3, v1
    v_and_b32 v29, 7, v1
    s_cmp_lt_u32 s71, 3
    s_cbranch_scc1 Lpa_200010_q
    s_cmp_eq_u32 s71, 7
    s_cbranch_scc1 Lpa_200010_4
    s_mul_hi_u32 s57, s65, 858993460
    s_mul_i32 s58, s57, 5
    s_sub_u32 s58, s65, s58
    s_mul_i32 s57, s57, 160
    s_lshr_b32 s60, s58, 1
    s_mul_i32 s60, s60, 80
    s_and_b32 s68, s58, 1
    s_lshl_b32 s68, s68, 5
    s_add_u32 s60, s60, s68
    s_cmp_eq_u32 s58, 4
    s_cselect_b32 s60, 64, s60
    s_cselect_b32 s68, 80, 16
    s_add_u32 s67, s57, s60
    s_add_u32 s68, s67, s68
    s_cmp_eq_u32 s71, 6
    s_movk_i32 s69, 1280
    s_cselect_b32 s69, 3072, s69
    s_lshl_b32 s60, s69, 3
    s_branch Lpa_200010
Lpa_200010_4:
    s_lshr_b32 s57, s65, 4
    s_lshl_b32 s67, s57, 6
    s_bfe_u32 s57, s65, 0x30001
    s_mul_i32 s57, s57, 192
    s_add_u32 s67, s67, s57
    s_and_b32 s57, s65, 1
    s_lshl_b32 s57, s57, 5
    s_add_u32 s67, s67, s57
    s_add_u32 s68, s67, 16
    s_movk_i32 s69, 1280
    s_movk_i32 s60, 10240
    s_branch Lpa_200010
Lpa_200010_q:
    s_lshl_b32 s67, s65, 5
    s_add_u32 s68, s67, 4
    s_movk_i32 s69, 3840
    s_mov_b32 s60, 61440
    s_add_u32 s57, s71, 1
    s_cmp_eq_u32 s57, 3
    s_cselect_b32 s57, 0, s57
    s_mul_i32 s57, s57, 1280
    s_add_u32 s59, s59, s57
    v_and_b32 v30, 4, v28
    v_add_u32 v28, v28, v30
Lpa_200010:
    v_mul_lo_u32 v36, s69, v28
    v_lshl_add_u32 v36, v29, 4, v36
    v_add_u32 v37, s60, v36
    s_mul_i32 s67, s67, s69
    s_add_u32 s67, s67, s59
    s_mul_i32 s68, s68, s69
    s_add_u32 s68, s68, s59
    s_cmp_ge_u32 s64, 2160
    s_cselect_b32 s67, 1073741824, s67
    s_cselect_b32 s68, 1073741824, s68
    s_mov_b32 s36, s6
    s_mov_b32 s37, s7
    s_mov_b32 s38, 819200
    s_mov_b32 s39, 0x20000
    s_cmp_eq_u32 s71, 3
    s_cselect_b64 s[36:37], s[8:9], s[36:37]
    s_cmp_eq_u32 s71, 4
    s_cselect_b64 s[36:37], s[12:13], s[36:37]
    s_cmp_eq_u32 s71, 5
    s_cselect_b64 s[36:37], s[14:15], s[36:37]
    s_cmp_eq_u32 s71, 6
    s_cselect_b64 s[36:37], s[16:17], s[36:37]
    s_cmp_eq_u32 s71, 7
    s_cselect_b64 s[36:37], s[18:19], s[36:37]
    s_cmp_ge_u32 s71, 6
    s_cselect_b32 s38, 1966080, s38
    s_cmp_lt_u32 s71, 3
    s_cselect_b32 s38, 2457600, s38
    buffer_load_dwordx4 v[96:99], v36, s[36:39], s67 offen nt
    buffer_load_dwordx4 v[100:103], v37, s[36:39], s67 offen nt
    buffer_load_dwordx4 v[104:107], v36, s[36:39], s68 offen nt
    buffer_load_dwordx4 v[108:111], v37, s[36:39], s68 offen nt
    s_add_u32 s64, s63, 768
    s_cmp_ge_u32 s64, 1680
    s_cbranch_scc1 Lpd_200011_4
    s_mul_hi_u32 s66, s64, 214748365
    s_mul_i32 s57, s66, 20
    s_sub_u32 s65, s64, s57
    s_mul_hi_u32 s71, s66, 429496730
    s_min_u32 s71, s71, 6
    s_mul_i32 s57, s71, 10
    s_sub_u32 s66, s66, s57
    s_branch Lpd_200011
Lpd_200011_4:
    s_sub_u32 s57, s64, 1680
    s_mul_hi_u32 s66, s57, 89478486
    s_mul_i32 s58, s66, 48
    s_sub_u32 s65, s57, s58
    s_mov_b32 s71, 7
Lpd_200011:
    s_cmp_eq_u32 s71, 6
    s_cbranch_scc1 Ld3_200012
    s_mul_i32 s69, s71, 819200
    s_cmp_eq_u32 s71, 7
    s_cselect_b32 s69, 6881280, s69
    s_mov_b32 s60, 102400
    s_cselect_b32 s60, 245760, s60
    s_mul_i32 s57, s65, 5120
    s_add_u32 s69, s69, s57
    s_add_u32 s69, s69, 262144
    s_cmp_ge_u32 s64, 2160
    s_cselect_b32 s69, 1073741824, s69
    s_lshl_b32 s57, s66, 2
    s_add_u32 s57, s57, 0
    s_mul_hi_u32 s58, s57, 858993460
    s_mul_i32 s59, s58, 5
    s_sub_u32 s57, s57, s59
    s_lshl_b32 s57, s57, 10
    s_mul_i32 s58, s58, s60
    s_add_u32 s57, s57, s58
    s_add_u32 s67, s57, s69
    s_lshl_b32 s57, s66, 2
    s_add_u32 s57, s57, 1
    s_mul_hi_u32 s58, s57, 858993460
    s_mul_i32 s59, s58, 5
    s_sub_u32 s57, s57, s59
    s_lshl_b32 s57, s57, 10
    s_mul_i32 s58, s58, s60
    s_add_u32 s57, s57, s58
    s_add_u32 s68, s57, s69
    s_lshl_b32 s57, s66, 2
    s_add_u32 s57, s57, 2
    s_mul_hi_u32 s58, s57, 858993460
    s_mul_i32 s59, s58, 5
    s_sub_u32 s57, s57, s59
    s_lshl_b32 s57, s57, 10
    s_mul_i32 s58, s58, s60
    s_add_u32 s57, s57, s58
    s_add_u32 s74, s57, s69
    s_lshl_b32 s57, s66, 2
    s_add_u32 s57, s57, 3
    s_mul_hi_u32 s58, s57, 858993460
    s_mul_i32 s59, s58, 5
    s_sub_u32 s57, s57, s59
    s_lshl_b32 s57, s57, 10
    s_mul_i32 s58, s58, s60
    s_add_u32 s57, s57, s58
    s_add_u32 s75, s57, s69
    s_mul_i32 s57, s65, 2560
    s_add_u32 s57, s57, 32768
    s_cmp_eq_u32 s71, 4
    s_cselect_b32 s57, s57, 1073741824
    s_branch Ld3_200012_c
Ld3_200012:
    s_mul_i32 s57, s66, 81920
    s_lshl_b32 s58, s65, 12
    s_add_u32 s57, s57, s58
    s_add_u32 s67, s57, 5177344
    s_add_u32 s68, s57, 5178368
    s_add_u32 s74, s57, 5179392
    s_add_u32 s75, s57, 5180416
    s_mul_i32 s57, s65, 6144
    s_add_u32 s57, s57, 98304
Ld3_200012_c:
    s_lshl_b32 s58, s66, 8
    s_add_u32 s57, s57, s58
    s_waitcnt vmcnt(4)
    ds_write_b128 v32, v[80:83] offset:0
    ds_write_b128 v32, v[84:87] offset:1024
    ds_read_b64_tr_b16 v[208:209], v33 offset:0
    ds_read_b64_tr_b16 v[212:213], v33 offset:32
    ds_read_b64_tr_b16 v[216:217], v33 offset:64
    ds_read_b64_tr_b16 v[220:221], v33 offset:96
    ds_write_b128 v32, v[88:91] offset:0
    ds_write_b128 v32, v[92:95] offset:1024
    ds_read_b64_tr_b16 v[210:211], v33 offset:0
    ds_read_b64_tr_b16 v[214:215], v33 offset:32
    ds_read_b64_tr_b16 v[218:219], v33 offset:64
    ds_read_b64_tr_b16 v[222:223], v33 offset:96
    s_waitcnt lgkmcnt(0)
    buffer_store_dwordx4 v[208:211], v2, s[28:31], s67 offen sc1
    buffer_store_dwordx4 v[212:215], v2, s[28:31], s68 offen sc1
    buffer_store_dwordx4 v[216:219], v2, s[28:31], s74 offen sc1
    buffer_store_dwordx4 v[220:223], v2, s[28:31], s75 offen sc1
    v_mov_b32 v224, 0
    v_mov_b32 v225, 0
    v_mov_b32 v226, 0
    v_mov_b32 v227, 0
    v_dot2c_f32_bf16 v224, s72, v208
    v_dot2c_f32_bf16 v225, s72, v212
    v_dot2c_f32_bf16 v226, s72, v216
    v_dot2c_f32_bf16 v227, s72, v220
    v_dot2c_f32_bf16 v224, s72, v209
    v_dot2c_f32_bf16 v225, s72, v213
    v_dot2c_f32_bf16 v226, s72, v217
    v_dot2c_f32_bf16 v227, s72, v221
    v_dot2c_f32_bf16 v224, s72, v210
    v_dot2c_f32_bf16 v225, s72, v214
    v_dot2c_f32_bf16 v226, s72, v218
    v_dot2c_f32_bf16 v227, s72, v222
    v_dot2c_f32_bf16 v224, s72, v211
    v_dot2c_f32_bf16 v225, s72, v215
    v_dot2c_f32_bf16 v226, s72, v219
    v_dot2c_f32_bf16 v227, s72, v223
    s_nop 1
    v_permlane32_swap_b32 v224, v226
    v_permlane32_swap_b32 v225, v227
    v_add_f32 v224, v224, v226
    v_add_f32 v225, v225, v227
    s_nop 1
    v_permlane16_swap_b32 v224, v225
    v_add_f32 v224, v224, v225
    buffer_store_dword v224, v34, s[28:31], s57 offen sc1
    s_add_u32 s64, s63, 1536
    s_cmp_ge_u32 s64, 1680
    s_cbranch_scc1 Lpd_200013_4
    s_mul_hi_u32 s66, s64, 214748365
    s_mul_i32 s57, s66, 20
    s_sub_u32 s65, s64, s57
    s_mul_hi_u32 s71, s66, 429496730
    s_min_u32 s71, s71, 6
    s_mul_i32 s57, s71, 10
    s_sub_u32 s66, s66, s57
    s_branch Lpd_200013
Lpd_200013_4:
    s_sub_u32 s57, s64, 1680
    s_mul_hi_u32 s66, s57, 89478486
    s_mul_i32 s58, s66, 48
    s_sub_u32 s65, s57, s58
    s_mov_b32 s71, 7
Lpd_200013:
    s_cmp_eq_u32 s71, 6
    s_cbranch_scc1 Ld3_200014
    s_mul_i32 s69, s71, 819200
    s_cmp_eq_u32 s71, 7
    s_cselect_b32 s69, 6881280, s69
    s_mov_b32 s60, 102400
    s_cselect_b32 s60, 245760, s60
    s_mul_i32 s57, s65, 5120
    s_add_u32 s69, s69, s57
    s_add_u32 s69, s69, 262144
    s_cmp_ge_u32 s64, 2160
    s_cselect_b32 s69, 1073741824, s69
    s_lshl_b32 s57, s66, 2
    s_add_u32 s57, s57, 0
    s_mul_hi_u32 s58, s57, 858993460
    s_mul_i32 s59, s58, 5
    s_sub_u32 s57, s57, s59
    s_lshl_b32 s57, s57, 10
    s_mul_i32 s58, s58, s60
    s_add_u32 s57, s57, s58
    s_add_u32 s67, s57, s69
    s_lshl_b32 s57, s66, 2
    s_add_u32 s57, s57, 1
    s_mul_hi_u32 s58, s57, 858993460
    s_mul_i32 s59, s58, 5
    s_sub_u32 s57, s57, s59
    s_lshl_b32 s57, s57, 10
    s_mul_i32 s58, s58, s60
    s_add_u32 s57, s57, s58
    s_add_u32 s68, s57, s69
    s_lshl_b32 s57, s66, 2
    s_add_u32 s57, s57, 2
    s_mul_hi_u32 s58, s57, 858993460
    s_mul_i32 s59, s58, 5
    s_sub_u32 s57, s57, s59
    s_lshl_b32 s57, s57, 10
    s_mul_i32 s58, s58, s60
    s_add_u32 s57, s57, s58
    s_add_u32 s74, s57, s69
    s_lshl_b32 s57, s66, 2
    s_add_u32 s57, s57, 3
    s_mul_hi_u32 s58, s57, 858993460
    s_mul_i32 s59, s58, 5
    s_sub_u32 s57, s57, s59
    s_lshl_b32 s57, s57, 10
    s_mul_i32 s58, s58, s60
    s_add_u32 s57, s57, s58
    s_add_u32 s75, s57, s69
    s_mul_i32 s57, s65, 2560
    s_add_u32 s57, s57, 32768
    s_cmp_eq_u32 s71, 4
    s_cselect_b32 s57, s57, 1073741824
    s_branch Ld3_200014_c
Ld3_200014:
    s_mul_i32 s57, s66, 81920
    s_lshl_b32 s58, s65, 12
    s_add_u32 s57, s57, s58
    s_add_u32 s67, s57, 5177344
    s_add_u32 s68, s57, 5178368
    s_add_u32 s74, s57, 5179392
    s_add_u32 s75, s57, 5180416
    s_mul_i32 s57, s65, 6144
    s_add_u32 s57, s57, 98304
Ld3_200014_c:
    s_lshl_b32 s58, s66, 8
    s_add_u32 s57, s57, s58
    s_waitcnt vmcnt(5)
    ds_write_b128 v32, v[96:99] offset:0
    ds_write_b128 v32, v[100:103] offset:1024
    ds_read_b64_tr_b16 v[192:193], v33 offset:0
    ds_read_b64_tr_b16 v[196:197], v33 offset:32
    ds_read_b64_tr_b16 v[200:201], v33 offset:64
    ds_read_b64_tr_b16 v[204:205], v33 offset:96
    ds_write_b128 v32, v[104:107] offset:0
    ds_write_b128 v32, v[108:111] offset:1024
    ds_read_b64_tr_b16 v[194:195], v33 offset:0
    ds_read_b64_tr_b16 v[198:199], v33 offset:32
    ds_read_b64_tr_b16 v[202:203], v33 offset:64
    ds_read_b64_tr_b16 v[206:207], v33 offset:96
    s_waitcnt lgkmcnt(0)
    buffer_store_dwordx4 v[192:195], v2, s[28:31], s67 offen sc1
    buffer_store_dwordx4 v[196:199], v2, s[28:31], s68 offen sc1
    buffer_store_dwordx4 v[200:203], v2, s[28:31], s74 offen sc1
    buffer_store_dwordx4 v[204:207], v2, s[28:31], s75 offen sc1
    v_mov_b32 v224, 0
    v_mov_b32 v225, 0
    v_mov_b32 v226, 0
    v_mov_b32 v227, 0
    v_dot2c_f32_bf16 v224, s72, v192
    v_dot2c_f32_bf16 v225, s72, v196
    v_dot2c_f32_bf16 v226, s72, v200
    v_dot2c_f32_bf16 v227, s72, v204
    v_dot2c_f32_bf16 v224, s72, v193
    v_dot2c_f32_bf16 v225, s72, v197
    v_dot2c_f32_bf16 v226, s72, v201
    v_dot2c_f32_bf16 v227, s72, v205
    v_dot2c_f32_bf16 v224, s72, v194
    v_dot2c_f32_bf16 v225, s72, v198
    v_dot2c_f32_bf16 v226, s72, v202
    v_dot2c_f32_bf16 v227, s72, v206
    v_dot2c_f32_bf16 v224, s72, v195
    v_dot2c_f32_bf16 v225, s72, v199
    v_dot2c_f32_bf16 v226, s72, v203
    v_dot2c_f32_bf16 v227, s72, v207
    s_nop 1
    v_permlane32_swap_b32 v224, v226
    v_permlane32_swap_b32 v225, v227
    v_add_f32 v224, v224, v226
    v_add_f32 v225, v225, v227
    s_nop 1
    v_permlane16_swap_b32 v224, v225
    v_add_f32 v224, v224, v225
    buffer_store_dword v224, v34, s[28:31], s57 offen sc1
    s_lshl_b32 s57, s44, 7
    s_add_u32 s57, s57, 4096
    v_and_b32 v57, 7, v1
    v_lshlrev_b32 v57, 4, v57
L_xt:
    buffer_load_dwordx4 v[48:51], v57, s[28:31], s57 offen sc1
    s_waitcnt vmcnt(0)
    v_cmp_ne_u64 vcc, s[48:49], v[48:49]
    s_cbranch_vccz L_xt_ok
    s_sleep 4
    s_cmp_eq_u32 s46, 0
    s_cbranch_scc1 L_xt_ok
    s_sub_u32 s46, s46, 1
    s_branch L_xt
L_xt_ok:
    v_cmp_ne_u32 vcc, s62, v50
    s_cmp_eq_u64 vcc, 0
    s_cselect_b32 s57, 1, 2
    v_mov_b32 v57, s57
Lsp_200015:
    ds_read_b32 v13, v4 offset:96
    s_waitcnt lgkmcnt(0)
    v_cmp_gt_u32 vcc, 1, v13
    s_cbranch_vccz Lsp_200015_ok
    s_sleep 2
    s_cmp_eq_u32 s46, 0
    s_cbranch_scc1 Lsp_200015_ok
    s_sub_u32 s46, s46, 1
    s_branch Lsp_200015
Lsp_200015_ok:
    s_mov_b64 exec, 1
    ds_write_b32 v4, v57 offset:40
    s_mov_b64 exec, -1
    s_lshl_b32 s57, s63, 5
    s_add_u32 s57, s57, 9142272
    s_mov_b64 exec, 1
    buffer_store_dwordx2 v[38:39], v35, s[28:31], s57 offen sc1
    s_add_u32 s57, s57, 24576
    buffer_store_dwordx2 v[38:39], v35, s[28:31], s57 offen sc1
    s_mov_b64 exec, -1
Lsp_200016:
    ds_read_b32 v13, v4 offset:96
    s_waitcnt lgkmcnt(0)
    v_cmp_gt_u32 vcc, 3, v13
    s_cbranch_vccz Lsp_200016_ok
    s_sleep 2
    s_cmp_eq_u32 s46, 0
    s_cbranch_scc1 Lsp_200016_ok
    s_sub_u32 s46, s46, 1
    s_branch Lsp_200016
Lsp_200016_ok:
Lsp_200017:
    ds_read_b32 v13, v6 offset:0
    s_waitcnt lgkmcnt(0)
    v_cmp_gt_u32 vcc, 9, v13
    s_cbranch_vccz Lsp_200017_ok
    s_sleep 2
    s_cmp_eq_u32 s46, 0
    s_cbranch_scc1 Lsp_200017_ok
    s_sub_u32 s46, s46, 1
    s_branch Lsp_200017
Lsp_200017_ok:
L_pfb:
    buffer_load_dwordx2 v[128:129], v61, s[28:31], s56 offen sc1
    buffer_load_dwordx2 v[130:131], v62, s[28:31], s56 offen sc1
    buffer_load_dwordx2 v[132:133], v63, s[28:31], s56 offen sc1
    buffer_load_dwordx2 v[134:135], v53, s[28:31], s45 offen sc1
    buffer_load_dwordx2 v[136:137], v54, s[28:31], s61 offen sc1
    buffer_load_dwordx2 v[138:139], v54, s[28:31], s61 offen offset:1536 sc1
    s_waitcnt vmcnt(0)
    v_cmp_ne_u64 vcc, s[48:49], v[128:129]
    v_cmp_ne_u64 s[26:27], s[48:49], v[130:131]
    s_or_b64 vcc, vcc, s[26:27]
    v_cmp_ne_u64 s[26:27], s[48:49], v[132:133]
    s_or_b64 vcc, vcc, s[26:27]
    v_cmp_ne_u64 s[26:27], s[48:49], v[134:135]
    s_or_b64 vcc, vcc, s[26:27]
    v_cmp_ne_u64 s[26:27], s[48:49], v[136:137]
    s_or_b64 vcc, vcc, s[26:27]
    v_cmp_ne_u64 s[26:27], s[48:49], v[138:139]
    s_or_b64 vcc, vcc, s[26:27]
    s_cbranch_vccz L_pfb_ok
    s_sleep 8
    s_cmp_eq_u32 s46, 0
    s_cbranch_scc1 L_pfb_ok
    s_sub_u32 s46, s46, 1
    s_branch L_pfb
L_pfb_ok:
    v_mov_b32 v56, 8
    s_mov_b64 exec, 1
    ds_write_b32 v4, v56 offset:96
    s_mov_b64 exec, -1
Lsp_200018:
    ds_read_b32 v13, v6 offset:0
    s_waitcnt lgkmcnt(0)
    v_cmp_gt_u32 vcc, 9, v13
    s_cbranch_vccz Lsp_200018_ok
    s_sleep 2
    s_cmp_eq_u32 s46, 0
    s_cbranch_scc1 Lsp_200018_ok
    s_sub_u32 s46, s46, 1
    s_branch Lsp_200018
Lsp_200018_ok:
    s_mul_i32 s57, s43, 320
    s_add_u32 s57, s57, 32768
    s_mov_b64 exec, 0xfffff
    buffer_load_dwordx4 v[64:67], v2, s[28:31], s57 offen sc1
    s_add_u32 s57, s57, 2560
    buffer_load_dwordx4 v[68:71], v2, s[28:31], s57 offen sc1
    s_add_u32 s57, s57, 2560
    buffer_load_dwordx4 v[72:75], v2, s[28:31], s57 offen sc1
    s_add_u32 s57, s57, 2560
    buffer_load_dwordx4 v[76:79], v2, s[28:31], s57 offen sc1
    s_add_u32 s57, s57, 2560
    buffer_load_dwordx4 v[80:83], v2, s[28:31], s57 offen sc1
    s_add_u32 s57, s57, 2560
    buffer_load_dwordx4 v[84:87], v2, s[28:31], s57 offen sc1
    s_add_u32 s57, s57, 2560
    buffer_load_dwordx4 v[88:91], v2, s[28:31], s57 offen sc1
    s_add_u32 s57, s57, 2560
    buffer_load_dwordx4 v[92:95], v2, s[28:31], s57 offen sc1
    s_add_u32 s57, s57, 2560
    buffer_load_dwordx4 v[96:99], v2, s[28:31], s57 offen sc1
    s_add_u32 s57, s57, 2560
    buffer_load_dwordx4 v[100:103], v2, s[28:31], s57 offen sc1
    s_add_u32 s57, s57, 2560
    buffer_load_dwordx4 v[104:107], v2, s[28:31], s57 offen sc1
    s_add_u32 s57, s57, 2560
    buffer_load_dwordx4 v[108:111], v2, s[28:31], s57 offen sc1
    s_add_u32 s57, s57, 2560
    buffer_load_dwordx4 v[112:115], v2, s[28:31], s57 offen sc1
    s_add_u32 s57, s57, 2560
    buffer_load_dwordx4 v[116:119], v2, s[28:31], s57 offen sc1
    s_add_u32 s57, s57, 2560
    buffer_load_dwordx4 v[120:123], v2, s[28:31], s57 offen sc1
    s_add_u32 s57, s57, 2560
    buffer_load_dwordx4 v[124:127], v2, s[28:31], s57 offen sc1
    s_add_u32 s57, s57, 2560
    buffer_load_dwordx4 v[128:131], v2, s[28:31], s57 offen sc1
    s_add_u32 s57, s57, 2560
    buffer_load_dwordx4 v[132:135], v2, s[28:31], s57 offen sc1
    s_add_u32 s57, s57, 2560
    buffer_load_dwordx4 v[136:139], v2, s[28:31], s57 offen sc1
    s_add_u32 s57, s57, 2560
    buffer_load_dwordx4 v[140:143], v2, s[28:31], s57 offen sc1
    s_add_u32 s57, s57, 2560
    s_mul_i32 s57, s43, 768
    s_add_u32 s57, s57, 98304
    s_mov_b32 exec_lo, -1
    s_mov_b32 exec_hi, 0xffff
    buffer_load_dwordx4 v[144:147], v2, s[28:31], s57 offen sc1
    s_add_u32 s57, s57, 6144
    buffer_load_dwordx4 v[148:151], v2, s[28:31], s57 offen sc1
    s_add_u32 s57, s57, 6144
    buffer_load_dwordx4 v[152:155], v2, s[28:31], s57 offen sc1
    s_add_u32 s57, s57, 6144
    buffer_load_dwordx4 v[156:159], v2, s[28:31], s57 offen sc1
    s_add_u32 s57, s57, 6144
    buffer_load_dwordx4 v[160:163], v2, s[28:31], s57 offen sc1
    s_add_u32 s57, s57, 6144
    buffer_load_dwordx4 v[164:167], v2, s[28:31], s57 offen sc1
    s_add_u32 s57, s57, 6144
    buffer_load_dwordx4 v[168:171], v2, s[28:31], s57 offen sc1
    s_add_u32 s57, s57, 6144
    buffer_load_dwordx4 v[172:175], v2, s[28:31], s57 offen sc1
    s_add_u32 s57, s57, 6144
    buffer_load_dwordx4 v[176:179], v2, s[28:31], s57 offen sc1
    s_add_u32 s57, s57, 6144
    buffer_load_dwordx4 v[180:183], v2, s[28:31], s57 offen sc1
    s_add_u32 s57, s57, 6144
    buffer_load_dwordx4 v[184:187], v2, s[28:31], s57 offen sc1
    s_add_u32 s57, s57, 6144
    buffer_load_dwordx4 v[188:191], v2, s[28:31], s57 offen sc1
    s_add_u32 s57, s57, 6144
    buffer_load_dwordx4 v[192:195], v2, s[28:31], s57 offen sc1
    s_add_u32 s57, s57, 6144
    buffer_load_dwordx4 v[196:199], v2, s[28:31], s57 offen sc1
    s_add_u32 s57, s57, 6144
    buffer_load_dwordx4 v[200:203], v2, s[28:31], s57 offen sc1
    s_add_u32 s57, s57, 6144
    buffer_load_dwordx4 v[204:207], v2, s[28:31], s57 offen sc1
    s_add_u32 s57, s57, 6144
    buffer_load_dwordx4 v[208:211], v2, s[28:31], s57 offen sc1
    s_add_u32 s57, s57, 6144
    buffer_load_dwordx4 v[212:215], v2, s[28:31], s57 offen sc1
    s_add_u32 s57, s57, 6144
    buffer_load_dwordx4 v[216:219], v2, s[28:31], s57 offen sc1
    s_add_u32 s57, s57, 6144
    buffer_load_dwordx4 v[220:223], v2, s[28:31], s57 offen sc1
    s_add_u32 s57, s57, 6144
    s_waitcnt vmcnt(0)
    s_setprio 0
    v_add_f32 v144, v144, v148
    v_add_f32 v145, v145, v149
    v_add_f32 v146, v146, v150
    v_add_f32 v147, v147, v151
    v_add_f32 v144, v144, v152
    v_add_f32 v145, v145, v153
    v_add_f32 v146, v146, v154
    v_add_f32 v147, v147, v155
    v_add_f32 v144, v144, v156
    v_add_f32 v145, v145, v157
    v_add_f32 v146, v146, v158
    v_add_f32 v147, v147, v159
    v_add_f32 v144, v144, v160
    v_add_f32 v145, v145, v161
    v_add_f32 v146, v146, v162
    v_add_f32 v147, v147, v163
    v_add_f32 v144, v144, v164
    v_add_f32 v145, v145, v165
    v_add_f32 v146, v146, v166
    v_add_f32 v147, v147, v167
    v_add_f32 v144, v144, v168
    v_add_f32 v145, v145, v169
    v_add_f32 v146, v146, v170
    v_add_f32 v147, v147, v171
    v_add_f32 v144, v144, v172
    v_add_f32 v145, v145, v173
    v_add_f32 v146, v146, v174
    v_add_f32 v147, v147, v175
    v_add_f32 v144, v144, v176
    v_add_f32 v145, v145, v177
    v_add_f32 v146, v146, v178
    v_add_f32 v147, v147, v179
    v_add_f32 v144, v144, v180
    v_add_f32 v145, v145, v181
    v_add_f32 v146, v146, v182
    v_add_f32 v147, v147, v183
    v_add_f32 v144, v144, v184
    v_add_f32 v145, v145, v185
    v_add_f32 v146, v146, v186
    v_add_f32 v147, v147, v187
    v_add_f32 v144, v144, v188
    v_add_f32 v145, v145, v189
    v_add_f32 v146, v146, v190
    v_add_f32 v147, v147, v191
    v_add_f32 v144, v144, v192
    v_add_f32 v145, v145, v193
    v_add_f32 v146, v146, v194
    v_add_f32 v147, v147, v195
    v_add_f32 v144, v144, v196
    v_add_f32 v145, v145, v197
    v_add_f32 v146, v146, v198
    v_add_f32 v147, v147, v199
    v_add_f32 v144, v144, v200
    v_add_f32 v145, v145, v201
    v_add_f32 v146, v146, v202
    v_add_f32 v147, v147, v203
    v_add_f32 v144, v144, v204
    v_add_f32 v145, v145, v205
    v_add_f32 v146, v146, v206
    v_add_f32 v147, v147, v207
    v_add_f32 v144, v144, v208
    v_add_f32 v145, v145, v209
    v_add_f32 v146, v146, v210
    v_add_f32 v147, v147, v211
    v_add_f32 v144, v144, v212
    v_add_f32 v145, v145, v213
    v_add_f32 v146, v146, v214
    v_add_f32 v147, v147, v215
    v_add_f32 v144, v144, v216
    v_add_f32 v145, v145, v217
    v_add_f32 v146, v146, v218
    v_add_f32 v147, v147, v219
    v_add_f32 v144, v144, v220
    v_add_f32 v145, v145, v221
    v_add_f32 v146, v146, v222
    v_add_f32 v147, v147, v223
    v_add_u32 v228, 154176, v2
    ds_write_b128 v228, v[144:147]
    s_mov_b64 exec, 0xfffff
    v_add_f32 v64, v64, v68
    v_add_f32 v65, v65, v69
    v_add_f32 v66, v66, v70
    v_add_f32 v67, v67, v71
    v_add_f32 v64, v64, v72
    v_add_f32 v65, v65, v73
    v_add_f32 v66, v66, v74
    v_add_f32 v67, v67, v75
    v_add_f32 v64, v64, v76
    v_add_f32 v65, v65, v77
    v_add_f32 v66, v66, v78
    v_add_f32 v67, v67, v79
    v_add_f32 v64, v64, v80
    v_add_f32 v65, v65, v81
    v_add_f32 v66, v66, v82
    v_add_f32 v67, v67, v83
    v_add_f32 v64, v64, v84
    v_add_f32 v65, v65, v85
    v_add_f32 v66, v66, v86
    v_add_f32 v67, v67, v87
    v_add_f32 v64, v64, v88
    v_add_f32 v65, v65, v89
    v_add_f32 v66, v66, v90
    v_add_f32 v67, v67, v91
    v_add_f32 v64, v64, v92
    v_add_f32 v65, v65, v93
    v_add_f32 v66, v66, v94
    v_add_f32 v67, v67, v95
    v_add_f32 v64, v64, v96
    v_add_f32 v65, v65, v97
    v_add_f32 v66, v66, v98
    v_add_f32 v67, v67, v99
    v_add_f32 v64, v64, v100
    v_add_f32 v65, v65, v101
    v_add_f32 v66, v66, v102
    v_add_f32 v67, v67, v103
    v_add_f32 v64, v64, v104
    v_add_f32 v65, v65, v105
    v_add_f32 v66, v66, v106
    v_add_f32 v67, v67, v107
    v_add_f32 v64, v64, v108
    v_add_f32 v65, v65, v109
    v_add_f32 v66, v66, v110
    v_add_f32 v67, v67, v111
    v_add_f32 v64, v64, v112
    v_add_f32 v65, v65, v113
    v_add_f32 v66, v66, v114
    v_add_f32 v67, v67, v115
    v_add_f32 v64, v64, v116
    v_add_f32 v65, v65, v117
    v_add_f32 v66, v66, v118
    v_add_f32 v67, v67, v119
    v_add_f32 v64, v64, v120
    v_add_f32 v65, v65, v121
    v_add_f32 v66, v66, v122
    v_add_f32 v67, v67, v123
    v_add_f32 v64, v64, v124
    v_add_f32 v65, v65, v125
    v_add_f32 v66, v66, v126
    v_add_f32 v67, v67, v127
    v_add_f32 v64, v64, v128
    v_add_f32 v65, v65, v129
    v_add_f32 v66, v66, v130
    v_add_f32 v67, v67, v131
    v_add_f32 v64, v64, v132
    v_add_f32 v65, v65, v133
    v_add_f32 v66, v66, v134
    v_add_f32 v67, v67, v135
    v_add_f32 v64, v64, v136
    v_add_f32 v65, v65, v137
    v_add_f32 v66, v66, v138
    v_add_f32 v67, v67, v139
    v_add_f32 v64, v64, v140
    v_add_f32 v65, v65, v141
    v_add_f32 v66, v66, v142
    v_add_f32 v67, v67, v143
    v_add_u32 v228, 153856, v2
    ds_write_b128 v228, v[64:67]
    s_mov_b64 exec, -1
    v_mov_b32 v229, 2
    ds_write_b32 v4, v229 offset:44
    s_cmp_lg_u32 s2, 0
    s_cbranch_scc1 L_sv_end
    s_mov_b32 s57, 4096
L_ep:
    buffer_load_dwordx2 v[48:49], v2, s[28:31], s57 offen offset:0 sc1
    buffer_load_dwordx2 v[50:51], v2, s[28:31], s57 offen offset:1024 sc1
    buffer_load_dwordx2 v[52:53], v2, s[28:31], s57 offen offset:2048 sc1
    buffer_load_dwordx2 v[54:55], v2, s[28:31], s57 offen offset:3072 sc1
    s_waitcnt vmcnt(0)
    v_cmp_ne_u64 vcc, s[48:49], v[48:49]
    v_cmp_ne_u64 s[26:27], s[48:49], v[50:51]
    s_or_b64 vcc, vcc, s[26:27]
    v_cmp_ne_u64 s[26:27], s[48:49], v[52:53]
    s_or_b64 vcc, vcc, s[26:27]
    v_cmp_ne_u64 s[26:27], s[48:49], v[54:55]
    s_or_b64 vcc, vcc, s[26:27]
    s_cbranch_scc0 L_ep_ok
    s_sleep 4
    s_cmp_eq_u32 s46, 0
    s_cbranch_scc1 L_ep_ok
    s_sub_u32 s46, s46, 1
    s_branch L_ep
L_ep_ok:
    s_mov_b64 exec, 1
    buffer_store_dword v38, v35, s[28:31], 0 offen sc1
    s_mov_b64 exec, -1
L_sv_end:
    s_endpgm
Lw_5:
    ds_read_b32 v7, v6
    s_waitcnt lgkmcnt(0)
    v_cmp_gt_u32 s[22:23], 3, v7
    s_cmp_lg_u64 s[22:23], 0
    s_cbranch_scc0 Lw_5_ok
    s_cmp_eq_u32 s46, 0
    s_cbranch_scc1 Lw_5_ok
    s_sub_u32 s46, s46, 1
    s_branch Lw_5
Lw_6:
    ds_read_b32 v7, v6
    s_waitcnt lgkmcnt(0)
    v_cmp_gt_u32 s[22:23], 4, v7
    s_cmp_lg_u64 s[22:23], 0
    s_cbranch_scc0 Lw_6_ok
    s_cmp_eq_u32 s46, 0
    s_cbranch_scc1 Lw_6_ok
    s_sub_u32 s46, s46, 1
    s_branch Lw_6
Lw_7:
    ds_read_b32 v7, v6
    s_waitcnt lgkmcnt(0)
    v_cmp_gt_u32 s[22:23], 5, v7
    s_cmp_lg_u64 s[22:23], 0
    s_cbranch_scc0 Lw_7_ok
    s_cmp_eq_u32 s46, 0
    s_cbranch_scc1 Lw_7_ok
    s_sub_u32 s46, s46, 1
    s_branch Lw_7
Lw_8:
    ds_read_b32 v7, v6
    s_waitcnt lgkmcnt(0)
    v_cmp_gt_u32 s[22:23], 6, v7
    s_cmp_lg_u64 s[22:23], 0
    s_cbranch_scc0 Lw_8_ok
    s_cmp_eq_u32 s46, 0
    s_cbranch_scc1 Lw_8_ok
    s_sub_u32 s46, s46, 1
    s_branch Lw_8
Lw_9:
    ds_read_b32 v7, v6
    s_waitcnt lgkmcnt(0)
    v_cmp_gt_u32 s[22:23], 7, v7
    s_cmp_lg_u64 s[22:23], 0
    s_cbranch_scc0 Lw_9_ok
    s_cmp_eq_u32 s46, 0
    s_cbranch_scc1 Lw_9_ok
    s_sub_u32 s46, s46, 1
    s_branch Lw_9
Lw_10:
    ds_read_b32 v7, v6
    s_waitcnt lgkmcnt(0)
    v_cmp_gt_u32 s[22:23], 8, v7
    s_cmp_lg_u64 s[22:23], 0
    s_cbranch_scc0 Lw_10_ok
    s_cmp_eq_u32 s46, 0
    s_cbranch_scc1 Lw_10_ok
    s_sub_u32 s46, s46, 1
    s_branch Lw_10
Lo_11:
    s_nop 1
    s_add_u32 s57, s4, 0
    s_add_u32 s58, s57, 4096
    buffer_store_dwordx4 v[228:231], v2, s[28:31], s57 offen offset:0 sc1
    buffer_store_dwordx4 v[232:235], v2, s[28:31], s57 offen offset:1024 sc1
    buffer_store_dwordx4 v[236:239], v2, s[28:31], s57 offen offset:2048 sc1
    buffer_store_dwordx4 v[240:243], v2, s[28:31], s57 offen offset:3072 sc1
    buffer_store_dwordx4 v[244:247], v2, s[28:31], s58 offen offset:0 sc1
    s_nop 1
    s_branch Lo_11_b
Lw_12:
    ds_read_b32 v7, v6
    s_waitcnt lgkmcnt(0)
    v_cmp_gt_u32 s[22:23], 9, v7
    s_cmp_lg_u64 s[22:23], 0
    s_cbranch_scc0 Lw_12_ok
    s_cmp_eq_u32 s46, 0
    s_cbranch_scc1 Lw_12_ok
    s_sub_u32 s46, s46, 1
    s_branch Lw_12
Lw_13:
    ds_read_b32 v7, v6
    s_waitcnt lgkmcnt(0)
    v_cmp_gt_u32 s[22:23], 10, v7
    s_cmp_lg_u64 s[22:23], 0
    s_cbranch_scc0 Lw_13_ok
    s_cmp_eq_u32 s46, 0
    s_cbranch_scc1 Lw_13_ok
    s_sub_u32 s46, s46, 1
    s_branch Lw_13
Lw_14:
    ds_read_b32 v7, v6
    s_waitcnt lgkmcnt(0)
    v_cmp_gt_u32 s[22:23], 11, v7
    s_cmp_lg_u64 s[22:23], 0
    s_cbranch_scc0 Lw_14_ok
    s_cmp_eq_u32 s46, 0
    s_cbranch_scc1 Lw_14_ok
    s_sub_u32 s46, s46, 1
    s_branch Lw_14
Lw_15:
    ds_read_b32 v7, v6
    s_waitcnt lgkmcnt(0)
    v_cmp_gt_u32 s[22:23], 12, v7
    s_cmp_lg_u64 s[22:23], 0
    s_cbranch_scc0 Lw_15_ok
    s_cmp_eq_u32 s46, 0
    s_cbranch_scc1 Lw_15_ok
    s_sub_u32 s46, s46, 1
    s_branch Lw_15
Lw_16:
    ds_read_b32 v7, v6
    s_waitcnt lgkmcnt(0)
    v_cmp_gt_u32 s[22:23], 13, v7
    s_cmp_lg_u64 s[22:23], 0
    s_cbranch_scc0 Lw_16_ok
    s_cmp_eq_u32 s46, 0
    s_cbranch_scc1 Lw_16_ok
    s_sub_u32 s46, s46, 1
    s_branch Lw_16
Lo_17:
    s_nop 1
    s_add_u32 s57, s4, 5120
    s_add_u32 s58, s57, 4096
    buffer_store_dwordx4 v[228:231], v2, s[28:31], s57 offen offset:0 sc1
    buffer_store_dwordx4 v[232:235], v2, s[28:31], s57 offen offset:1024 sc1
    buffer_store_dwordx4 v[236:239], v2, s[28:31], s57 offen offset:2048 sc1
    buffer_store_dwordx4 v[240:243], v2, s[28:31], s57 offen offset:3072 sc1
    buffer_store_dwordx4 v[244:247], v2, s[28:31], s58 offen offset:0 sc1
    s_nop 1
    s_branch Lo_17_b
Lo_18:
    s_nop 1
    s_add_u32 s57, s4, 0
    s_add_u32 s58, s57, 4096
    buffer_load_dwordx4 v[196:199], v2, s[28:31], s57 offen offset:0 sc1
    buffer_load_dwordx4 v[200:203], v2, s[28:31], s57 offen offset:1024 sc1
    buffer_load_dwordx4 v[204:207], v2, s[28:31], s57 offen offset:2048 sc1
    buffer_load_dwordx4 v[208:211], v2, s[28:31], s57 offen offset:3072 sc1
    buffer_load_dwordx4 v[212:215], v2, s[28:31], s58 offen offset:0 sc1
    s_nop 1
    s_branch Lo_18_b
Lw_19:
    ds_read_b32 v7, v6
    s_waitcnt lgkmcnt(0)
    v_cmp_gt_u32 s[22:23], 14, v7
    s_cmp_lg_u64 s[22:23], 0
    s_cbranch_scc0 Lw_19_ok
    s_cmp_eq_u32 s46, 0
    s_cbranch_scc1 Lw_19_ok
    s_sub_u32 s46, s46, 1
    s_branch Lw_19
Lw_20:
    ds_read_b32 v7, v6
    s_waitcnt lgkmcnt(0)
    v_cmp_gt_u32 s[22:23], 15, v7
    s_cmp_lg_u64 s[22:23], 0
    s_cbranch_scc0 Lw_20_ok
    s_cmp_eq_u32 s46, 0
    s_cbranch_scc1 Lw_20_ok
    s_sub_u32 s46, s46, 1
    s_branch Lw_20
La_21:
    ds_read_b32 v26, v4 offset:40
    s_waitcnt lgkmcnt(0)
    v_cmp_gt_u32 vcc, 1, v26
    s_cbranch_vccz La_21_ok
    s_cmp_eq_u32 s46, 0
    s_cbranch_scc1 La_21_ok
    s_sub_u32 s46, s46, 1
    s_branch La_21
Lw_22:
    ds_read_b32 v7, v6
    s_waitcnt lgkmcnt(0)
    v_cmp_gt_u32 s[22:23], 16, v7
    s_cmp_lg_u64 s[22:23], 0
    s_cbranch_scc0 Lw_22_ok
    s_cmp_eq_u32 s46, 0
    s_cbranch_scc1 Lw_22_ok
    s_sub_u32 s46, s46, 1
    s_branch Lw_22
La_23:
    ds_read_b32 v25, v18 offset:0
    s_waitcnt lgkmcnt(0)
    v_cmp_gt_u32 vcc, 2, v25
    s_cbranch_vccz La_23_ok
    s_cmp_eq_u32 s46, 0
    s_cbranch_scc1 La_23_ok
    s_sub_u32 s46, s46, 1
    s_branch La_23
Lo_24:
    s_nop 1
    s_cmp_eq_u32 s44, 0
    s_cbranch_scc1 Lo_24_z
Lo_24_r:
    s_waitcnt vmcnt(0)
    v_cmp_ne_u64 vcc, s[48:49], v[198:199]
    v_cmp_ne_u64 s[26:27], s[48:49], v[202:203]
    s_or_b64 vcc, vcc, s[26:27]
    v_cmp_ne_u64 s[26:27], s[48:49], v[206:207]
    s_or_b64 vcc, vcc, s[26:27]
    v_cmp_ne_u64 s[26:27], s[48:49], v[210:211]
    s_or_b64 vcc, vcc, s[26:27]
    v_cmp_ne_u64 s[26:27], s[48:49], v[214:215]
    s_or_b64 vcc, vcc, s[26:27]
    s_cbranch_vccz Lo_24_ok
    s_cmp_eq_u32 s46, 0
    s_cbranch_scc1 Lo_24_ok
    s_sub_u32 s46, s46, 1
    s_add_u32 s57, s4, 0
    s_add_u32 s58, s57, 4096
    buffer_load_dwordx4 v[196:199], v2, s[28:31], s57 offen offset:0 sc1
    buffer_load_dwordx4 v[200:203], v2, s[28:31], s57 offen offset:1024 sc1
    buffer_load_dwordx4 v[204:207], v2, s[28:31], s57 offen offset:2048 sc1
    buffer_load_dwordx4 v[208:211], v2, s[28:31], s57 offen offset:3072 sc1
    buffer_load_dwordx4 v[212:215], v2, s[28:31], s58 offen offset:0 sc1
    s_branch Lo_24_r
Lo_24_z:
    s_waitcnt vmcnt(0)
    v_mov_b32 v196, 0
    v_mov_b32 v197, 0
    v_mov_b32 v200, 0
    v_mov_b32 v201, 0
    v_mov_b32 v204, 0
    v_mov_b32 v205, 0
    v_mov_b32 v208, 0
    v_mov_b32 v209, 0
    v_mov_b32 v212, 0
    v_mov_b32 v213, 0
Lo_24_ok:
    s_waitcnt lgkmcnt(0)
    v_mov_b32 v38, v196
    v_mov_b32 v39, v197
    v_mov_b32 v40, v200
    v_mov_b32 v41, v201
    v_mov_b32 v42, v204
    v_mov_b32 v43, v205
    v_mov_b32 v44, v208
    v_mov_b32 v45, v209
    v_mov_b32 v46, v212
    v_mov_b32 v47, v213
    s_add_u32 s57, s4, 5120
    s_add_u32 s58, s57, 4096
    buffer_load_dwordx4 v[196:199], v2, s[28:31], s57 offen offset:0 sc1
    buffer_load_dwordx4 v[200:203], v2, s[28:31], s57 offen offset:1024 sc1
    buffer_load_dwordx4 v[204:207], v2, s[28:31], s57 offen offset:2048 sc1
    buffer_load_dwordx4 v[208:211], v2, s[28:31], s57 offen offset:3072 sc1
    buffer_load_dwordx4 v[212:215], v2, s[28:31], s58 offen offset:0 sc1
    s_nop 1
    s_branch Lo_24_b
Lo_25:
    s_nop 1
    s_cmp_eq_u32 s44, 0
    s_cbranch_scc1 Lo_25_z
Lo_25_r:
    s_waitcnt vmcnt(0)
    v_cmp_ne_u64 vcc, s[48:49], v[198:199]
    v_cmp_ne_u64 s[26:27], s[48:49], v[202:203]
    s_or_b64 vcc, vcc, s[26:27]
    v_cmp_ne_u64 s[26:27], s[48:49], v[206:207]
    s_or_b64 vcc, vcc, s[26:27]
    v_cmp_ne_u64 s[26:27], s[48:49], v[210:211]
    s_or_b64 vcc, vcc, s[26:27]
    v_cmp_ne_u64 s[26:27], s[48:49], v[214:215]
    s_or_b64 vcc, vcc, s[26:27]
    s_cbranch_vccz Lo_25_ok
    s_cmp_eq_u32 s46, 0
    s_cbranch_scc1 Lo_25_ok
    s_sub_u32 s46, s46, 1
    s_add_u32 s57, s4, 5120
    s_add_u32 s58, s57, 4096
    buffer_load_dwordx4 v[196:199], v2, s[28:31], s57 offen offset:0 sc1
    buffer_load_dwordx4 v[200:203], v2, s[28:31], s57 offen offset:1024 sc1
    buffer_load_dwordx4 v[204:207], v2, s[28:31], s57 offen offset:2048 sc1
    buffer_load_dwordx4 v[208:211], v2, s[28:31], s57 offen offset:3072 sc1
    buffer_load_dwordx4 v[212:215], v2, s[28:31], s58 offen offset:0 sc1
    s_branch Lo_25_r
Lo_25_z:
    s_waitcnt vmcnt(0)
    v_mov_b32 v196, 0
    v_mov_b32 v197, 0
    v_mov_b32 v200, 0
    v_mov_b32 v201, 0
    v_mov_b32 v204, 0
    v_mov_b32 v205, 0
    v_mov_b32 v208, 0
    v_mov_b32 v209, 0
    v_mov_b32 v212, 0
    v_mov_b32 v213, 0
Lo_25_ok:
    s_waitcnt lgkmcnt(0)
    v_mov_b32 v230, v196
    v_mov_b32 v231, v197
    v_mov_b32 v234, v200
    v_mov_b32 v235, v201
    v_mov_b32 v238, v204
    v_mov_b32 v239, v205
    v_mov_b32 v242, v208
    v_mov_b32 v243, v209
    v_mov_b32 v246, v212
    v_mov_b32 v247, v213
    s_nop 1
    s_branch Lo_25_b
Lm_26:
    buffer_store_dwordx4 v[228:231], v2, s[28:31], s57 offen sc1
    buffer_store_dwordx4 v[232:235], v2, s[28:31], s57 offen offset:1024 sc1
    buffer_store_dwordx2 v[236:237], v3, s[28:31], s57 offen offset:2048 sc1
    s_branch Lm_26_b
Lm_27:
    buffer_store_dwordx2 v[12:13], v14, s[28:31], s57 offen sc1
    s_branch Lm_27_b
Lw_30:
    ds_read_b32 v7, v6
    s_waitcnt lgkmcnt(0)
    v_cmp_gt_u32 s[22:23], 19, v7
    s_cmp_lg_u64 s[22:23], 0
    s_cbranch_scc0 Lw_30_ok
    s_cmp_eq_u32 s46, 0
    s_cbranch_scc1 Lw_30_ok
    s_sub_u32 s46, s46, 1
    s_branch Lw_30
Lw_31:
    ds_read_b32 v7, v6
    s_waitcnt lgkmcnt(0)
    v_cmp_gt_u32 s[22:23], 20, v7
    s_cmp_lg_u64 s[22:23], 0
    s_cbranch_scc0 Lw_31_ok
    s_cmp_eq_u32 s46, 0
    s_cbranch_scc1 Lw_31_ok
    s_sub_u32 s46, s46, 1
    s_branch Lw_31
Lw_32:
    ds_read_b32 v7, v6
    s_waitcnt lgkmcnt(0)
    v_cmp_gt_u32 s[22:23], 21, v7
    s_cmp_lg_u64 s[22:23], 0
    s_cbranch_scc0 Lw_32_ok
    s_cmp_eq_u32 s46, 0
    s_cbranch_scc1 Lw_32_ok
    s_sub_u32 s46, s46, 1
    s_branch Lw_32
Lm_33:
    buffer_store_dwordx4 v[208:211], v2, s[28:31], s57 offen sc1
    buffer_store_dwordx4 v[212:215], v2, s[28:31], s57 offen offset:1024 sc1
    buffer_store_dwordx2 v[216:217], v3, s[28:31], s57 offen offset:2048 sc1
    s_branch Lm_33_b
Lm_34:
    buffer_store_dwordx4 v[240:243], v2, s[28:31], s57 offen sc1
    s_branch Lm_34_b
Lw_38:
    ds_read_b32 v7, v6
    s_waitcnt lgkmcnt(0)
    v_cmp_gt_u32 s[22:23], 23, v7
    s_cmp_lg_u64 s[22:23], 0
    s_cbranch_scc0 Lw_38_ok
    s_cmp_eq_u32 s46, 0
    s_cbranch_scc1 Lw_38_ok
    s_sub_u32 s46, s46, 1
    s_branch Lw_38
Lw_39:
    ds_read_b32 v7, v6
    s_waitcnt lgkmcnt(0)
    v_cmp_gt_u32 s[22:23], 24, v7
    s_cmp_lg_u64 s[22:23], 0
    s_cbranch_scc0 Lw_39_ok
    s_cmp_eq_u32 s46, 0
    s_cbranch_scc1 Lw_39_ok
    s_sub_u32 s46, s46, 1
    s_branch Lw_39
Lw_40:
    ds_read_b32 v7, v6
    s_waitcnt lgkmcnt(0)
    v_cmp_gt_u32 s[22:23], 25, v7
    s_cmp_lg_u64 s[22:23], 0
    s_cbranch_scc0 Lw_40_ok
    s_cmp_eq_u32 s46, 0
    s_cbranch_scc1 Lw_40_ok
    s_sub_u32 s46, s46, 1
    s_branch Lw_40
Lm_41:
    buffer_store_dwordx4 v[228:231], v2, s[28:31], s57 offen sc1
    buffer_store_dwordx4 v[232:235], v2, s[28:31], s57 offen offset:1024 sc1
    buffer_store_dwordx2 v[236:237], v3, s[28:31], s57 offen offset:2048 sc1
    s_branch Lm_41_b
Lm_43:
    buffer_store_dwordx2 v[12:13], v14, s[28:31], s57 offen sc1
    s_branch Lm_43_b
Lsh_42:
    s_bitcmp1_b32 s43, 1
    s_mov_b32 s70, 0xc000c000
    s_cselect_b32 s70, 0x00030003, s70
    s_mov_b32 s71, s70
    s_add_u32 s57, s56, 90112
    s_mov_b64 exec, s[70:71]
    buffer_store_dwordx4 v[228:231], v2, s[28:31], s57 offen sc1
    buffer_store_dwordx4 v[232:235], v2, s[28:31], s57 offen offset:1024 sc1
    buffer_store_dwordx2 v[236:237], v3, s[28:31], s57 offen offset:2048 sc1
    s_lshl_b32 s57, s43, 3
    s_add_u32 s57, s57, s55
    s_add_u32 s57, s57, 110720
    s_mov_b64 exec, 1
    s_waitcnt vmcnt(3)
    s_cmp_lg_u32 s50, 1
    s_cbranch_scc1 Lsh_42_s
    buffer_store_dwordx2 v[12:13], v14, s[28:31], s57 offen
    s_branch Lsh_42_t
Lsh_42_s:
    buffer_store_dwordx2 v[12:13], v14, s[28:31], s57 offen sc1
Lsh_42_t:
    s_waitcnt vmcnt(1)
    buffer_store_dwordx2 v[12:13], v14, s[28:31], s57 offen offset:128 sc1
    s_mov_b64 exec, -1
    s_branch Lsh_42_b
Lw_46:
    ds_read_b32 v7, v6
    s_waitcnt lgkmcnt(0)
    v_cmp_gt_u32 s[22:23], 27, v7
    s_cmp_lg_u64 s[22:23], 0
    s_cbranch_scc0 Lw_46_ok
    s_cmp_eq_u32 s46, 0
    s_cbranch_scc1 Lw_46_ok
    s_sub_u32 s46, s46, 1
    s_branch Lw_46
Lw_47:
    ds_read_b32 v7, v6
    s_waitcnt lgkmcnt(0)
    v_cmp_gt_u32 s[22:23], 28, v7
    s_cmp_lg_u64 s[22:23], 0
    s_cbranch_scc0 Lw_47_ok
    s_cmp_eq_u32 s46, 0
    s_cbranch_scc1 Lw_47_ok
    s_sub_u32 s46, s46, 1
    s_branch Lw_47
Lw_48:
    ds_read_b32 v7, v6
    s_waitcnt lgkmcnt(0)
    v_cmp_gt_u32 s[22:23], 29, v7
    s_cmp_lg_u64 s[22:23], 0
    s_cbranch_scc0 Lw_48_ok
    s_cmp_eq_u32 s46, 0
    s_cbranch_scc1 Lw_48_ok
    s_sub_u32 s46, s46, 1
    s_branch Lw_48
Lm_49:
    buffer_store_dwordx4 v[218:221], v2, s[28:31], s57 offen sc1
    buffer_store_dwordx4 v[222:225], v2, s[28:31], s57 offen offset:1024 sc1
    buffer_store_dwordx2 v[226:227], v3, s[28:31], s57 offen offset:2048 sc1
    s_branch Lm_49_b
Lm_50:
    buffer_store_dwordx4 v[240:243], v2, s[28:31], s57 offen sc1
    s_branch Lm_50_b
Lw_53:
    ds_read_b32 v7, v6
    s_waitcnt lgkmcnt(0)
    v_cmp_gt_u32 s[22:23], 31, v7
    s_cmp_lg_u64 s[22:23], 0
    s_cbranch_scc0 Lw_53_ok
    s_cmp_eq_u32 s46, 0
    s_cbranch_scc1 Lw_53_ok
    s_sub_u32 s46, s46, 1
    s_branch Lw_53
Lw_54:
    ds_read_b32 v7, v6
    s_waitcnt lgkmcnt(0)
    v_cmp_gt_u32 s[22:23], 32, v7
    s_cmp_lg_u64 s[22:23], 0
    s_cbranch_scc0 Lw_54_ok
    s_cmp_eq_u32 s46, 0
    s_cbranch_scc1 Lw_54_ok
    s_sub_u32 s46, s46, 1
    s_branch Lw_54
Lw_55:
    ds_read_b32 v7, v6
    s_waitcnt lgkmcnt(0)
    v_cmp_gt_u32 s[22:23], 33, v7
    s_cmp_lg_u64 s[22:23], 0
    s_cbranch_scc0 Lw_55_ok
    s_cmp_eq_u32 s46, 0
    s_cbranch_scc1 Lw_55_ok
    s_sub_u32 s46, s46, 1
    s_branch Lw_55
Lw_56:
    ds_read_b32 v7, v6
    s_waitcnt lgkmcnt(0)
    v_cmp_gt_u32 s[22:23], 34, v7
    s_cmp_lg_u64 s[22:23], 0
    s_cbranch_scc0 Lw_56_ok
    s_cmp_eq_u32 s46, 0
    s_cbranch_scc1 Lw_56_ok
    s_sub_u32 s46, s46, 1
    s_branch Lw_56
Lw_57:
    ds_read_b32 v7, v6
    s_waitcnt lgkmcnt(0)
    v_cmp_gt_u32 s[22:23], 35, v7
    s_cmp_lg_u64 s[22:23], 0
    s_cbranch_scc0 Lw_57_ok
    s_cmp_eq_u32 s46, 0
    s_cbranch_scc1 Lw_57_ok
    s_sub_u32 s46, s46, 1
    s_branch Lw_57
Lw_58:
    ds_read_b32 v7, v6
    s_waitcnt lgkmcnt(0)
    v_cmp_gt_u32 s[22:23], 36, v7
    s_cmp_lg_u64 s[22:23], 0
    s_cbranch_scc0 Lw_58_ok
    s_cmp_eq_u32 s46, 0
    s_cbranch_scc1 Lw_58_ok
    s_sub_u32 s46, s46, 1
    s_branch Lw_58
Lw_59:
    ds_read_b32 v7, v6
    s_waitcnt lgkmcnt(0)
    v_cmp_gt_u32 s[22:23], 37, v7
    s_cmp_lg_u64 s[22:23], 0
    s_cbranch_scc0 Lw_59_ok
    s_cmp_eq_u32 s46, 0
    s_cbranch_scc1 Lw_59_ok
    s_sub_u32 s46, s46, 1
    s_branch Lw_59
Lm_60:
    buffer_store_dwordx4 v[228:231], v2, s[28:31], s57 offen sc1
    buffer_store_dwordx4 v[232:235], v2, s[28:31], s57 offen offset:1024 sc1
    s_branch Lm_60_b
Lw_61:
    ds_read_b32 v7, v6
    s_waitcnt lgkmcnt(0)
    v_cmp_gt_u32 s[22:23], 38, v7
    s_cmp_lg_u64 s[22:23], 0
    s_cbranch_scc0 Lw_61_ok
    s_cmp_eq_u32 s46, 0
    s_cbranch_scc1 Lw_61_ok
    s_sub_u32 s46, s46, 1
    s_branch Lw_61
Lm_62:
    buffer_store_dwordx2 v[12:13], v14, s[28:31], s57 offen sc1
    s_branch Lm_62_b
Lw_63:
    ds_read_b32 v7, v6
    s_waitcnt lgkmcnt(0)
    v_cmp_gt_u32 s[22:23], 39, v7
    s_cmp_lg_u64 s[22:23], 0
    s_cbranch_scc0 Lw_63_ok
    s_cmp_eq_u32 s46, 0
    s_cbranch_scc1 Lw_63_ok
    s_sub_u32 s46, s46, 1
    s_branch Lw_63
Lw_64:
    ds_read_b32 v7, v6
    s_waitcnt lgkmcnt(0)
    v_cmp_gt_u32 s[22:23], 40, v7
    s_cmp_lg_u64 s[22:23], 0
    s_cbranch_scc0 Lw_64_ok
    s_cmp_eq_u32 s46, 0
    s_cbranch_scc1 Lw_64_ok
    s_sub_u32 s46, s46, 1
    s_branch Lw_64
Lg_65:
    s_mov_b32 s58, 110976
    buffer_load_dwordx2 v[244:245], v20, s[28:31], s58 offen sc1
    s_waitcnt vmcnt(0)
    v_cmp_ne_u64 vcc, s[48:49], v[244:245]
    s_cbranch_vccz Lg_65_ok
    s_cmp_eq_u32 s46, 0
    s_cbranch_scc1 Lg_65_ok
    s_sub_u32 s46, s46, 1
    s_branch Lg_65
Lw_66:
    ds_read_b32 v7, v6
    s_waitcnt lgkmcnt(0)
    v_cmp_gt_u32 s[22:23], 41, v7
    s_cmp_lg_u64 s[22:23], 0
    s_cbranch_scc0 Lw_66_ok
    s_cmp_eq_u32 s46, 0
    s_cbranch_scc1 Lw_66_ok
    s_sub_u32 s46, s46, 1
    s_branch Lw_66
Lm_67:
    buffer_store_dwordx4 v[228:231], v2, s[28:31], s57 offen sc1
    buffer_store_dwordx4 v[232:235], v2, s[28:31], s57 offen offset:1024 sc1
    s_branch Lm_67_b
Lw_68:
    ds_read_b32 v7, v6
    s_waitcnt lgkmcnt(0)
    v_cmp_gt_u32 s[22:23], 42, v7
    s_cmp_lg_u64 s[22:23], 0
    s_cbranch_scc0 Lw_68_ok
    s_cmp_eq_u32 s46, 0
    s_cbranch_scc1 Lw_68_ok
    s_sub_u32 s46, s46, 1
    s_branch Lw_68
Lm_69:
    buffer_store_dwordx2 v[12:13], v14, s[28:31], s57 offen sc1
    s_branch Lm_69_b
Lw_70:
    ds_read_b32 v7, v6
    s_waitcnt lgkmcnt(0)
    v_cmp_gt_u32 s[22:23], 43, v7
    s_cmp_lg_u64 s[22:23], 0
    s_cbranch_scc0 Lw_70_ok
    s_cmp_eq_u32 s46, 0
    s_cbranch_scc1 Lw_70_ok
    s_sub_u32 s46, s46, 1
    s_branch Lw_70
Lw_71:
    ds_read_b32 v7, v6
    s_waitcnt lgkmcnt(0)
    v_cmp_gt_u32 s[22:23], 44, v7
    s_cmp_lg_u64 s[22:23], 0
    s_cbranch_scc0 Lw_71_ok
    s_cmp_eq_u32 s46, 0
    s_cbranch_scc1 Lw_71_ok
    s_sub_u32 s46, s46, 1
    s_branch Lw_71
Lg_72:
    s_mov_b32 s58, 111104
    buffer_load_dwordx2 v[244:245], v20, s[28:31], s58 offen sc1
    s_waitcnt vmcnt(0)
    v_cmp_ne_u64 vcc, s[48:49], v[244:245]
    s_cbranch_vccz Lg_72_ok
    s_cmp_eq_u32 s46, 0
    s_cbranch_scc1 Lg_72_ok
    s_sub_u32 s46, s46, 1
    s_branch Lg_72
Lw_73:
    ds_read_b32 v7, v6
    s_waitcnt lgkmcnt(0)
    v_cmp_gt_u32 s[22:23], 45, v7
    s_cmp_lg_u64 s[22:23], 0
    s_cbranch_scc0 Lw_73_ok
    s_cmp_eq_u32 s46, 0
    s_cbranch_scc1 Lw_73_ok
    s_sub_u32 s46, s46, 1
    s_branch Lw_73
Lm_74:
    buffer_store_dwordx4 v[228:231], v2, s[28:31], s57 offen sc1
    buffer_store_dwordx4 v[232:235], v2, s[28:31], s57 offen offset:1024 sc1
    s_branch Lm_74_b
Lw_75:
    ds_read_b32 v7, v6
    s_waitcnt lgkmcnt(0)
    v_cmp_gt_u32 s[22:23], 46, v7
    s_cmp_lg_u64 s[22:23], 0
    s_cbranch_scc0 Lw_75_ok
    s_cmp_eq_u32 s46, 0
    s_cbranch_scc1 Lw_75_ok
    s_sub_u32 s46, s46, 1
    s_branch Lw_75
Lm_76:
    buffer_store_dwordx2 v[12:13], v14, s[28:31], s57 offen sc1
    s_branch Lm_76_b
Lw_77:
    ds_read_b32 v7, v6
    s_waitcnt lgkmcnt(0)
    v_cmp_gt_u32 s[22:23], 47, v7
    s_cmp_lg_u64 s[22:23], 0
    s_cbranch_scc0 Lw_77_ok
    s_cmp_eq_u32 s46, 0
    s_cbranch_scc1 Lw_77_ok
    s_sub_u32 s46, s46, 1
    s_branch Lw_77
Lw_78:
    ds_read_b32 v7, v6
    s_waitcnt lgkmcnt(0)
    v_cmp_gt_u32 s[22:23], 48, v7
    s_cmp_lg_u64 s[22:23], 0
    s_cbranch_scc0 Lw_78_ok
    s_cmp_eq_u32 s46, 0
    s_cbranch_scc1 Lw_78_ok
    s_sub_u32 s46, s46, 1
    s_branch Lw_78
Lw_79:
    ds_read_b32 v7, v6
    s_waitcnt lgkmcnt(0)
    v_cmp_gt_u32 s[22:23], 49, v7
    s_cmp_lg_u64 s[22:23], 0
    s_cbranch_scc0 Lw_79_ok
    s_cmp_eq_u32 s46, 0
    s_cbranch_scc1 Lw_79_ok
    s_sub_u32 s46, s46, 1
    s_branch Lw_79
Lg_80:
    s_mov_b32 s58, 111232
    buffer_load_dwordx2 v[244:245], v20, s[28:31], s58 offen sc1
    s_waitcnt vmcnt(0)
    v_cmp_ne_u64 vcc, s[48:49], v[244:245]
    s_cbranch_vccz Lg_80_ok
    s_cmp_eq_u32 s46, 0
    s_cbranch_scc1 Lg_80_ok
    s_sub_u32 s46, s46, 1
    s_branch Lg_80
Lw_81:
    ds_read_b32 v7, v6
    s_waitcnt lgkmcnt(0)
    v_cmp_gt_u32 s[22:23], 50, v7
    s_cmp_lg_u64 s[22:23], 0
    s_cbranch_scc0 Lw_81_ok
    s_cmp_eq_u32 s46, 0
    s_cbranch_scc1 Lw_81_ok
    s_sub_u32 s46, s46, 1
    s_branch Lw_81
Lw_82:
    ds_read_b32 v7, v6
    s_waitcnt lgkmcnt(0)
    v_cmp_gt_u32 s[22:23], 51, v7
    s_cmp_lg_u64 s[22:23], 0
    s_cbranch_scc0 Lw_82_ok
    s_cmp_eq_u32 s46, 0
    s_cbranch_scc1 Lw_82_ok
    s_sub_u32 s46, s46, 1
    s_branch Lw_82
Lw_83:
    ds_read_b32 v7, v6
    s_waitcnt lgkmcnt(0)
    v_cmp_gt_u32 s[22:23], 52, v7
    s_cmp_lg_u64 s[22:23], 0
    s_cbranch_scc0 Lw_83_ok
    s_cmp_eq_u32 s46, 0
    s_cbranch_scc1 Lw_83_ok
    s_sub_u32 s46, s46, 1
    s_branch Lw_83
Lw_84:
    ds_read_b32 v7, v6
    s_waitcnt lgkmcnt(0)
    v_cmp_gt_u32 s[22:23], 53, v7
    s_cmp_lg_u64 s[22:23], 0
    s_cbranch_scc0 Lw_84_ok
    s_cmp_eq_u32 s46, 0
    s_cbranch_scc1 Lw_84_ok
    s_sub_u32 s46, s46, 1
    s_branch Lw_84
Lf_97:
    ds_read_b32 v13, v4 offset:96
    s_waitcnt lgkmcnt(0)
    v_cmp_gt_u32 vcc, 1, v13
    s_cbranch_vccz Lf_97_ok
Lsp_100001:
    ds_read_b32 v13, v4 offset:96
    s_waitcnt lgkmcnt(0)
    v_cmp_gt_u32 vcc, 1, v13
    s_cbranch_vccz Lsp_100001_ok
    s_sleep 1
    s_cmp_eq_u32 s46, 0
    s_cbranch_scc1 Lsp_100001_ok
    s_sub_u32 s46, s46, 1
    s_branch Lsp_100001
Lsp_100001_ok:
    s_branch Lf_97_ok
Lf_98:
    ds_read_b32 v13, v12 offset:0
    s_waitcnt lgkmcnt(0)
    v_cmp_gt_u32 vcc, 1, v13
    s_cbranch_vccz Lf_98_ok
Lsp_100002:
    ds_read_b32 v13, v12 offset:0
    s_waitcnt lgkmcnt(0)
    v_cmp_gt_u32 vcc, 1, v13
    s_cbranch_vccz Lsp_100002_ok
    s_sleep 2
    s_cmp_eq_u32 s46, 0
    s_cbranch_scc1 Lsp_100002_ok
    s_sub_u32 s46, s46, 1
    s_branch Lsp_100002
Lsp_100002_ok:
    s_branch Lf_98_ok
Lf_99:
    ds_read_b32 v13, v12 offset:0
    s_waitcnt lgkmcnt(0)
    v_cmp_gt_u32 vcc, 2, v13
    s_cbranch_vccz Lf_99_ok
Lsp_100003:
    ds_read_b32 v13, v12 offset:0
    s_waitcnt lgkmcnt(0)
    v_cmp_gt_u32 vcc, 2, v13
    s_cbranch_vccz Lsp_100003_ok
    s_sleep 2
    s_cmp_eq_u32 s46, 0
    s_cbranch_scc1 Lsp_100003_ok
    s_sub_u32 s46, s46, 1
    s_branch Lsp_100003
Lsp_100003_ok:
    s_branch Lf_99_ok
Lf_100:
    ds_read_b32 v13, v12 offset:0
    s_waitcnt lgkmcnt(0)
    v_cmp_gt_u32 vcc, 4, v13
    s_cbranch_vccz Lf_100_ok
Lsp_100004:
    ds_read_b32 v13, v12 offset:0
    s_waitcnt lgkmcnt(0)
    v_cmp_gt_u32 vcc, 4, v13
    s_cbranch_vccz Lsp_100004_ok
    s_sleep 2
    s_cmp_eq_u32 s46, 0
    s_cbranch_scc1 Lsp_100004_ok
    s_sub_u32 s46, s46, 1
    s_branch Lsp_100004
Lsp_100004_ok:
    s_branch Lf_100_ok
Lf_101:
    ds_read_b32 v13, v12 offset:0
    s_waitcnt lgkmcnt(0)
    v_cmp_gt_u32 vcc, 6, v13
    s_cbranch_vccz Lf_101_ok
Lsp_100005:
    ds_read_b32 v13, v12 offset:0
    s_waitcnt lgkmcnt(0)
    v_cmp_gt_u32 vcc, 6, v13
    s_cbranch_vccz Lsp_100005_ok
    s_sleep 2
    s_cmp_eq_u32 s46, 0
    s_cbranch_scc1 Lsp_100005_ok
    s_sub_u32 s46, s46, 1
    s_branch Lsp_100005
Lsp_100005_ok:
    s_branch Lf_101_ok
Lf_102:
    ds_read_b32 v13, v12 offset:0
    s_waitcnt lgkmcnt(0)
    v_cmp_gt_u32 vcc, 8, v13
    s_cbranch_vccz Lf_102_ok
Lsp_100006:
    ds_read_b32 v13, v12 offset:0
    s_waitcnt lgkmcnt(0)
    v_cmp_gt_u32 vcc, 8, v13
    s_cbranch_vccz Lsp_100006_ok
    s_sleep 2
    s_cmp_eq_u32 s46, 0
    s_cbranch_scc1 Lsp_100006_ok
    s_sub_u32 s46, s46, 1
    s_branch Lsp_100006
Lsp_100006_ok:
    s_branch Lf_102_ok
Lf_103:
    ds_read_b32 v13, v12 offset:0
    s_waitcnt lgkmcnt(0)
    v_cmp_gt_u32 vcc, 10, v13
    s_cbranch_vccz Lf_103_ok
Lsp_100007:
    ds_read_b32 v13, v12 offset:0
    s_waitcnt lgkmcnt(0)
    v_cmp_gt_u32 vcc, 10, v13
    s_cbranch_vccz Lsp_100007_ok
    s_sleep 2
    s_cmp_eq_u32 s46, 0
    s_cbranch_scc1 Lsp_100007_ok
    s_sub_u32 s46, s46, 1
    s_branch Lsp_100007
Lsp_100007_ok:
    s_branch Lf_103_ok
Lf_104:
    ds_read_b32 v13, v12 offset:0
    s_waitcnt lgkmcnt(0)
    v_cmp_gt_u32 vcc, 12, v13
    s_cbranch_vccz Lf_104_ok
Lsp_100008:
    ds_read_b32 v13, v12 offset:0
    s_waitcnt lgkmcnt(0)
    v_cmp_gt_u32 vcc, 12, v13
    s_cbranch_vccz Lsp_100008_ok
    s_sleep 2
    s_cmp_eq_u32 s46, 0
    s_cbranch_scc1 Lsp_100008_ok
    s_sub_u32 s46, s46, 1
    s_branch Lsp_100008
Lsp_100008_ok:
    s_branch Lf_104_ok
Lf_105:
    ds_read_b32 v13, v4 offset:96
    s_waitcnt lgkmcnt(0)
    v_cmp_gt_u32 vcc, 4, v13
    s_cbranch_vccz Lf_105_ok
Lsp_100009:
    ds_read_b32 v13, v4 offset:96
    s_waitcnt lgkmcnt(0)
    v_cmp_gt_u32 vcc, 4, v13
    s_cbranch_vccz Lsp_100009_ok
    s_sleep 1
    s_cmp_eq_u32 s46, 0
    s_cbranch_scc1 Lsp_100009_ok
    s_sub_u32 s46, s46, 1
    s_branch Lsp_100009
Lsp_100009_ok:
    s_branch Lf_105_ok
Lf_106:
    ds_read_b32 v13, v12 offset:0
    s_waitcnt lgkmcnt(0)
    v_cmp_gt_u32 vcc, 14, v13
    s_cbranch_vccz Lf_106_ok
Lsp_100010:
    ds_read_b32 v13, v12 offset:0
    s_waitcnt lgkmcnt(0)
    v_cmp_gt_u32 vcc, 14, v13
    s_cbranch_vccz Lsp_100010_ok
    s_sleep 2
    s_cmp_eq_u32 s46, 0
    s_cbranch_scc1 Lsp_100010_ok
    s_sub_u32 s46, s46, 1
    s_branch Lsp_100010
Lsp_100010_ok:
    s_branch Lf_106_ok
Lf_107:
    ds_read_b32 v13, v12 offset:0
    s_waitcnt lgkmcnt(0)
    v_cmp_gt_u32 vcc, 16, v13
    s_cbranch_vccz Lf_107_ok
Lsp_100011:
    ds_read_b32 v13, v12 offset:0
    s_waitcnt lgkmcnt(0)
    v_cmp_gt_u32 vcc, 16, v13
    s_cbranch_vccz Lsp_100011_ok
    s_sleep 2
    s_cmp_eq_u32 s46, 0
    s_cbranch_scc1 Lsp_100011_ok
    s_sub_u32 s46, s46, 1
    s_branch Lsp_100011
Lsp_100011_ok:
    s_branch Lf_107_ok
Lf_108:
    ds_read_b32 v13, v12 offset:0
    s_waitcnt lgkmcnt(0)
    v_cmp_gt_u32 vcc, 17, v13
    s_cbranch_vccz Lf_108_ok
Lsp_100012:
    ds_read_b32 v13, v12 offset:0
    s_waitcnt lgkmcnt(0)
    v_cmp_gt_u32 vcc, 17, v13
    s_cbranch_vccz Lsp_100012_ok
    s_sleep 2
    s_cmp_eq_u32 s46, 0
    s_cbranch_scc1 Lsp_100012_ok
    s_sub_u32 s46, s46, 1
    s_branch Lsp_100012
Lsp_100012_ok:
    s_branch Lf_108_ok
Lf_109:
    ds_read_b32 v13, v12 offset:0
    s_waitcnt lgkmcnt(0)
    v_cmp_gt_u32 vcc, 18, v13
    s_cbranch_vccz Lf_109_ok
Lsp_100013:
    ds_read_b32 v13, v12 offset:0
    s_waitcnt lgkmcnt(0)
    v_cmp_gt_u32 vcc, 18, v13
    s_cbranch_vccz Lsp_100013_ok
    s_sleep 2
    s_cmp_eq_u32 s46, 0
    s_cbranch_scc1 Lsp_100013_ok
    s_sub_u32 s46, s46, 1
    s_branch Lsp_100013
Lsp_100013_ok:
    s_branch Lf_109_ok
Lf_110:
    ds_read_b32 v13, v12 offset:0
    s_waitcnt lgkmcnt(0)
    v_cmp_gt_u32 vcc, 20, v13
    s_cbranch_vccz Lf_110_ok
Lsp_100014:
    ds_read_b32 v13, v12 offset:0
    s_waitcnt lgkmcnt(0)
    v_cmp_gt_u32 vcc, 20, v13
    s_cbranch_vccz Lsp_100014_ok
    s_sleep 2
    s_cmp_eq_u32 s46, 0
    s_cbranch_scc1 Lsp_100014_ok
    s_sub_u32 s46, s46, 1
    s_branch Lsp_100014
Lsp_100014_ok:
    s_branch Lf_110_ok
Lf_111:
    ds_read_b32 v13, v12 offset:0
    s_waitcnt lgkmcnt(0)
    v_cmp_gt_u32 vcc, 22, v13
    s_cbranch_vccz Lf_111_ok
Lsp_100015:
    ds_read_b32 v13, v12 offset:0
    s_waitcnt lgkmcnt(0)
    v_cmp_gt_u32 vcc, 22, v13
    s_cbranch_vccz Lsp_100015_ok
    s_sleep 2
    s_cmp_eq_u32 s46, 0
    s_cbranch_scc1 Lsp_100015_ok
    s_sub_u32 s46, s46, 1
    s_branch Lsp_100015
Lsp_100015_ok:
    s_branch Lf_111_ok
Lf_112:
    ds_read_b32 v13, v12 offset:0
    s_waitcnt lgkmcnt(0)
    v_cmp_gt_u32 vcc, 24, v13
    s_cbranch_vccz Lf_112_ok
Lsp_100016:
    ds_read_b32 v13, v12 offset:0
    s_waitcnt lgkmcnt(0)
    v_cmp_gt_u32 vcc, 24, v13
    s_cbranch_vccz Lsp_100016_ok
    s_sleep 2
    s_cmp_eq_u32 s46, 0
    s_cbranch_scc1 Lsp_100016_ok
    s_sub_u32 s46, s46, 1
    s_branch Lsp_100016
Lsp_100016_ok:
    s_branch Lf_112_ok
Lf_113:
    ds_read_b32 v13, v12 offset:0
    s_waitcnt lgkmcnt(0)
    v_cmp_gt_u32 vcc, 26, v13
    s_cbranch_vccz Lf_113_ok
Lsp_100017:
    ds_read_b32 v13, v12 offset:0
    s_waitcnt lgkmcnt(0)
    v_cmp_gt_u32 vcc, 26, v13
    s_cbranch_vccz Lsp_100017_ok
    s_sleep 2
    s_cmp_eq_u32 s46, 0
    s_cbranch_scc1 Lsp_100017_ok
    s_sub_u32 s46, s46, 1
    s_branch Lsp_100017
Lsp_100017_ok:
    s_branch Lf_113_ok
Lf_114:
    ds_read_b32 v13, v12 offset:0
    s_waitcnt lgkmcnt(0)
    v_cmp_gt_u32 vcc, 28, v13
    s_cbranch_vccz Lf_114_ok
Lsp_100018:
    ds_read_b32 v13, v12 offset:0
    s_waitcnt lgkmcnt(0)
    v_cmp_gt_u32 vcc, 28, v13
    s_cbranch_vccz Lsp_100018_ok
    s_sleep 2
    s_cmp_eq_u32 s46, 0
    s_cbranch_scc1 Lsp_100018_ok
    s_sub_u32 s46, s46, 1
    s_branch Lsp_100018
Lsp_100018_ok:
    s_branch Lf_114_ok
Lf_115:
    ds_read_b32 v13, v12 offset:0
    s_waitcnt lgkmcnt(0)
    v_cmp_gt_u32 vcc, 30, v13
    s_cbranch_vccz Lf_115_ok
Lsp_100019:
    ds_read_b32 v13, v12 offset:0
    s_waitcnt lgkmcnt(0)
    v_cmp_gt_u32 vcc, 30, v13
    s_cbranch_vccz Lsp_100019_ok
    s_sleep 2
    s_cmp_eq_u32 s46, 0
    s_cbranch_scc1 Lsp_100019_ok
    s_sub_u32 s46, s46, 1
    s_branch Lsp_100019
Lsp_100019_ok:
    s_branch Lf_115_ok
Lf_116:
    ds_read_b32 v13, v12 offset:0
    s_waitcnt lgkmcnt(0)
    v_cmp_gt_u32 vcc, 32, v13
    s_cbranch_vccz Lf_116_ok
Lsp_100020:
    ds_read_b32 v13, v12 offset:0
    s_waitcnt lgkmcnt(0)
    v_cmp_gt_u32 vcc, 32, v13
    s_cbranch_vccz Lsp_100020_ok
    s_sleep 2
    s_cmp_eq_u32 s46, 0
    s_cbranch_scc1 Lsp_100020_ok
    s_sub_u32 s46, s46, 1
    s_branch Lsp_100020
Lsp_100020_ok:
    s_branch Lf_116_ok
Lf_117:
    ds_read_b32 v13, v12 offset:0
    s_waitcnt lgkmcnt(0)
    v_cmp_gt_u32 vcc, 34, v13
    s_cbranch_vccz Lf_117_ok
Lsp_100021:
    ds_read_b32 v13, v12 offset:0
    s_waitcnt lgkmcnt(0)
    v_cmp_gt_u32 vcc, 34, v13
    s_cbranch_vccz Lsp_100021_ok
    s_sleep 2
    s_cmp_eq_u32 s46, 0
    s_cbranch_scc1 Lsp_100021_ok
    s_sub_u32 s46, s46, 1
    s_branch Lsp_100021
Lsp_100021_ok:
    s_branch Lf_117_ok
Lf_118:
    ds_read_b32 v13, v12 offset:0
    s_waitcnt lgkmcnt(0)
    v_cmp_gt_u32 vcc, 36, v13
    s_cbranch_vccz Lf_118_ok
Lsp_100022:
    ds_read_b32 v13, v12 offset:0
    s_waitcnt lgkmcnt(0)
    v_cmp_gt_u32 vcc, 36, v13
    s_cbranch_vccz Lsp_100022_ok
    s_sleep 2
    s_cmp_eq_u32 s46, 0
    s_cbranch_scc1 Lsp_100022_ok
    s_sub_u32 s46, s46, 1
    s_branch Lsp_100022
Lsp_100022_ok:
    s_branch Lf_118_ok
Lf_119:
    ds_read_b32 v13, v12 offset:0
    s_waitcnt lgkmcnt(0)
    v_cmp_gt_u32 vcc, 38, v13
    s_cbranch_vccz Lf_119_ok
Lsp_100023:
    ds_read_b32 v13, v12 offset:0
    s_waitcnt lgkmcnt(0)
    v_cmp_gt_u32 vcc, 38, v13
    s_cbranch_vccz Lsp_100023_ok
    s_sleep 2
    s_cmp_eq_u32 s46, 0
    s_cbranch_scc1 Lsp_100023_ok
    s_sub_u32 s46, s46, 1
    s_branch Lsp_100023
Lsp_100023_ok:
    s_branch Lf_119_ok
Lf_120:
    ds_read_b32 v13, v12 offset:0
    s_waitcnt lgkmcnt(0)
    v_cmp_gt_u32 vcc, 40, v13
    s_cbranch_vccz Lf_120_ok
Lsp_100024:
    ds_read_b32 v13, v12 offset:0
    s_waitcnt lgkmcnt(0)
    v_cmp_gt_u32 vcc, 40, v13
    s_cbranch_vccz Lsp_100024_ok
    s_sleep 2
    s_cmp_eq_u32 s46, 0
    s_cbranch_scc1 Lsp_100024_ok
    s_sub_u32 s46, s46, 1
    s_branch Lsp_100024
Lsp_100024_ok:
    s_branch Lf_120_ok
Lf_121:
    ds_read_b32 v13, v12 offset:0
    s_waitcnt lgkmcnt(0)
    v_cmp_gt_u32 vcc, 42, v13
    s_cbranch_vccz Lf_121_ok
Lsp_100025:
    ds_read_b32 v13, v12 offset:0
    s_waitcnt lgkmcnt(0)
    v_cmp_gt_u32 vcc, 42, v13
    s_cbranch_vccz Lsp_100025_ok
    s_sleep 2
    s_cmp_eq_u32 s46, 0
    s_cbranch_scc1 Lsp_100025_ok
    s_sub_u32 s46, s46, 1
    s_branch Lsp_100025
Lsp_100025_ok:
    s_branch Lf_121_ok
Lf_122:
    ds_read_b32 v13, v12 offset:0
    s_waitcnt lgkmcnt(0)
    v_cmp_gt_u32 vcc, 44, v13
    s_cbranch_vccz Lf_122_ok
Lsp_100026:
    ds_read_b32 v13, v12 offset:0
    s_waitcnt lgkmcnt(0)
    v_cmp_gt_u32 vcc, 44, v13
    s_cbranch_vccz Lsp_100026_ok
    s_sleep 2
    s_cmp_eq_u32 s46, 0
    s_cbranch_scc1 Lsp_100026_ok
    s_sub_u32 s46, s46, 1
    s_branch Lsp_100026
Lsp_100026_ok:
    s_branch Lf_122_ok
Lf_123:
    ds_read_b32 v13, v12 offset:0
    s_waitcnt lgkmcnt(0)
    v_cmp_gt_u32 vcc, 46, v13
    s_cbranch_vccz Lf_123_ok
Lsp_100027:
    ds_read_b32 v13, v12 offset:0
    s_waitcnt lgkmcnt(0)
    v_cmp_gt_u32 vcc, 46, v13
    s_cbranch_vccz Lsp_100027_ok
    s_sleep 2
    s_cmp_eq_u32 s46, 0
    s_cbranch_scc1 Lsp_100027_ok
    s_sub_u32 s46, s46, 1
    s_branch Lsp_100027
Lsp_100027_ok:
    s_branch Lf_123_ok
L_end:
    s_endpgm
L_code_end:
.p2align 7
.type L_table,@object
L_table:
.long 0
.long 1
.long 2
.long 3
.long 4
.long 5
.long 6
.long 7
.long 8
.long 9
.long 10
.long 11
.long 12
.long 13
.long 14
.long 15
.long 16
.long 17
.long 18
.long 19
.long 20
.long 21
.long 22
.long 23
.long 24
.long 25
.long 26
.long 27
.long 28
.long 29
.long 30
.long 31
.long 32
.long 33
.long 34
.long 35
.long 36
.long 37
.long 38
.long 39
.long 40
.long 41
.long 42
.long 43
.long 44
.long 45
.long 46
.long 47
.long 48
.long 49
.long 50
.long 51
.long 52
.long 53
.long 54
.long 55
.long 56
.long 57
.long 58
.long 59
.long 60
.long 61
.long 62
.long 63
.size L_table, 256
.section .rodata,"a"
.p2align 6
.amdhsa_kernel sequential_preLN__sliding_local_dilated__mixer_s_mlp__prompt_kernel
  .amdhsa_next_free_vgpr 256
  .amdhsa_next_free_sgpr 102
  .amdhsa_accum_offset 256
  .amdhsa_group_segment_fixed_size 0
  .amdhsa_kernarg_size 88
  .amdhsa_user_sgpr_count 2
  .amdhsa_user_sgpr_kernarg_segment_ptr 1
  .amdhsa_system_sgpr_workgroup_id_x 1
  .amdhsa_float_denorm_mode_32 3
.end_amdhsa_kernel
```
